```python
import torch

def _softmax(x, axis=-1):
    return torch.softmax(x, dim=axis)
def _gelu(x):
    return torch.nn.functional.gelu(x, approximate="tanh")
def _silu(x):
    return torch.nn.functional.silu(x)
def _sigmoid(x):
    return torch.sigmoid(x)
def _layernorm(x, axis=-1, eps=1e-5):
    m = x.mean(dim=axis, keepdim=True)
    v = x.var(dim=axis, keepdim=True, unbiased=False)
    return (x - m) / torch.sqrt(v + eps)
def _scatter_add(tgt, idx, src, axis=0):
    return tgt.clone().index_add_(axis, idx, src)
def _segment_sum(src, seg, n):
    out = torch.zeros((n,) + src.shape[1:], dtype=src.dtype)
    return out.index_add_(0, seg, src)
def _pad(x, pw):
    flat = tuple(v for pair in reversed(pw) for v in pair)
    return torch.nn.functional.pad(x, flat)

kernel_name = 'parallel_sum__spectral_fnet__geglu_ffn__prompt'

def setup_inputs():

    _w = (lambda a: (lambda t: t.to(torch.bfloat16) if t.is_floating_point() else t)(torch.as_tensor(a)))
    def _A_setup():
        B, S, D = 1, 2048, 576
        ns = torch.arange(S)[:, None] * torch.arange(S)[None, :]
        nd = torch.arange(D)[:, None] * torch.arange(D)[None, :]
        Ws_re = torch.cos(-2.0 * torch.pi * ns / S).to(float)
        Ws_im = torch.sin(-2.0 * torch.pi * ns / S).to(float)
        Wd_re = torch.cos(-2.0 * torch.pi * nd / D).to(float)
        Wd_im = torch.sin(-2.0 * torch.pi * nd / D).to(float)
        return {
            "x": _w((lambda *s: torch.randn(*s, dtype=torch.bfloat16) * 0.05)(B, S, D)),
            "dft_seq_re": _w(Ws_re),
            "dft_seq_im": _w(Ws_im),
            "dft_hid_re": _w(Wd_re),
            "dft_hid_im": _w(Wd_im),
        }
    _A_in = _A_setup()

    def _B_setup():
        B, S, D, F = 1, 2048, 576, 4608
        return {
            "x": _w((lambda *s: torch.randn(*s, dtype=torch.bfloat16) * 0.05)(B, S, D)),
            "w_gate": _w((lambda *s: torch.randn(*s, dtype=torch.bfloat16) * 0.2)(D, F)),
            "w_up": _w((lambda *s: torch.randn(*s, dtype=torch.bfloat16) * 0.2)(D, F)),
            "w_down": _w((lambda *s: torch.randn(*s, dtype=torch.bfloat16) * 0.2)(F, D)),
        }
    _B_in = _B_setup()

    return {
        "A_x": _A_in["x"],
        "A_dft_seq_re": _A_in["dft_seq_re"],
        "A_dft_seq_im": _A_in["dft_seq_im"],
        "A_dft_hid_re": _A_in["dft_hid_re"],
        "A_dft_hid_im": _A_in["dft_hid_im"],
        "B_x": _B_in["x"],
        "B_w_gate": _B_in["w_gate"],
        "B_w_up": _B_in["w_up"],
        "B_w_down": _B_in["w_down"],
    }

def reference(A_x, A_dft_seq_re, A_dft_seq_im, A_dft_hid_re, A_dft_hid_im, B_x, B_w_gate, B_w_up, B_w_down):
    def _A_ref(x, dft_seq_re, dft_seq_im, dft_hid_re, dft_hid_im):
        a = torch.einsum("bsd,ed->bse", x, dft_hid_re)
        b = torch.einsum("bsd,ed->bse", x, dft_hid_im)
        y = torch.einsum("ts,bse->bte", dft_seq_re, a) - torch.einsum("ts,bse->bte", dft_seq_im, b)
        return y

    def _B_ref(x, w_gate, w_up, w_down):
        return (_gelu(x @ w_gate) * (x @ w_up)) @ w_down

    x = A_x
    xn = _layernorm(x, axis=-1)
    return x + _A_ref(xn, A_dft_seq_re, A_dft_seq_im, A_dft_hid_re, A_dft_hid_im) + _B_ref(xn, B_w_gate, B_w_up, B_w_down)
```

```asm
; @launch kernel=prep_kernel grid=(428,1,1) block=(256,1,1) lds=12288
; @launch kernel=ffn_kernel grid=(256,1,1) block=(256,1,1) lds=163840
; @launch kernel=fin_kernel grid=(256,1,1) block=(576,1,1) lds=0
.amdgcn_target "amdgcn-amd-amdhsa--gfx950"
.text
.globl prep_kernel
.p2align 8
.type prep_kernel,@function
prep_kernel:
    s_cmp_ge_u32 s2, 428
    s_cbranch_scc1 L_k1_done
    s_load_dwordx2 s[4:5], s[0:1], 0
    s_load_dwordx4 s[8:11], s[0:1], 16
    s_load_dwordx2 s[12:13], s[0:1], 32
    s_load_dwordx8 s[16:23], s[0:1], 48
    s_load_dwordx4 s[24:27], s[0:1], 80
    s_waitcnt lgkmcnt(0)
    v_lshrrev_b32 v20, 6, v0
    v_and_b32 v21, 63, v0
    v_readfirstlane_b32 s48, v20
    s_cmp_ge_u32 s2, 428
    s_cbranch_scc1 L_k1_done
    s_cmp_ge_u32 s2, 256
    s_cbranch_scc1 L_k1_df
    s_mov_b32 s32, s4
    s_mov_b32 s33, s5
    s_mov_b32 s34, 2359296
    s_mov_b32 s35, 0x00020000
    s_mov_b32 s36, s26
    s_mov_b32 s37, s27
    s_mov_b32 s38, 2359296
    s_mov_b32 s39, 0x00020000
    s_add_u32 s40, s26, 4194304
    s_addc_u32 s41, s27, 0
    s_mov_b32 s42, 2367488
    s_mov_b32 s43, 0x00020000
    v_lshrrev_b32 v1, 5, v0
    v_and_b32 v2, 31, v0
    s_lshl_b32 s3, s2, 3
    v_add_u32 v1, s3, v1
    v_mul_u32_u24 v3, 1152, v1
    v_lshl_add_u32 v3, v2, 2, v3
    buffer_load_dword v8, v3, s[32:35], 0 offen offset:0
    buffer_load_dword v9, v3, s[32:35], 0 offen offset:128
    buffer_load_dword v10, v3, s[32:35], 0 offen offset:256
    buffer_load_dword v11, v3, s[32:35], 0 offen offset:384
    buffer_load_dword v12, v3, s[32:35], 0 offen offset:512
    buffer_load_dword v13, v3, s[32:35], 0 offen offset:640
    buffer_load_dword v14, v3, s[32:35], 0 offen offset:768
    buffer_load_dword v15, v3, s[32:35], 0 offen offset:896
    buffer_load_dword v16, v3, s[32:35], 0 offen offset:1024
    v_lshrrev_b32 v84, 2, v2
    v_lshlrev_b32 v84, 7, v84
    v_lshrrev_b32 v85, 5, v0
    v_lshl_add_u32 v84, v85, 4, v84
    v_and_b32 v85, 3, v2
    v_lshl_add_u32 v84, v85, 2, v84
    s_waitcnt vmcnt(0)
    v_lshlrev_b32 v32, 16, v8
    v_and_b32 v33, 0xffff0000, v8
    v_lshlrev_b32 v34, 16, v9
    v_and_b32 v35, 0xffff0000, v9
    v_lshlrev_b32 v36, 16, v10
    v_and_b32 v37, 0xffff0000, v10
    v_lshlrev_b32 v38, 16, v11
    v_and_b32 v39, 0xffff0000, v11
    v_lshlrev_b32 v40, 16, v12
    v_and_b32 v41, 0xffff0000, v12
    v_lshlrev_b32 v42, 16, v13
    v_and_b32 v43, 0xffff0000, v13
    v_lshlrev_b32 v44, 16, v14
    v_and_b32 v45, 0xffff0000, v14
    v_lshlrev_b32 v46, 16, v15
    v_and_b32 v47, 0xffff0000, v15
    v_lshlrev_b32 v48, 16, v16
    v_and_b32 v49, 0xffff0000, v16
    v_pk_add_f32 v[70:71], v[32:33], v[34:35]
    v_pk_add_f32 v[72:73], v[36:37], v[38:39]
    v_pk_add_f32 v[70:71], v[70:71], v[40:41]
    v_pk_add_f32 v[72:73], v[72:73], v[42:43]
    v_pk_add_f32 v[70:71], v[70:71], v[44:45]
    v_pk_add_f32 v[72:73], v[72:73], v[46:47]
    v_pk_add_f32 v[70:71], v[70:71], v[48:49]
    v_pk_add_f32 v[70:71], v[70:71], v[72:73]
    v_add_f32 v70, v70, v71
    s_nop 1
    v_add_f32_dpp v70, v70, v70 row_ror:8 row_mask:0xf bank_mask:0xf
    s_nop 1
    v_add_f32_dpp v70, v70, v70 row_ror:4 row_mask:0xf bank_mask:0xf
    s_nop 1
    v_add_f32_dpp v70, v70, v70 row_ror:2 row_mask:0xf bank_mask:0xf
    s_nop 1
    v_add_f32_dpp v70, v70, v70 row_ror:1 row_mask:0xf bank_mask:0xf
    ds_swizzle_b32 v69, v70 offset:0x401F
    s_waitcnt lgkmcnt(0)
    v_add_f32 v70, v70, v69
    v_mul_f32 v70, 0xbae38e39, v70
    v_mov_b32 v72, 0
    v_mov_b32 v73, 0
    v_mov_b32 v80, 0
    v_mov_b32 v81, 0
    v_pk_add_f32 v[74:75], v[32:33], v[70:71] op_sel_hi:[1,0]
    v_pk_fma_f32 v[72:73], v[74:75], v[74:75], v[72:73]
    v_pk_add_f32 v[76:77], v[34:35], v[70:71] op_sel_hi:[1,0]
    v_pk_fma_f32 v[80:81], v[76:77], v[76:77], v[80:81]
    v_pk_add_f32 v[74:75], v[36:37], v[70:71] op_sel_hi:[1,0]
    v_pk_fma_f32 v[72:73], v[74:75], v[74:75], v[72:73]
    v_pk_add_f32 v[76:77], v[38:39], v[70:71] op_sel_hi:[1,0]
    v_pk_fma_f32 v[80:81], v[76:77], v[76:77], v[80:81]
    v_pk_add_f32 v[74:75], v[40:41], v[70:71] op_sel_hi:[1,0]
    v_pk_fma_f32 v[72:73], v[74:75], v[74:75], v[72:73]
    v_pk_add_f32 v[76:77], v[42:43], v[70:71] op_sel_hi:[1,0]
    v_pk_fma_f32 v[80:81], v[76:77], v[76:77], v[80:81]
    v_pk_add_f32 v[74:75], v[44:45], v[70:71] op_sel_hi:[1,0]
    v_pk_fma_f32 v[72:73], v[74:75], v[74:75], v[72:73]
    v_pk_add_f32 v[76:77], v[46:47], v[70:71] op_sel_hi:[1,0]
    v_pk_fma_f32 v[80:81], v[76:77], v[76:77], v[80:81]
    v_pk_add_f32 v[74:75], v[48:49], v[70:71] op_sel_hi:[1,0]
    v_pk_fma_f32 v[72:73], v[74:75], v[74:75], v[72:73]
    v_pk_add_f32 v[72:73], v[72:73], v[80:81]
    v_add_f32 v72, v72, v73
    s_nop 1
    v_add_f32_dpp v72, v72, v72 row_ror:8 row_mask:0xf bank_mask:0xf
    s_nop 1
    v_add_f32_dpp v72, v72, v72 row_ror:4 row_mask:0xf bank_mask:0xf
    s_nop 1
    v_add_f32_dpp v72, v72, v72 row_ror:2 row_mask:0xf bank_mask:0xf
    s_nop 1
    v_add_f32_dpp v72, v72, v72 row_ror:1 row_mask:0xf bank_mask:0xf
    ds_swizzle_b32 v69, v72 offset:0x401F
    s_waitcnt lgkmcnt(0)
    v_add_f32 v72, v72, v69
    v_mul_f32 v72, 0x3ae38e39, v72
    v_sub_f32 v82, 0, v70
    v_cvt_pk_bf16_f32 v76, v82, v72
    v_lshlrev_b32 v70, 16, v76
    v_and_b32 v72, 0xffff0000, v76
    v_sub_f32 v70, 0, v70
    v_add_f32 v72, 0x3727c5ac, v72
    v_cvt_pk_bf16_f32 v76, v72, v72
    v_lshlrev_b32 v72, 16, v76
    v_sqrt_f32 v72, v72
    s_nop 0
    v_cvt_pk_bf16_f32 v76, v72, v72
    v_lshlrev_b32 v72, 16, v76
    v_rcp_f32 v72, v72
    v_mov_b32 v77, 0
    v_mov_b32 v83, 0xbf803f80
    v_pk_add_f32 v[32:33], v[32:33], v[70:71] op_sel_hi:[1,0]
    v_cvt_pk_bf16_f32 v76, v32, v33
    v_lshlrev_b32 v32, 16, v76
    v_and_b32 v33, 0xffff0000, v76
    v_pk_mul_f32 v[32:33], v[32:33], v[72:73] op_sel_hi:[1,0]
    v_cvt_pk_bf16_f32 v8, v32, v33
    ds_write_b32 v84, v8 offset:0
    v_dot2_f32_bf16 v77, v8, v83, v77
    v_pk_add_f32 v[34:35], v[34:35], v[70:71] op_sel_hi:[1,0]
    v_cvt_pk_bf16_f32 v76, v34, v35
    v_lshlrev_b32 v34, 16, v76
    v_and_b32 v35, 0xffff0000, v76
    v_pk_mul_f32 v[34:35], v[34:35], v[72:73] op_sel_hi:[1,0]
    v_cvt_pk_bf16_f32 v9, v34, v35
    ds_write_b32 v84, v9 offset:1024
    v_dot2_f32_bf16 v77, v9, v83, v77
    v_pk_add_f32 v[36:37], v[36:37], v[70:71] op_sel_hi:[1,0]
    v_cvt_pk_bf16_f32 v76, v36, v37
    v_lshlrev_b32 v36, 16, v76
    v_and_b32 v37, 0xffff0000, v76
    v_pk_mul_f32 v[36:37], v[36:37], v[72:73] op_sel_hi:[1,0]
    v_cvt_pk_bf16_f32 v10, v36, v37
    ds_write_b32 v84, v10 offset:2048
    v_dot2_f32_bf16 v77, v10, v83, v77
    v_pk_add_f32 v[38:39], v[38:39], v[70:71] op_sel_hi:[1,0]
    v_cvt_pk_bf16_f32 v76, v38, v39
    v_lshlrev_b32 v38, 16, v76
    v_and_b32 v39, 0xffff0000, v76
    v_pk_mul_f32 v[38:39], v[38:39], v[72:73] op_sel_hi:[1,0]
    v_cvt_pk_bf16_f32 v11, v38, v39
    ds_write_b32 v84, v11 offset:3072
    v_dot2_f32_bf16 v77, v11, v83, v77
    v_pk_add_f32 v[40:41], v[40:41], v[70:71] op_sel_hi:[1,0]
    v_cvt_pk_bf16_f32 v76, v40, v41
    v_lshlrev_b32 v40, 16, v76
    v_and_b32 v41, 0xffff0000, v76
    v_pk_mul_f32 v[40:41], v[40:41], v[72:73] op_sel_hi:[1,0]
    v_cvt_pk_bf16_f32 v12, v40, v41
    ds_write_b32 v84, v12 offset:4096
    v_dot2_f32_bf16 v77, v12, v83, v77
    v_pk_add_f32 v[42:43], v[42:43], v[70:71] op_sel_hi:[1,0]
    v_cvt_pk_bf16_f32 v76, v42, v43
    v_lshlrev_b32 v42, 16, v76
    v_and_b32 v43, 0xffff0000, v76
    v_pk_mul_f32 v[42:43], v[42:43], v[72:73] op_sel_hi:[1,0]
    v_cvt_pk_bf16_f32 v13, v42, v43
    ds_write_b32 v84, v13 offset:5120
    v_dot2_f32_bf16 v77, v13, v83, v77
    v_pk_add_f32 v[44:45], v[44:45], v[70:71] op_sel_hi:[1,0]
    v_cvt_pk_bf16_f32 v76, v44, v45
    v_lshlrev_b32 v44, 16, v76
    v_and_b32 v45, 0xffff0000, v76
    v_pk_mul_f32 v[44:45], v[44:45], v[72:73] op_sel_hi:[1,0]
    v_cvt_pk_bf16_f32 v14, v44, v45
    ds_write_b32 v84, v14 offset:6144
    v_dot2_f32_bf16 v77, v14, v83, v77
    v_pk_add_f32 v[46:47], v[46:47], v[70:71] op_sel_hi:[1,0]
    v_cvt_pk_bf16_f32 v76, v46, v47
    v_lshlrev_b32 v46, 16, v76
    v_and_b32 v47, 0xffff0000, v76
    v_pk_mul_f32 v[46:47], v[46:47], v[72:73] op_sel_hi:[1,0]
    v_cvt_pk_bf16_f32 v15, v46, v47
    ds_write_b32 v84, v15 offset:7168
    v_dot2_f32_bf16 v77, v15, v83, v77
    v_pk_add_f32 v[48:49], v[48:49], v[70:71] op_sel_hi:[1,0]
    v_cvt_pk_bf16_f32 v76, v48, v49
    v_lshlrev_b32 v48, 16, v76
    v_and_b32 v49, 0xffff0000, v76
    v_pk_mul_f32 v[48:49], v[48:49], v[72:73] op_sel_hi:[1,0]
    v_cvt_pk_bf16_f32 v16, v48, v49
    ds_write_b32 v84, v16 offset:8192
    v_dot2_f32_bf16 v77, v16, v83, v77
    s_waitcnt lgkmcnt(0)
    s_barrier
    v_lshlrev_b32 v84, 4, v0
    ds_read_b128 v[88:91], v84 offset:0
    ds_read_b128 v[92:95], v84 offset:4096
    ds_read_b128 v[96:99], v84 offset:8192
    s_lshr_b32 s30, s2, 2
    s_mul_i32 s30, s30, 36864
    s_and_b32 s31, s2, 3
    s_lshl_b32 s31, s31, 7
    s_add_u32 s30, s30, s31
    v_lshrrev_b32 v85, 4, v0
    v_lshlrev_b32 v85, 10, v85
    v_bfe_u32 v86, v0, 3, 1
    v_lshl_add_u32 v85, v86, 9, v85
    v_and_b32 v86, 7, v0
    v_lshl_add_u32 v85, v86, 4, v85
    v_cmp_gt_u32 vcc, 64, v0
    v_mov_b32 v86, 0x7ff00000
    s_nop 0
    v_cndmask_b32 v86, v86, v85, vcc
    s_waitcnt lgkmcnt(2)
    buffer_store_dwordx4 v[88:91], v85, s[36:39], s30 offen sc1
    s_add_u32 s30, s30, 16384
    s_waitcnt lgkmcnt(1)
    buffer_store_dwordx4 v[92:95], v85, s[36:39], s30 offen sc1
    s_add_u32 s30, s30, 16384
    s_waitcnt lgkmcnt(0)
    buffer_store_dwordx4 v[96:99], v86, s[36:39], s30 offen sc1
    s_nop 1
    v_add_f32_dpp v77, v77, v77 row_ror:8 row_mask:0xf bank_mask:0xf
    s_nop 1
    v_add_f32_dpp v77, v77, v77 row_ror:4 row_mask:0xf bank_mask:0xf
    s_nop 1
    v_add_f32_dpp v77, v77, v77 row_ror:2 row_mask:0xf bank_mask:0xf
    s_nop 1
    v_add_f32_dpp v77, v77, v77 row_ror:1 row_mask:0xf bank_mask:0xf
    ds_swizzle_b32 v69, v77 offset:0x401F
    s_waitcnt lgkmcnt(0)
    v_add_f32 v77, v77, v69
    v_cvt_pk_bf16_f32 v77, v77, v77
    v_mov_b32 v78, 0
    v_lshlrev_b32 v79, 1, v1
    v_add_u32 v79, 2359296, v79
    v_cmp_eq_u32 vcc, 0, v2
    v_mov_b32 v80, 0x7ff00000
    s_nop 0
    v_cndmask_b32 v79, v80, v79, vcc
    buffer_store_short v77, v79, s[40:43], 0 offen
    s_movk_i32 s30, 4096
    buffer_store_short v78, v79, s[40:43], s30 offen
    s_branch L_k1_done
L_k1_df:
    s_cmp_ge_u32 s2, 418
    s_cbranch_scc1 L_k1_tab
    s_sub_u32 s28, s2, 256
    s_lshl_b32 s28, s28, 2
    s_add_u32 s28, s28, s48
    s_mul_hi_u32 s29, s28, 119304648
    s_mul_i32 s30, s29, 36
    s_sub_u32 s30, s28, s30
    s_cmp_ge_u32 s29, 9
    s_cselect_b32 s32, s12, s10
    s_cselect_b32 s33, s13, s11
    s_cselect_b32 s31, 9, 0
    s_mov_b32 s34, 663552
    s_mov_b32 s35, 0x00020000
    s_sub_u32 s29, s29, s31
    s_add_u32 s36, s26, 8388608
    s_addc_u32 s37, s27, 0
    s_mov_b32 s38, 1327104
    s_mov_b32 s39, 0x00020000
    v_and_b32 v1, 31, v21
    s_lshl_b32 s29, s29, 5
    v_add_u32 v1, s29, v1
    v_mul_u32_u24 v1, 1152, v1
    v_lshrrev_b32 v2, 5, v21
    v_lshl_add_u32 v1, v2, 4, v1
    s_lshl_b32 s40, s30, 5
    buffer_load_dwordx4 v[8:11], v1, s[32:35], s40 offen
    v_lshlrev_b32 v3, 4, v21
    s_sub_u32 s41, s28, s30
    s_add_u32 s28, s28, s41
    s_lshl_b32 s28, s28, 10
    s_sub_u32 s60, s2, 256
    s_lshr_b32 s60, s60, 3
    s_cmp_ge_u32 s60, 4
    s_cbranch_scc1 L_cp3_w0
    s_getpc_b64 s[56:57]
L_k1_pc3:
    s_add_u32 s56, s56, ffn_kernel-L_k1_pc3
    s_addc_u32 s57, s57, 0
    s_lshl_b32 s60, s60, 14
    v_lshlrev_b32 v30, 6, v0
    v_add_u32 v30, s60, v30
    v_cmp_gt_u32 vcc, L_code_end-ffn_kernel, v30
    s_and_saveexec_b64 s[58:59], vcc
    s_cbranch_execz L_cp3_r
    global_load_dword v31, v30, s[56:57]
    s_mov_b64 exec, s[58:59]
    s_waitcnt vmcnt(1)
    s_branch L_cp3_j
L_cp3_r:
    s_mov_b64 exec, s[58:59]
L_cp3_w0:
    s_waitcnt vmcnt(0)
L_cp3_j:
    buffer_store_dwordx4 v[8:11], v3, s[36:39], s28 offen sc1
    s_add_u32 s28, s28, 36864
    buffer_store_dwordx4 v[8:11], v3, s[36:39], s28 offen sc1
    s_branch L_k1_done
L_k1_tab:
    s_sub_u32 s28, s2, 418
    s_lshl_b32 s28, s28, 2
    s_add_u32 s28, s28, s48
    s_cmp_eq_u32 s28, 38
    s_cbranch_scc0 L_k1_tab2
    s_add_u32 s36, s26, 10485760
    s_addc_u32 s37, s27, 0
    s_mov_b32 s38, 3072
    s_mov_b32 s39, 0x00020000
    v_lshlrev_b32 v3, 4, v21
    v_mov_b32 v8, 0
    v_mov_b32 v9, 0
    v_mov_b32 v10, 0
    v_mov_b32 v11, 0
    buffer_store_dwordx4 v[8:11], v3, s[36:39], 0 offen
    buffer_store_dwordx4 v[8:11], v3, s[36:39], 0 offen offset:1024
    buffer_store_dwordx4 v[8:11], v3, s[36:39], 0 offen offset:2048
    s_branch L_k1_done
L_k1_tab2:
    s_cmp_ge_u32 s28, 38
    s_cbranch_scc1 L_k1_done
    s_add_u32 s36, s26, 9961472
    s_addc_u32 s37, s27, 0
    s_mov_b32 s38, 38912
    s_mov_b32 s39, 0x00020000
    v_and_b32 v1, 31, v21
    v_lshrrev_b32 v2, 5, v21
    v_lshlrev_b32 v3, 4, v21
    s_lshl_b32 s29, s28, 10
    s_cmp_ge_u32 s28, 22
    s_cbranch_scc1 L_k1_t3
    s_cmp_ge_u32 s28, 6
    s_cbranch_scc1 L_k1_t2
    s_and_b32 s30, s28, 1
    s_lshl_b32 s30, s30, 4
    v_lshl_add_u32 v4, v2, 3, s30
    v_add_u32 v5, 0, v4
    v_mul_u32_u24 v5, v5, v1
    v_and_b32 v5, 31, v5
    v_cvt_f32_u32 v5, v5
    v_mul_f32 v5, 0x3d000000, v5
    v_cos_f32 v8, v5
    v_sin_f32 v16, v5
    v_add_u32 v5, 1, v4
    v_mul_u32_u24 v5, v5, v1
    v_and_b32 v5, 31, v5
    v_cvt_f32_u32 v5, v5
    v_mul_f32 v5, 0x3d000000, v5
    v_cos_f32 v9, v5
    v_sin_f32 v17, v5
    v_add_u32 v5, 2, v4
    v_mul_u32_u24 v5, v5, v1
    v_and_b32 v5, 31, v5
    v_cvt_f32_u32 v5, v5
    v_mul_f32 v5, 0x3d000000, v5
    v_cos_f32 v10, v5
    v_sin_f32 v18, v5
    v_add_u32 v5, 3, v4
    v_mul_u32_u24 v5, v5, v1
    v_and_b32 v5, 31, v5
    v_cvt_f32_u32 v5, v5
    v_mul_f32 v5, 0x3d000000, v5
    v_cos_f32 v11, v5
    v_sin_f32 v19, v5
    v_add_u32 v5, 4, v4
    v_mul_u32_u24 v5, v5, v1
    v_and_b32 v5, 31, v5
    v_cvt_f32_u32 v5, v5
    v_mul_f32 v5, 0x3d000000, v5
    v_cos_f32 v12, v5
    v_sin_f32 v20, v5
    v_add_u32 v5, 5, v4
    v_mul_u32_u24 v5, v5, v1
    v_and_b32 v5, 31, v5
    v_cvt_f32_u32 v5, v5
    v_mul_f32 v5, 0x3d000000, v5
    v_cos_f32 v13, v5
    v_sin_f32 v21, v5
    v_add_u32 v5, 6, v4
    v_mul_u32_u24 v5, v5, v1
    v_and_b32 v5, 31, v5
    v_cvt_f32_u32 v5, v5
    v_mul_f32 v5, 0x3d000000, v5
    v_cos_f32 v14, v5
    v_sin_f32 v22, v5
    v_add_u32 v5, 7, v4
    v_mul_u32_u24 v5, v5, v1
    v_and_b32 v5, 31, v5
    v_cvt_f32_u32 v5, v5
    v_mul_f32 v5, 0x3d000000, v5
    v_cos_f32 v15, v5
    v_sin_f32 v23, v5
    s_nop 0
    s_cmp_lt_u32 s28, 2
    s_cbranch_scc1 L_k1_t1p
    v_mov_b32 v8, v16
    v_mov_b32 v9, v17
    v_mov_b32 v10, v18
    v_mov_b32 v11, v19
    v_mov_b32 v12, v20
    v_mov_b32 v13, v21
    v_mov_b32 v14, v22
    v_mov_b32 v15, v23
    s_cmp_lt_u32 s28, 4
    s_cbranch_scc1 L_k1_t1p
    v_sub_f32 v8, 0, v16
    v_sub_f32 v9, 0, v17
    v_sub_f32 v10, 0, v18
    v_sub_f32 v11, 0, v19
    v_sub_f32 v12, 0, v20
    v_sub_f32 v13, 0, v21
    v_sub_f32 v14, 0, v22
    v_sub_f32 v15, 0, v23
L_k1_t1p:
    v_cvt_pk_bf16_f32 v24, v8, v9
    v_cvt_pk_bf16_f32 v25, v10, v11
    v_cvt_pk_bf16_f32 v26, v12, v13
    v_cvt_pk_bf16_f32 v27, v14, v15
    buffer_store_dwordx4 v[24:27], v3, s[36:39], s29 offen
    s_branch L_k1_done
L_k1_t2:
    s_sub_u32 s30, s28, 6
    s_lshr_b32 s31, s30, 3
    s_and_b32 s30, s30, 7
    s_lshl_b32 s31, s31, 5
    s_lshr_b32 s40, s30, 1
    s_lshl_b32 s40, s40, 3
    s_add_u32 s31, s31, s40
    s_and_b32 s40, s30, 1
    s_lshl_b32 s40, s40, 1
    s_add_u32 s31, s31, s40
    v_lshl_add_u32 v4, v2, 2, s31
    v_add_u32 v5, 0, v4
    v_mul_u32_u24 v5, v5, v1
    v_cvt_f32_u32 v5, v5
    v_mul_f32 v5, 0x3a000000, v5
    v_cos_f32 v24, v5
    v_sin_f32 v25, v5
    v_add_u32 v5, 1, v4
    v_mul_u32_u24 v5, v5, v1
    v_cvt_f32_u32 v5, v5
    v_mul_f32 v5, 0x3a000000, v5
    v_cos_f32 v26, v5
    v_sin_f32 v27, v5
    s_nop 1
    buffer_store_dwordx4 v[24:27], v3, s[36:39], s29 offen
    s_branch L_k1_done
L_k1_t3:
    s_sub_u32 s30, s28, 22
    s_lshr_b32 s31, s30, 3
    s_bfe_u32 s40, s30, 0x10002
    s_and_b32 s30, s30, 3
    s_lshl_b32 s40, s40, 5
    v_add_u32 v1, s40, v1
    s_lshl_b32 s30, s30, 4
    v_lshl_add_u32 v4, v2, 2, s30
    v_add_u32 v5, 0, v4
    v_mul_u32_u24 v5, v5, v1
    v_and_b32 v5, 63, v5
    v_cvt_f32_u32 v5, v5
    v_mul_f32 v5, 0x3c800000, v5
    v_cos_f32 v8, v5
    v_sin_f32 v16, v5
    v_add_u32 v5, 1, v4
    v_mul_u32_u24 v5, v5, v1
    v_and_b32 v5, 63, v5
    v_cvt_f32_u32 v5, v5
    v_mul_f32 v5, 0x3c800000, v5
    v_cos_f32 v9, v5
    v_sin_f32 v17, v5
    v_add_u32 v5, 2, v4
    v_mul_u32_u24 v5, v5, v1
    v_and_b32 v5, 63, v5
    v_cvt_f32_u32 v5, v5
    v_mul_f32 v5, 0x3c800000, v5
    v_cos_f32 v10, v5
    v_sin_f32 v18, v5
    v_add_u32 v5, 3, v4
    v_mul_u32_u24 v5, v5, v1
    v_and_b32 v5, 63, v5
    v_cvt_f32_u32 v5, v5
    v_mul_f32 v5, 0x3c800000, v5
    v_cos_f32 v11, v5
    v_sin_f32 v19, v5
    v_add_u32 v5, 8, v4
    v_mul_u32_u24 v5, v5, v1
    v_and_b32 v5, 63, v5
    v_cvt_f32_u32 v5, v5
    v_mul_f32 v5, 0x3c800000, v5
    v_cos_f32 v12, v5
    v_sin_f32 v20, v5
    v_add_u32 v5, 9, v4
    v_mul_u32_u24 v5, v5, v1
    v_and_b32 v5, 63, v5
    v_cvt_f32_u32 v5, v5
    v_mul_f32 v5, 0x3c800000, v5
    v_cos_f32 v13, v5
    v_sin_f32 v21, v5
    v_add_u32 v5, 10, v4
    v_mul_u32_u24 v5, v5, v1
    v_and_b32 v5, 63, v5
    v_cvt_f32_u32 v5, v5
    v_mul_f32 v5, 0x3c800000, v5
    v_cos_f32 v14, v5
    v_sin_f32 v22, v5
    v_add_u32 v5, 11, v4
    v_mul_u32_u24 v5, v5, v1
    v_and_b32 v5, 63, v5
    v_cvt_f32_u32 v5, v5
    v_mul_f32 v5, 0x3c800000, v5
    v_cos_f32 v15, v5
    v_sin_f32 v23, v5
    s_nop 0
    s_cmp_eq_u32 s31, 0
    s_cbranch_scc1 L_k1_t3p
    v_mov_b32 v8, v16
    v_mov_b32 v9, v17
    v_mov_b32 v10, v18
    v_mov_b32 v11, v19
    v_mov_b32 v12, v20
    v_mov_b32 v13, v21
    v_mov_b32 v14, v22
    v_mov_b32 v15, v23
L_k1_t3p:
    v_cvt_pk_bf16_f32 v24, v8, v9
    v_cvt_pk_bf16_f32 v25, v10, v11
    v_cvt_pk_bf16_f32 v26, v12, v13
    v_cvt_pk_bf16_f32 v27, v14, v15
    buffer_store_dwordx4 v[24:27], v3, s[36:39], s29 offen
L_k1_done:
    s_endpgm
.text
.globl ffn_kernel
.p2align 8
.type ffn_kernel,@function
ffn_kernel:
    s_cmp_ge_u32 s2, 256
    s_cbranch_scc1 L_ffn_done
    s_load_dwordx8 s[16:23], s[0:1], 48
    s_load_dwordx4 s[24:27], s[0:1], 80
    v_lshrrev_b32 v20, 6, v0
    v_and_b32 v248, 63, v0
    v_readfirstlane_b32 s48, v20
    s_and_b32 s62, s2, 7
    s_lshr_b32 s63, s2, 3
    s_lshr_b32 s51, s63, 1
    s_and_b32 s63, s63, 1
    s_lshl_b32 s52, s62, 1
    s_add_u32 s52, s52, s63
    s_lshr_b32 s49, s48, 1
    s_and_b32 s50, s48, 1
    s_mul_i32 s62, s52, 288
    s_lshl_b32 s53, s63, 5
    s_add_u32 s53, s53, s62
    s_lshl_b32 s56, s53, 1
    s_mul_i32 s82, s51, 18
    s_lshr_b32 s82, s82, 4
    s_lshl_b32 s55, s48, 11
    v_lshlrev_b32 v1, 4, v248
    v_lshrrev_b32 v200, 3, v248
    s_lshl_b32 s87, s50, 4
    v_add_u32 v200, s87, v200
    v_mul_u32_u24 v200, 9216, v200
    v_bfe_u32 v201, v248, 4, 1
    s_lshl_b32 s87, s49, 1
    v_or_b32 v201, s87, v201
    v_bfe_u32 v202, v248, 1, 2
    v_xor_b32 v202, v202, v201
    v_and_b32 v203, 1, v248
    v_lshlrev_b32 v203, 4, v203
    v_lshl_add_u32 v203, v202, 5, v203
    v_add_u32 v2, v200, v203
    v_add_u32 v3, 73728, v2
    s_lshl_b32 s87, s51, 2
    s_add_u32 s87, s87, s48
    s_mul_i32 s70, s87, 36864
    s_waitcnt lgkmcnt(0)
    s_cmp_ge_u32 s48, 2
    s_cselect_b32 s32, s18, s16
    s_cselect_b32 s33, s19, s17
    s_mov_b32 s34, 5308416
    s_mov_b32 s35, 0x00020000
    s_mov_b32 s36, s26
    s_mov_b32 s37, s27
    s_mov_b32 s38, 2359296
    s_mov_b32 s39, 0x00020000
    s_mov_b32 s40, s20
    s_mov_b32 s41, s21
    s_mov_b32 s42, 5308416
    s_mov_b32 s43, 0x00020000
    s_mov_b32 s4, s82
    s_mul_i32 s61, s4, 294912
    s_add_u32 m0, s55, 0
    s_add_u32 s61, s61, s56
    buffer_load_dwordx4 v2, s[32:35], s61 offen lds
    s_lshl_b32 s69, s4, 11
    s_add_u32 m0, s55, 73728
    s_add_u32 s69, s69, s70
    buffer_load_dwordx4 v1, s[36:39], s69 offen lds
    s_add_u32 m0, s55, 1024
    s_nop 0
    buffer_load_dwordx4 v3, s[32:35], s61 offen lds
    s_add_u32 m0, s55, 74752
    s_add_u32 s69, s69, 1024
    buffer_load_dwordx4 v1, s[36:39], s69 offen lds
    s_add_u32 s5, s4, 1
    s_cmp_eq_u32 s5, 18
    s_cselect_b32 s5, 0, s5
    s_mul_i32 s61, s5, 294912
    s_add_u32 m0, s55, 8192
    s_add_u32 s61, s61, s56
    buffer_load_dwordx4 v2, s[32:35], s61 offen lds
    s_lshl_b32 s69, s5, 11
    s_add_u32 m0, s55, 81920
    s_add_u32 s69, s69, s70
    buffer_load_dwordx4 v1, s[36:39], s69 offen lds
    s_add_u32 m0, s55, 9216
    s_nop 0
    buffer_load_dwordx4 v3, s[32:35], s61 offen lds
    s_add_u32 m0, s55, 82944
    s_add_u32 s69, s69, 1024
    buffer_load_dwordx4 v1, s[36:39], s69 offen lds
    s_add_u32 s6, s5, 1
    s_cmp_eq_u32 s6, 18
    s_cselect_b32 s6, 0, s6
    s_mul_i32 s61, s6, 294912
    s_add_u32 m0, s55, 16384
    s_add_u32 s61, s61, s56
    buffer_load_dwordx4 v2, s[32:35], s61 offen lds
    s_lshl_b32 s69, s6, 11
    s_add_u32 m0, s55, 90112
    s_add_u32 s69, s69, s70
    buffer_load_dwordx4 v1, s[36:39], s69 offen lds
    s_add_u32 m0, s55, 17408
    s_nop 0
    buffer_load_dwordx4 v3, s[32:35], s61 offen lds
    s_add_u32 m0, s55, 91136
    s_add_u32 s69, s69, 1024
    buffer_load_dwordx4 v1, s[36:39], s69 offen lds
    s_add_u32 s7, s6, 1
    s_cmp_eq_u32 s7, 18
    s_cselect_b32 s7, 0, s7
    s_mul_i32 s61, s7, 294912
    s_add_u32 m0, s55, 24576
    s_add_u32 s61, s61, s56
    buffer_load_dwordx4 v2, s[32:35], s61 offen lds
    s_lshl_b32 s69, s7, 11
    s_add_u32 m0, s55, 98304
    s_add_u32 s69, s69, s70
    buffer_load_dwordx4 v1, s[36:39], s69 offen lds
    s_add_u32 m0, s55, 25600
    s_nop 0
    buffer_load_dwordx4 v3, s[32:35], s61 offen lds
    s_add_u32 m0, s55, 99328
    s_add_u32 s69, s69, 1024
    buffer_load_dwordx4 v1, s[36:39], s69 offen lds
    s_add_u32 s8, s7, 1
    s_cmp_eq_u32 s8, 18
    s_cselect_b32 s8, 0, s8
    s_mul_i32 s61, s8, 294912
    s_add_u32 m0, s55, 32768
    s_add_u32 s61, s61, s56
    buffer_load_dwordx4 v2, s[32:35], s61 offen lds
    s_lshl_b32 s69, s8, 11
    s_add_u32 m0, s55, 106496
    s_add_u32 s69, s69, s70
    buffer_load_dwordx4 v1, s[36:39], s69 offen lds
    s_add_u32 m0, s55, 33792
    s_nop 0
    buffer_load_dwordx4 v3, s[32:35], s61 offen lds
    s_add_u32 m0, s55, 107520
    s_add_u32 s69, s69, 1024
    buffer_load_dwordx4 v1, s[36:39], s69 offen lds
    s_add_u32 s9, s8, 1
    s_cmp_eq_u32 s9, 18
    s_cselect_b32 s9, 0, s9
    s_mul_i32 s61, s9, 294912
    s_add_u32 m0, s55, 40960
    s_add_u32 s61, s61, s56
    buffer_load_dwordx4 v2, s[32:35], s61 offen lds
    s_lshl_b32 s69, s9, 11
    s_add_u32 m0, s55, 114688
    s_add_u32 s69, s69, s70
    buffer_load_dwordx4 v1, s[36:39], s69 offen lds
    s_add_u32 m0, s55, 41984
    s_nop 0
    buffer_load_dwordx4 v3, s[32:35], s61 offen lds
    s_add_u32 m0, s55, 115712
    s_add_u32 s69, s69, 1024
    buffer_load_dwordx4 v1, s[36:39], s69 offen lds
    s_add_u32 s10, s9, 1
    s_cmp_eq_u32 s10, 18
    s_cselect_b32 s10, 0, s10
    s_mul_i32 s61, s10, 294912
    s_add_u32 m0, s55, 49152
    s_add_u32 s61, s61, s56
    buffer_load_dwordx4 v2, s[32:35], s61 offen lds
    s_lshl_b32 s69, s10, 11
    s_add_u32 m0, s55, 122880
    s_add_u32 s69, s69, s70
    buffer_load_dwordx4 v1, s[36:39], s69 offen lds
    s_add_u32 m0, s55, 50176
    s_nop 0
    buffer_load_dwordx4 v3, s[32:35], s61 offen lds
    s_add_u32 m0, s55, 123904
    s_add_u32 s69, s69, 1024
    buffer_load_dwordx4 v1, s[36:39], s69 offen lds
    s_add_u32 s11, s10, 1
    s_cmp_eq_u32 s11, 18
    s_cselect_b32 s11, 0, s11
    s_mul_i32 s61, s11, 294912
    s_add_u32 m0, s55, 57344
    s_add_u32 s61, s61, s56
    buffer_load_dwordx4 v2, s[32:35], s61 offen lds
    s_lshl_b32 s69, s11, 11
    s_add_u32 m0, s55, 131072
    s_add_u32 s69, s69, s70
    buffer_load_dwordx4 v1, s[36:39], s69 offen lds
    s_add_u32 m0, s55, 58368
    s_nop 0
    buffer_load_dwordx4 v3, s[32:35], s61 offen lds
    s_add_u32 m0, s55, 132096
    s_add_u32 s69, s69, 1024
    buffer_load_dwordx4 v1, s[36:39], s69 offen lds
    v_bfe_u32 v200, v248, 4, 1
    v_bfe_u32 v201, v248, 5, 1
    v_bfe_u32 v203, v248, 2, 2
    v_and_b32 v204, 3, v248
    v_lshlrev_b32 v205, 12, v200
    v_lshl_add_u32 v206, v201, 3, v203
    v_lshl_add_u32 v205, v206, 7, v205
    v_lshl_add_u32 v205, v204, 3, v205
    v_lshrrev_b32 v206, 1, v203
    v_lshl_or_b32 v206, v200, 1, v206
    s_lshl_b32 s87, s50, 1
    v_xor_b32 v204, s87, v206
    v_lshl_add_u32 v6, v204, 5, v205
    v_xor_b32 v204, 1, v204
    v_lshl_add_u32 v7, v204, 5, v205
    v_add_u32 v8, 49152, v6
    v_add_u32 v9, 49152, v7
    s_lshl_b32 s87, s49, 12
    s_add_u32 s87, s87, 73728
    v_add_u32 v229, s87, v1
    v_add_u32 v13, 49152, v229
    s_add_u32 s12, s11, 1
    s_cmp_eq_u32 s12, 18
    s_cselect_b32 s12, 0, s12
    s_add_u32 s13, s12, 1
    s_cmp_eq_u32 s13, 18
    s_cselect_b32 s13, 0, s13
    s_add_u32 s14, s13, 1
    s_cmp_eq_u32 s14, 18
    s_cselect_b32 s14, 0, s14
    s_add_u32 s15, s14, 1
    s_cmp_eq_u32 s15, 18
    s_cselect_b32 s15, 0, s15
    s_add_u32 s16, s15, 1
    s_cmp_eq_u32 s16, 18
    s_cselect_b32 s16, 0, s16
    s_add_u32 s17, s16, 1
    s_cmp_eq_u32 s17, 18
    s_cselect_b32 s17, 0, s17
    s_add_u32 s18, s17, 1
    s_cmp_eq_u32 s18, 18
    s_cselect_b32 s18, 0, s18
    s_add_u32 s19, s18, 1
    s_cmp_eq_u32 s19, 18
    s_cselect_b32 s19, 0, s19
    s_add_u32 s20, s19, 1
    s_cmp_eq_u32 s20, 18
    s_cselect_b32 s20, 0, s20
    s_add_u32 s21, s20, 1
    s_cmp_eq_u32 s21, 18
    s_cselect_b32 s21, 0, s21
    s_waitcnt vmcnt(24)
    s_barrier
    ds_read_b64_tr_b16 v[176:177], v6 offset:0
    ds_read_b64_tr_b16 v[178:179], v6 offset:512
    ds_read_b64_tr_b16 v[180:181], v7 offset:0
    ds_read_b64_tr_b16 v[182:183], v7 offset:512
    ds_read_b128 a[0:3], v229 offset:0
    ds_read_b128 a[4:7], v229 offset:2048
    ds_read_b64_tr_b16 v[184:185], v6 offset:2048
    ds_read_b64_tr_b16 v[186:187], v6 offset:2560
    ds_read_b64_tr_b16 v[188:189], v7 offset:2048
    ds_read_b64_tr_b16 v[190:191], v7 offset:2560
    ds_read_b128 a[8:11], v229 offset:1024
    ds_read_b128 a[12:15], v229 offset:3072
    s_waitcnt lgkmcnt(6)
    v_mfma_f32_32x32x16_bf16 v[16:31], v[176:179], a[0:3], 0
    ds_read_b64_tr_b16 v[192:193], v6 offset:8192
    v_mfma_f32_32x32x16_bf16 v[32:47], v[176:179], a[4:7], 0
    ds_read_b64_tr_b16 v[194:195], v6 offset:8704
    ds_read_b64_tr_b16 v[196:197], v7 offset:8192
    v_mfma_f32_32x32x16_bf16 v[48:63], v[180:183], a[0:3], 0
    ds_read_b64_tr_b16 v[198:199], v7 offset:8704
    s_and_b32 s22, s52, 1
    v_mfma_f32_32x32x16_bf16 v[64:79], v[180:183], a[4:7], 0
    ds_read_b128 a[16:19], v229 offset:8192
    ds_read_b128 a[20:23], v229 offset:10240
    s_mul_i32 s87, s52, 288
    s_waitcnt lgkmcnt(6)
    v_mfma_f32_32x32x16_bf16 v[16:31], v[184:187], a[8:11], v[16:31]
    ds_read_b64_tr_b16 v[176:177], v6 offset:10240
    s_cmp_eq_u32 s22, 0
    s_cselect_b32 s54, 256, 0
    v_mfma_f32_32x32x16_bf16 v[32:47], v[184:187], a[12:15], v[32:47]
    ds_read_b64_tr_b16 v[178:179], v6 offset:10752
    ds_read_b64_tr_b16 v[180:181], v7 offset:10240
    s_add_u32 s54, s54, s87
    v_mfma_f32_32x32x16_bf16 v[48:63], v[188:191], a[8:11], v[48:63]
    ds_read_b64_tr_b16 v[182:183], v7 offset:10752
    s_add_u32 s57, s56, 128
    v_mfma_f32_32x32x16_bf16 v[64:79], v[188:191], a[12:15], v[64:79]
    ds_read_b128 a[24:27], v229 offset:9216
    ds_read_b128 a[28:31], v229 offset:11264
    s_add_u32 s58, s56, 256
    s_waitcnt lgkmcnt(6)
    v_mfma_f32_32x32x16_bf16 v[16:31], v[192:195], a[16:19], v[16:31]
    s_waitcnt vmcnt(16)
    s_barrier
    ds_read_b64_tr_b16 v[184:185], v6 offset:16384
    s_add_u32 s59, s56, 384
    v_mfma_f32_32x32x16_bf16 v[32:47], v[192:195], a[20:23], v[32:47]
    ds_read_b64_tr_b16 v[186:187], v6 offset:16896
    ds_read_b64_tr_b16 v[188:189], v7 offset:16384
    s_mul_i32 s61, s12, 294912
    s_add_u32 m0, s55, 65536
    s_add_u32 s61, s61, s56
    buffer_load_dwordx4 v2, s[32:35], s61 offen lds
    s_lshl_b32 s60, s22, 5
    v_mfma_f32_32x32x16_bf16 v[48:63], v[196:199], a[16:19], v[48:63]
    ds_read_b64_tr_b16 v[190:191], v7 offset:16896
    s_lshl_b32 s69, s12, 11
    s_add_u32 m0, s55, 139264
    s_add_u32 s69, s69, s70
    buffer_load_dwordx4 v1, s[36:39], s69 offen lds
    s_sub_u32 s60, s54, s60
    v_mfma_f32_32x32x16_bf16 v[64:79], v[196:199], a[20:23], v[64:79]
    ds_read_b128 a[32:35], v229 offset:16384
    ds_read_b128 a[36:39], v229 offset:18432
    s_add_u32 m0, s55, 66560
    s_lshl_b32 s60, s60, 1
    buffer_load_dwordx4 v3, s[32:35], s61 offen lds
    s_waitcnt lgkmcnt(6)
    v_mfma_f32_32x32x16_bf16 v[16:31], v[176:179], a[24:27], v[16:31]
    ds_read_b64_tr_b16 v[192:193], v6 offset:18432
    s_add_u32 m0, s55, 140288
    s_add_u32 s69, s69, 1024
    buffer_load_dwordx4 v1, s[36:39], s69 offen lds
    v_mfma_f32_32x32x16_bf16 v[32:47], v[176:179], a[28:31], v[32:47]
    ds_read_b64_tr_b16 v[194:195], v6 offset:18944
    ds_read_b64_tr_b16 v[196:197], v7 offset:18432
    s_mul_i32 s61, s13, 294912
    s_add_u32 m0, s55, 0
    s_add_u32 s61, s61, s56
    buffer_load_dwordx4 v2, s[32:35], s61 offen lds
    s_mov_b32 s64, 0xbdd2d3e8
    v_mfma_f32_32x32x16_bf16 v[48:63], v[180:183], a[24:27], v[48:63]
    ds_read_b64_tr_b16 v[198:199], v7 offset:18944
    s_lshl_b32 s69, s13, 11
    s_add_u32 m0, s55, 73728
    s_add_u32 s69, s69, s70
    buffer_load_dwordx4 v1, s[36:39], s69 offen lds
    v_mov_b32 v14, 0xc0135761
    v_mfma_f32_32x32x16_bf16 v[64:79], v[180:183], a[28:31], v[64:79]
    ds_read_b128 a[40:43], v229 offset:17408
    ds_read_b128 a[44:47], v229 offset:19456
    s_add_u32 m0, s55, 1024
    v_lshrrev_b32 v207, 2, v248
    buffer_load_dwordx4 v3, s[32:35], s61 offen lds
    s_waitcnt lgkmcnt(6)
    v_mfma_f32_32x32x16_bf16 v[16:31], v[184:187], a[32:35], v[16:31]
    ds_read_b64_tr_b16 v[176:177], v6 offset:24576
    s_add_u32 m0, s55, 74752
    s_add_u32 s69, s69, 1024
    buffer_load_dwordx4 v1, s[36:39], s69 offen lds
    s_lshl_b32 s87, s50, 4
    v_mfma_f32_32x32x16_bf16 v[32:47], v[184:187], a[36:39], v[32:47]
    ds_read_b64_tr_b16 v[178:179], v6 offset:25088
    ds_read_b64_tr_b16 v[180:181], v7 offset:24576
    v_add_u32 v207, s87, v207
    v_mfma_f32_32x32x16_bf16 v[48:63], v[188:191], a[32:35], v[48:63]
    ds_read_b64_tr_b16 v[182:183], v7 offset:25088
    v_mul_u32_u24 v207, 9216, v207
    v_mfma_f32_32x32x16_bf16 v[64:79], v[188:191], a[36:39], v[64:79]
    ds_read_b128 a[48:51], v229 offset:24576
    ds_read_b128 a[52:55], v229 offset:26624
    v_bfe_u32 v208, v248, 1, 1
    s_waitcnt lgkmcnt(6)
    v_mfma_f32_32x32x16_bf16 v[16:31], v[192:195], a[40:43], v[16:31]
    ds_read_b64_tr_b16 v[184:185], v6 offset:26624
    v_xor_b32 v208, s49, v208
    v_mfma_f32_32x32x16_bf16 v[32:47], v[192:195], a[44:47], v[32:47]
    ds_read_b64_tr_b16 v[186:187], v6 offset:27136
    ds_read_b64_tr_b16 v[188:189], v7 offset:26624
    s_lshl_b32 s87, s22, 1
    v_mfma_f32_32x32x16_bf16 v[48:63], v[196:199], a[40:43], v[48:63]
    ds_read_b64_tr_b16 v[190:191], v7 offset:27136
    v_mfma_f32_32x32x16_bf16 v[64:79], v[196:199], a[44:47], v[64:79]
    ds_read_b128 a[56:59], v229 offset:25600
    ds_read_b128 a[60:63], v229 offset:27648
    v_add_u32 v208, s87, v208
    s_waitcnt lgkmcnt(6)
    v_mfma_f32_32x32x16_bf16 v[16:31], v[176:179], a[48:51], v[16:31]
    s_waitcnt vmcnt(16)
    s_barrier
    ds_read_b64_tr_b16 v[192:193], v6 offset:32768
    v_lshl_add_u32 v207, v208, 5, v207
    v_mfma_f32_32x32x16_bf16 v[32:47], v[176:179], a[52:55], v[32:47]
    ds_read_b64_tr_b16 v[194:195], v6 offset:33280
    ds_read_b64_tr_b16 v[196:197], v7 offset:32768
    s_mul_i32 s61, s14, 294912
    s_add_u32 m0, s55, 8192
    s_add_u32 s61, s61, s56
    buffer_load_dwordx4 v2, s[32:35], s61 offen lds
    v_and_b32 v208, 1, v248
    v_mfma_f32_32x32x16_bf16 v[48:63], v[180:183], a[48:51], v[48:63]
    ds_read_b64_tr_b16 v[198:199], v7 offset:33280
    s_lshl_b32 s69, s14, 11
    s_add_u32 m0, s55, 81920
    s_add_u32 s69, s69, s70
    buffer_load_dwordx4 v1, s[36:39], s69 offen lds
    v_lshl_add_u32 v4, v208, 4, v207
    v_mfma_f32_32x32x16_bf16 v[64:79], v[180:183], a[52:55], v[64:79]
    ds_read_b128 a[64:67], v229 offset:32768
    ds_read_b128 a[68:71], v229 offset:34816
    s_add_u32 m0, s55, 9216
    v_bfe_u32 v207, v248, 4, 1
    buffer_load_dwordx4 v3, s[32:35], s61 offen lds
    s_waitcnt lgkmcnt(6)
    v_mfma_f32_32x32x16_bf16 v[16:31], v[184:187], a[56:59], v[16:31]
    ds_read_b64_tr_b16 v[176:177], v6 offset:34816
    s_add_u32 m0, s55, 82944
    s_add_u32 s69, s69, 1024
    buffer_load_dwordx4 v1, s[36:39], s69 offen lds
    v_bfe_u32 v208, v248, 5, 1
    v_mfma_f32_32x32x16_bf16 v[32:47], v[184:187], a[60:63], v[32:47]
    ds_read_b64_tr_b16 v[178:179], v6 offset:35328
    ds_read_b64_tr_b16 v[180:181], v7 offset:34816
    s_mul_i32 s61, s15, 294912
    s_add_u32 m0, s55, 16384
    s_add_u32 s61, s61, s56
    buffer_load_dwordx4 v2, s[32:35], s61 offen lds
    v_bfe_u32 v209, v248, 2, 2
    v_mfma_f32_32x32x16_bf16 v[48:63], v[188:191], a[56:59], v[48:63]
    ds_read_b64_tr_b16 v[182:183], v7 offset:35328
    s_lshl_b32 s69, s15, 11
    s_add_u32 m0, s55, 90112
    s_add_u32 s69, s69, s70
    buffer_load_dwordx4 v1, s[36:39], s69 offen lds
    v_lshl_add_u32 v208, v208, 3, v209
    v_mfma_f32_32x32x16_bf16 v[64:79], v[188:191], a[60:63], v[64:79]
    ds_read_b128 a[72:75], v229 offset:33792
    ds_read_b128 a[76:79], v229 offset:35840
    s_add_u32 m0, s55, 17408
    v_lshlrev_b32 v208, 6, v208
    buffer_load_dwordx4 v3, s[32:35], s61 offen lds
    s_waitcnt lgkmcnt(6)
    v_mfma_f32_32x32x16_bf16 v[16:31], v[192:195], a[64:67], v[16:31]
    ds_read_b64_tr_b16 v[184:185], v6 offset:40960
    s_add_u32 m0, s55, 91136
    s_add_u32 s69, s69, 1024
    buffer_load_dwordx4 v1, s[36:39], s69 offen lds
    v_mfma_f32_32x32x16_bf16 v[32:47], v[192:195], a[68:71], v[32:47]
    ds_read_b64_tr_b16 v[186:187], v6 offset:41472
    ds_read_b64_tr_b16 v[188:189], v7 offset:40960
    v_lshl_add_u32 v208, v207, 11, v208
    v_mfma_f32_32x32x16_bf16 v[48:63], v[196:199], a[64:67], v[48:63]
    ds_read_b64_tr_b16 v[190:191], v7 offset:41472
    v_xor_b32 v207, s50, v207
    v_mfma_f32_32x32x16_bf16 v[64:79], v[196:199], a[68:71], v[64:79]
    ds_read_b128 a[80:83], v229 offset:40960
    ds_read_b128 a[84:87], v229 offset:43008
    v_lshl_add_u32 v208, v207, 5, v208
    s_waitcnt lgkmcnt(6)
    v_mfma_f32_32x32x16_bf16 v[16:31], v[176:179], a[72:75], v[16:31]
    ds_read_b64_tr_b16 v[192:193], v6 offset:43008
    v_and_b32 v207, 3, v248
    v_mfma_f32_32x32x16_bf16 v[32:47], v[176:179], a[76:79], v[32:47]
    ds_read_b64_tr_b16 v[194:195], v6 offset:43520
    ds_read_b64_tr_b16 v[196:197], v7 offset:43008
    v_lshl_add_u32 v10, v207, 3, v208
    v_mfma_f32_32x32x16_bf16 v[48:63], v[180:183], a[72:75], v[48:63]
    ds_read_b64_tr_b16 v[198:199], v7 offset:43520
    v_add_u32 v11, 49152, v10
    v_mfma_f32_32x32x16_bf16 v[64:79], v[180:183], a[76:79], v[64:79]
    ds_read_b128 a[88:91], v229 offset:41984
    ds_read_b128 a[92:95], v229 offset:44032
    s_mul_i32 s87, s49, 36
    s_waitcnt lgkmcnt(6)
    v_mfma_f32_32x32x16_bf16 v[16:31], v[184:187], a[80:83], v[16:31]
    s_waitcnt vmcnt(16)
    s_barrier
    ds_read_b64_tr_b16 v[176:177], v8 offset:0
    s_lshl_b32 s22, s50, 1
    v_mfma_f32_32x32x16_bf16 v[32:47], v[184:187], a[84:87], v[32:47]
    ds_read_b64_tr_b16 v[178:179], v8 offset:512
    ds_read_b64_tr_b16 v[180:181], v9 offset:0
    s_mul_i32 s61, s16, 294912
    s_add_u32 m0, s55, 24576
    s_add_u32 s61, s61, s56
    buffer_load_dwordx4 v2, s[32:35], s61 offen lds
    s_add_u32 s22, s22, s87
    v_mfma_f32_32x32x16_bf16 v[48:63], v[188:191], a[80:83], v[48:63]
    ds_read_b64_tr_b16 v[182:183], v9 offset:512
    s_lshl_b32 s69, s16, 11
    s_add_u32 m0, s55, 98304
    s_add_u32 s69, s69, s70
    buffer_load_dwordx4 v1, s[36:39], s69 offen lds
    s_lshl_b32 s22, s22, 10
    v_mfma_f32_32x32x16_bf16 v[64:79], v[188:191], a[84:87], v[64:79]
    ds_read_b128 a[96:99], v13 offset:0
    ds_read_b128 a[100:103], v13 offset:2048
    s_add_u32 m0, s55, 25600
    s_add_u32 s22, s22, 73728
    buffer_load_dwordx4 v3, s[32:35], s61 offen lds
    s_waitcnt lgkmcnt(6)
    v_mfma_f32_32x32x16_bf16 v[16:31], v[192:195], a[88:91], v[16:31]
    ds_read_b64_tr_b16 v[184:185], v8 offset:2048
    s_add_u32 m0, s55, 99328
    s_add_u32 s69, s69, 1024
    buffer_load_dwordx4 v1, s[36:39], s69 offen lds
    v_mfma_f32_32x32x16_bf16 v[32:47], v[192:195], a[92:95], v[32:47]
    ds_read_b64_tr_b16 v[186:187], v8 offset:2560
    ds_read_b64_tr_b16 v[188:189], v9 offset:2048
    s_mul_i32 s61, s17, 294912
    s_add_u32 m0, s55, 32768
    s_add_u32 s61, s61, s56
    buffer_load_dwordx4 v2, s[32:35], s61 offen lds
    v_add_u32 v12, s22, v1
    v_mfma_f32_32x32x16_bf16 v[48:63], v[196:199], a[88:91], v[48:63]
    ds_read_b64_tr_b16 v[190:191], v9 offset:2560
    s_lshl_b32 s69, s17, 11
    s_add_u32 m0, s55, 106496
    s_add_u32 s69, s69, s70
    buffer_load_dwordx4 v1, s[36:39], s69 offen lds
    v_lshrrev_b32 v207, 3, v248
    v_mfma_f32_32x32x16_bf16 v[64:79], v[196:199], a[92:95], v[64:79]
    ds_read_b128 a[104:107], v13 offset:1024
    ds_read_b128 a[108:111], v13 offset:3072
    s_add_u32 m0, s55, 33792
    s_lshl_b32 s87, s48, 3
    buffer_load_dwordx4 v3, s[32:35], s61 offen lds
    s_waitcnt lgkmcnt(6)
    v_mfma_f32_32x32x16_bf16 v[16:31], v[176:179], a[96:99], v[16:31]
    ds_read_b64_tr_b16 v[192:193], v8 offset:8192
    s_add_u32 m0, s55, 107520
    s_add_u32 s69, s69, 1024
    buffer_load_dwordx4 v1, s[36:39], s69 offen lds
    v_add_u32 v207, s87, v207
    v_mfma_f32_32x32x16_bf16 v[32:47], v[176:179], a[100:103], v[32:47]
    ds_read_b64_tr_b16 v[194:195], v8 offset:8704
    ds_read_b64_tr_b16 v[196:197], v9 offset:8192
    v_mul_u32_u24 v207, 1152, v207
    v_mfma_f32_32x32x16_bf16 v[48:63], v[180:183], a[96:99], v[48:63]
    ds_read_b64_tr_b16 v[198:199], v9 offset:8704
    v_bfe_u32 v208, v248, 4, 1
    v_mfma_f32_32x32x16_bf16 v[64:79], v[180:183], a[100:103], v[64:79]
    ds_read_b128 a[112:115], v13 offset:8192
    ds_read_b128 a[116:119], v13 offset:10240
    v_lshlrev_b32 v208, 1, v208
    s_waitcnt lgkmcnt(6)
    v_mfma_f32_32x32x16_bf16 v[16:31], v[184:187], a[104:107], v[16:31]
    ds_read_b64_tr_b16 v[176:177], v8 offset:10240
    v_bfe_u32 v209, v248, 1, 2
    v_mfma_f32_32x32x16_bf16 v[32:47], v[184:187], a[108:111], v[32:47]
    ds_read_b64_tr_b16 v[178:179], v8 offset:10752
    ds_read_b64_tr_b16 v[180:181], v9 offset:10240
    v_mfma_f32_32x32x16_bf16 v[48:63], v[188:191], a[104:107], v[48:63]
    ds_read_b64_tr_b16 v[182:183], v9 offset:10752
    v_xor_b32 v209, v209, v208
    v_mfma_f32_32x32x16_bf16 v[64:79], v[188:191], a[108:111], v[64:79]
    ds_read_b128 a[120:123], v13 offset:9216
    ds_read_b128 a[124:127], v13 offset:11264
    v_and_b32 v210, 1, v248
    s_waitcnt lgkmcnt(6)
    v_mfma_f32_32x32x16_bf16 v[16:31], v[192:195], a[112:115], v[16:31]
    s_waitcnt vmcnt(16)
    s_barrier
    ds_read_b64_tr_b16 v[184:185], v8 offset:16384
    v_lshlrev_b32 v210, 4, v210
    v_mfma_f32_32x32x16_bf16 v[32:47], v[192:195], a[116:119], v[32:47]
    ds_read_b64_tr_b16 v[186:187], v8 offset:16896
    ds_read_b64_tr_b16 v[188:189], v9 offset:16384
    s_mul_i32 s61, s18, 294912
    s_add_u32 m0, s55, 40960
    s_add_u32 s61, s61, s56
    buffer_load_dwordx4 v2, s[32:35], s61 offen lds
    v_lshl_add_u32 v210, v209, 5, v210
    v_mfma_f32_32x32x16_bf16 v[48:63], v[196:199], a[112:115], v[48:63]
    ds_read_b64_tr_b16 v[190:191], v9 offset:16896
    v_add_u32 v224, v207, v210
    v_mfma_f32_32x32x16_bf16 v[64:79], v[196:199], a[116:119], v[64:79]
    ds_read_b128 a[128:131], v13 offset:16384
    ds_read_b128 a[132:135], v13 offset:18432
    s_lshl_b32 s69, s18, 11
    s_add_u32 m0, s55, 114688
    s_add_u32 s69, s69, s70
    buffer_load_dwordx4 v1, s[36:39], s69 offen lds
    v_bfe_u32 v207, v248, 4, 1
    s_waitcnt lgkmcnt(6)
    v_mfma_f32_32x32x16_bf16 v[16:31], v[176:179], a[120:123], v[16:31]
    ds_read_b64_tr_b16 v[192:193], v8 offset:18432
    v_bfe_u32 v208, v248, 5, 1
    v_mfma_f32_32x32x16_bf16 v[32:47], v[176:179], a[124:127], v[32:47]
    ds_read_b64_tr_b16 v[194:195], v8 offset:18944
    ds_read_b64_tr_b16 v[196:197], v9 offset:18432
    s_add_u32 m0, s55, 41984
    v_bfe_u32 v209, v248, 2, 2
    buffer_load_dwordx4 v3, s[32:35], s61 offen lds
    v_mfma_f32_32x32x16_bf16 v[48:63], v[180:183], a[120:123], v[48:63]
    ds_read_b64_tr_b16 v[198:199], v9 offset:18944
    v_and_b32 v210, 3, v248
    v_mfma_f32_32x32x16_bf16 v[64:79], v[180:183], a[124:127], v[64:79]
    ds_read_b128 a[136:139], v13 offset:17408
    ds_read_b128 a[140:143], v13 offset:19456
    s_add_u32 m0, s55, 115712
    s_add_u32 s69, s69, 1024
    buffer_load_dwordx4 v1, s[36:39], s69 offen lds
    s_waitcnt lgkmcnt(6)
    v_mfma_f32_32x32x16_bf16 v[16:31], v[184:187], a[128:131], v[16:31]
    ds_read_b64_tr_b16 v[176:177], v6 offset:0
    v_lshl_add_u32 v211, v208, 2, v209
    v_mfma_f32_32x32x16_bf16 v[32:47], v[184:187], a[132:135], v[32:47]
    ds_read_b64_tr_b16 v[178:179], v6 offset:512
    ds_read_b64_tr_b16 v[180:181], v7 offset:0
    s_mul_i32 s61, s19, 294912
    s_add_u32 m0, s55, 49152
    s_add_u32 s61, s61, s56
    buffer_load_dwordx4 v2, s[32:35], s61 offen lds
    v_lshlrev_b32 v211, 7, v211
    v_mfma_f32_32x32x16_bf16 v[48:63], v[188:191], a[128:131], v[48:63]
    ds_read_b64_tr_b16 v[182:183], v7 offset:512
    v_lshl_add_u32 v211, v210, 3, v211
    v_mfma_f32_32x32x16_bf16 v[64:79], v[188:191], a[132:135], v[64:79]
    ds_read_b128 a[144:147], v229 offset:0
    ds_read_b128 a[148:151], v229 offset:2048
    s_lshl_b32 s69, s19, 11
    s_add_u32 m0, s55, 122880
    s_add_u32 s69, s69, s70
    buffer_load_dwordx4 v1, s[36:39], s69 offen lds
    v_and_b32 v209, 2, v209
    s_waitcnt lgkmcnt(6)
    v_mfma_f32_32x32x16_bf16 v[16:31], v[192:195], a[136:139], v[16:31]
    ds_read_b64_tr_b16 v[184:185], v6 offset:2048
    s_lshl_b32 s87, s50, 1
    v_mfma_f32_32x32x16_bf16 v[32:47], v[192:195], a[140:143], v[32:47]
    ds_read_b64_tr_b16 v[186:187], v6 offset:2560
    ds_read_b64_tr_b16 v[188:189], v7 offset:2048
    s_add_u32 m0, s55, 50176
    v_or_b32 v207, s87, v207
    buffer_load_dwordx4 v3, s[32:35], s61 offen lds
    v_mfma_f32_32x32x16_bf16 v[48:63], v[196:199], a[136:139], v[48:63]
    ds_read_b64_tr_b16 v[190:191], v7 offset:2560
    v_xor_b32 v207, v207, v209
    v_mfma_f32_32x32x16_bf16 v[64:79], v[196:199], a[140:143], v[64:79]
    ds_read_b128 a[152:155], v229 offset:1024
    ds_read_b128 a[156:159], v229 offset:3072
    s_add_u32 m0, s55, 123904
    s_add_u32 s69, s69, 1024
    buffer_load_dwordx4 v1, s[36:39], s69 offen lds
    v_lshl_add_u32 v225, v207, 5, v211
    s_waitcnt lgkmcnt(6)
    v_mfma_f32_32x32x16_bf16 v[16:31], v[176:179], a[144:147], v[16:31]
    s_waitcnt vmcnt(16)
    s_barrier
    ds_read_b64_tr_b16 v[192:193], v6 offset:8192
    v_add_u32 v226, 36864, v225
    v_mfma_f32_32x32x16_bf16 v[32:47], v[176:179], a[148:151], v[32:47]
    ds_read_b64_tr_b16 v[194:195], v6 offset:8704
    ds_read_b64_tr_b16 v[196:197], v7 offset:8192
    s_mul_i32 s61, s20, 294912
    s_add_u32 m0, s55, 57344
    s_add_u32 s61, s61, s56
    buffer_load_dwordx4 v2, s[32:35], s61 offen lds
    v_add_u32 v227, 73728, v225
    v_mfma_f32_32x32x16_bf16 v[48:63], v[180:183], a[144:147], v[48:63]
    ds_read_b64_tr_b16 v[198:199], v7 offset:8704
    v_mfma_f32_32x32x16_bf16 v[64:79], v[180:183], a[148:151], v[64:79]
    ds_read_b128 a[160:163], v229 offset:8192
    ds_read_b128 a[164:167], v229 offset:10240
    s_lshl_b32 s69, s20, 11
    s_add_u32 m0, s55, 131072
    s_add_u32 s69, s69, s70
    buffer_load_dwordx4 v1, s[36:39], s69 offen lds
    v_add_u32 v228, 110592, v225
    s_waitcnt lgkmcnt(6)
    v_mfma_f32_32x32x16_bf16 v[16:31], v[184:187], a[152:155], v[16:31]
    ds_read_b64_tr_b16 v[176:177], v6 offset:10240
    s_add_u32 s44, s26, 25165824
    s_addc_u32 s45, s27, 0
    v_mfma_f32_32x32x16_bf16 v[32:47], v[184:187], a[156:159], v[32:47]
    ds_read_b64_tr_b16 v[178:179], v6 offset:10752
    ds_read_b64_tr_b16 v[180:181], v7 offset:10240
    s_add_u32 m0, s55, 58368
    s_mov_b32 s46, 37748736
    buffer_load_dwordx4 v3, s[32:35], s61 offen lds
    v_mfma_f32_32x32x16_bf16 v[48:63], v[188:191], a[152:155], v[48:63]
    ds_read_b64_tr_b16 v[182:183], v7 offset:10752
    s_mov_b32 s47, 0x00020000
    v_mfma_f32_32x32x16_bf16 v[64:79], v[188:191], a[156:159], v[64:79]
    ds_read_b128 a[168:171], v229 offset:9216
    ds_read_b128 a[172:175], v229 offset:11264
    s_add_u32 m0, s55, 132096
    s_add_u32 s69, s69, 1024
    buffer_load_dwordx4 v1, s[36:39], s69 offen lds
    s_add_u32 s72, s26, 8388608
    s_addc_u32 s73, s27, 0
    s_waitcnt lgkmcnt(6)
    v_mfma_f32_32x32x16_bf16 v[16:31], v[192:195], a[160:163], v[16:31]
    ds_read_b64_tr_b16 v[184:185], v6 offset:16384
    s_mov_b32 s74, 1327104
    v_mfma_f32_32x32x16_bf16 v[32:47], v[192:195], a[164:167], v[32:47]
    ds_read_b64_tr_b16 v[186:187], v6 offset:16896
    ds_read_b64_tr_b16 v[188:189], v7 offset:16384
    s_mul_i32 s61, s21, 294912
    s_add_u32 m0, s55, 65536
    s_add_u32 s61, s61, s56
    buffer_load_dwordx4 v2, s[32:35], s61 offen lds
    s_mov_b32 s75, 0x00020000
    v_mfma_f32_32x32x16_bf16 v[48:63], v[196:199], a[160:163], v[48:63]
    ds_read_b64_tr_b16 v[190:191], v7 offset:16896
    s_add_u32 s76, s26, 4194304
    s_addc_u32 s77, s27, 0
    v_mfma_f32_32x32x16_bf16 v[64:79], v[196:199], a[164:167], v[64:79]
    ds_read_b128 a[176:179], v229 offset:16384
    ds_read_b128 a[180:183], v229 offset:18432
    s_lshl_b32 s69, s21, 11
    s_add_u32 m0, s55, 139264
    s_add_u32 s69, s69, s70
    buffer_load_dwordx4 v1, s[36:39], s69 offen lds
    s_mov_b32 s78, 2367488
    s_waitcnt lgkmcnt(6)
    v_mfma_f32_32x32x16_bf16 v[16:31], v[176:179], a[168:171], v[16:31]
    ds_read_b64_tr_b16 v[192:193], v6 offset:18432
    v_mfma_f32_32x32x16_bf16 v[32:47], v[176:179], a[172:175], v[32:47]
    ds_read_b64_tr_b16 v[194:195], v6 offset:18944
    ds_read_b64_tr_b16 v[196:197], v7 offset:18432
    s_add_u32 m0, s55, 66560
    s_mov_b32 s79, 0x00020000
    buffer_load_dwordx4 v3, s[32:35], s61 offen lds
    v_mfma_f32_32x32x16_bf16 v[48:63], v[180:183], a[168:171], v[48:63]
    ds_read_b64_tr_b16 v[198:199], v7 offset:18944
    s_add_u32 s96, s26, 10485760
    s_addc_u32 s97, s27, 0
    v_mfma_f32_32x32x16_bf16 v[64:79], v[180:183], a[172:175], v[64:79]
    ds_read_b128 a[184:187], v229 offset:17408
    ds_read_b128 a[188:191], v229 offset:19456
    s_add_u32 m0, s55, 140288
    s_add_u32 s69, s69, 1024
    buffer_load_dwordx4 v1, s[36:39], s69 offen lds
    s_mov_b32 s98, 1152
    s_waitcnt lgkmcnt(6)
    v_mfma_f32_32x32x16_bf16 v[16:31], v[184:187], a[176:179], v[16:31]
    s_waitcnt vmcnt(16)
    s_barrier
    ds_read_b64_tr_b16 v[176:177], v6 offset:24576
    s_mov_b32 s99, 0x00020000
    v_mfma_f32_32x32x16_bf16 v[32:47], v[184:187], a[180:183], v[32:47]
    ds_read_b64_tr_b16 v[178:179], v6 offset:25088
    ds_read_b64_tr_b16 v[180:181], v7 offset:24576
    s_mul_i32 s61, s4, 294912
    s_add_u32 m0, s55, 0
    s_add_u32 s61, s61, s57
    buffer_load_dwordx4 v2, s[32:35], s61 offen lds
    s_lshl_b32 s66, s48, 10
    v_mfma_f32_32x32x16_bf16 v[48:63], v[188:191], a[176:179], v[48:63]
    ds_read_b64_tr_b16 v[182:183], v7 offset:25088
    s_mul_i32 s65, s51, 2359296
    v_mfma_f32_32x32x16_bf16 v[64:79], v[188:191], a[180:183], v[64:79]
    ds_read_b128 a[192:195], v229 offset:24576
    ds_read_b128 a[196:199], v229 offset:26624
    s_add_u32 m0, s55, 1024
    s_lshl_b32 s87, s52, 10
    buffer_load_dwordx4 v3, s[32:35], s61 offen lds
    s_waitcnt lgkmcnt(6)
    v_mfma_f32_32x32x16_bf16 v[16:31], v[192:195], a[184:187], v[16:31]
    ds_read_b64_tr_b16 v[184:185], v6 offset:26624
    s_add_u32 s65, s65, s87
    v_mfma_f32_32x32x16_bf16 v[32:47], v[192:195], a[188:191], v[32:47]
    ds_read_b64_tr_b16 v[186:187], v6 offset:27136
    ds_read_b64_tr_b16 v[188:189], v7 offset:26624
    s_mul_i32 s61, s5, 294912
    s_add_u32 m0, s55, 8192
    s_add_u32 s61, s61, s57
    buffer_load_dwordx4 v2, s[32:35], s61 offen lds
    s_mul_i32 s87, s49, 36
    v_mfma_f32_32x32x16_bf16 v[48:63], v[196:199], a[184:187], v[48:63]
    ds_read_b64_tr_b16 v[190:191], v7 offset:27136
    v_mfma_f32_32x32x16_bf16 v[64:79], v[196:199], a[188:191], v[64:79]
    ds_read_b128 a[200:203], v229 offset:25600
    ds_read_b128 a[204:207], v229 offset:27648
    s_add_u32 m0, s55, 9216
    s_add_u32 s87, s87, s50
    buffer_load_dwordx4 v3, s[32:35], s61 offen lds
    s_waitcnt lgkmcnt(6)
    v_mfma_f32_32x32x16_bf16 v[16:31], v[176:179], a[192:195], v[16:31]
    ds_read_b64_tr_b16 v[192:193], v6 offset:32768
    s_lshl_b32 s87, s87, 15
    v_mfma_f32_32x32x16_bf16 v[32:47], v[176:179], a[196:199], v[32:47]
    ds_read_b64_tr_b16 v[194:195], v6 offset:33280
    ds_read_b64_tr_b16 v[196:197], v7 offset:32768
    s_add_u32 s65, s65, s87
    v_mfma_f32_32x32x16_bf16 v[48:63], v[180:183], a[192:195], v[48:63]
    ds_read_b64_tr_b16 v[198:199], v7 offset:33280
    s_mul_i32 s67, s53, 1152
    v_mfma_f32_32x32x16_bf16 v[64:79], v[180:183], a[196:199], v[64:79]
    ds_read_b128 a[208:211], v229 offset:32768
    ds_read_b128 a[212:215], v229 offset:34816
    s_mul_i32 s68, s54, 1152
    s_waitcnt lgkmcnt(6)
    v_mfma_f32_32x32x16_bf16 v[16:31], v[184:187], a[200:203], v[16:31]
    ds_read_b64_tr_b16 v[176:177], v6 offset:34816
    s_mul_i32 s83, s51, 9
    v_mfma_f32_32x32x16_bf16 v[32:47], v[184:187], a[204:207], v[32:47]
    ds_read_b64_tr_b16 v[178:179], v6 offset:35328
    ds_read_b64_tr_b16 v[180:181], v7 offset:34816
    s_lshr_b32 s83, s83, 4
    v_mfma_f32_32x32x16_bf16 v[48:63], v[188:191], a[200:203], v[48:63]
    ds_read_b64_tr_b16 v[182:183], v7 offset:35328
    s_lshl_b32 s87, s52, 1
    v_mfma_f32_32x32x16_bf16 v[64:79], v[188:191], a[204:207], v[64:79]
    ds_read_b128 a[216:219], v229 offset:33792
    ds_read_b128 a[220:223], v229 offset:35840
    s_add_u32 s87, s87, s50
    s_waitcnt lgkmcnt(6)
    v_mfma_f32_32x32x16_bf16 v[16:31], v[192:195], a[208:211], v[16:31]
    s_waitcnt vmcnt(12)
    s_barrier
    ds_read_b64_tr_b16 v[184:185], v6 offset:40960
    s_mul_i32 s80, s87, 73728
    v_mfma_f32_32x32x16_bf16 v[32:47], v[192:195], a[212:215], v[32:47]
    ds_read_b64_tr_b16 v[186:187], v6 offset:41472
    ds_read_b64_tr_b16 v[188:189], v7 offset:40960
    s_mul_i32 s61, s6, 294912
    s_add_u32 m0, s55, 16384
    s_add_u32 s61, s61, s57
    buffer_load_dwordx4 v2, s[32:35], s61 offen lds
    v_mfma_f32_32x32x16_bf16 v[48:63], v[196:199], a[208:211], v[48:63]
    ds_read_b64_tr_b16 v[190:191], v7 offset:41472
    s_lshl_b32 s22, s82, 11
    v_mfma_f32_32x32x16_bf16 v[64:79], v[196:199], a[212:215], v[64:79]
    ds_read_b128 a[224:227], v229 offset:40960
    ds_read_b128 a[228:231], v229 offset:43008
    s_add_u32 m0, s55, 17408
    s_add_u32 s80, s80, s22
    buffer_load_dwordx4 v3, s[32:35], s61 offen lds
    s_waitcnt lgkmcnt(6)
    v_mfma_f32_32x32x16_bf16 v[16:31], v[176:179], a[216:219], v[16:31]
    ds_read_b64_tr_b16 v[192:193], v6 offset:43008
    s_lshl_b32 s22, s87, 4
    v_mfma_f32_32x32x16_bf16 v[32:47], v[176:179], a[220:223], v[32:47]
    ds_read_b64_tr_b16 v[194:195], v6 offset:43520
    ds_read_b64_tr_b16 v[196:197], v7 offset:43008
    s_mul_i32 s61, s7, 294912
    s_add_u32 m0, s55, 24576
    s_add_u32 s61, s61, s57
    buffer_load_dwordx4 v2, s[32:35], s61 offen lds
    s_add_u32 s22, s22, s51
    v_mfma_f32_32x32x16_bf16 v[48:63], v[180:183], a[216:219], v[48:63]
    ds_read_b64_tr_b16 v[198:199], v7 offset:43520
    s_lshl_b32 s86, s22, 2
    v_mfma_f32_32x32x16_bf16 v[64:79], v[180:183], a[220:223], v[64:79]
    ds_read_b128 a[232:235], v229 offset:41984
    ds_read_b128 a[236:239], v229 offset:44032
    s_add_u32 m0, s55, 25600
    s_nop 0
    buffer_load_dwordx4 v3, s[32:35], s61 offen lds
    s_cmp_lg_u32 s49, 0
    s_cselect_b32 s86, 0x7ff00000, s86
    s_waitcnt lgkmcnt(6)
    v_mfma_f32_32x32x16_bf16 v[16:31], v[184:187], a[224:227], v[16:31]
    ds_read_b64_tr_b16 v[176:177], v8 offset:0
    s_cmp_ge_u32 s87, 9
    s_cselect_b32 s22, 9, 0
    s_cselect_b32 s81, 4096, 0
    v_mfma_f32_32x32x16_bf16 v[32:47], v[184:187], a[228:231], v[32:47]
    ds_read_b64_tr_b16 v[178:179], v8 offset:512
    ds_read_b64_tr_b16 v[180:181], v9 offset:0
    s_sub_u32 s87, s87, s22
    v_mfma_f32_32x32x16_bf16 v[48:63], v[188:191], a[224:227], v[48:63]
    ds_read_b64_tr_b16 v[182:183], v9 offset:512
    s_lshl_b32 s87, s87, 18
    v_mfma_f32_32x32x16_bf16 v[64:79], v[188:191], a[228:231], v[64:79]
    ds_read_b128 a[240:243], v13 offset:0
    ds_read_b128 a[244:247], v13 offset:2048
    s_waitcnt lgkmcnt(6)
    v_mfma_f32_32x32x16_bf16 v[16:31], v[192:195], a[232:235], v[16:31]
    ds_read_b64_tr_b16 v[184:185], v8 offset:2048
    s_add_u32 s81, s81, s87
    v_mfma_f32_32x32x16_bf16 v[32:47], v[192:195], a[236:239], v[32:47]
    ds_read_b64_tr_b16 v[186:187], v8 offset:2560
    ds_read_b64_tr_b16 v[188:189], v9 offset:2048
    s_lshl_b32 s87, s51, 8
    v_mfma_f32_32x32x16_bf16 v[48:63], v[196:199], a[232:235], v[48:63]
    ds_read_b64_tr_b16 v[190:191], v9 offset:2560
    s_add_u32 s81, s81, s87
    v_mfma_f32_32x32x16_bf16 v[64:79], v[196:199], a[236:239], v[64:79]
    ds_read_b128 a[248:251], v13 offset:1024
    ds_read_b128 a[252:255], v13 offset:3072
    s_lshl_b32 s87, s49, 7
    s_waitcnt lgkmcnt(6)
    v_mfma_f32_32x32x16_bf16 v[16:31], v[176:179], a[240:243], v[16:31]
    s_waitcnt vmcnt(8)
    s_barrier
    ds_read_b64_tr_b16 v[192:193], v8 offset:8192
    s_add_u32 s81, s81, s87
    v_mfma_f32_32x32x16_bf16 v[32:47], v[176:179], a[244:247], v[32:47]
    ds_read_b64_tr_b16 v[194:195], v8 offset:8704
    ds_read_b64_tr_b16 v[196:197], v9 offset:8192
    s_mul_i32 s61, s8, 294912
    s_add_u32 m0, s55, 32768
    s_add_u32 s61, s61, s57
    buffer_load_dwordx4 v2, s[32:35], s61 offen lds
    s_cmp_ge_u32 s52, 9
    s_cselect_b32 s81, 0x7ff00000, s81
    v_mfma_f32_32x32x16_bf16 v[48:63], v[180:183], a[240:243], v[48:63]
    ds_read_b64_tr_b16 v[198:199], v9 offset:8704
    s_lshl_b32 s87, s48, 12
    v_mfma_f32_32x32x16_bf16 v[64:79], v[180:183], a[244:247], v[64:79]
    ds_read_b128 v[144:147], v13 offset:8192
    ds_read_b128 v[148:151], v13 offset:10240
    s_add_u32 m0, s55, 33792
    s_add_u32 s87, s87, 147456
    buffer_load_dwordx4 v3, s[32:35], s61 offen lds
    s_waitcnt lgkmcnt(6)
    v_mfma_f32_32x32x16_bf16 v[16:31], v[184:187], a[248:251], v[16:31]
    ds_read_b64_tr_b16 v[176:177], v8 offset:10240
    v_and_b32 v207, 31, v248
    v_mfma_f32_32x32x16_bf16 v[32:47], v[184:187], a[252:255], v[32:47]
    ds_read_b64_tr_b16 v[178:179], v8 offset:10752
    ds_read_b64_tr_b16 v[180:181], v9 offset:10240
    s_mul_i32 s61, s9, 294912
    s_add_u32 m0, s55, 40960
    s_add_u32 s61, s61, s57
    buffer_load_dwordx4 v2, s[32:35], s61 offen lds
    v_mfma_f32_32x32x16_bf16 v[48:63], v[188:191], a[248:251], v[48:63]
    ds_read_b64_tr_b16 v[182:183], v9 offset:10752
    v_lshlrev_b32 v207, 7, v207
    v_mfma_f32_32x32x16_bf16 v[64:79], v[188:191], a[252:255], v[64:79]
    ds_read_b128 v[152:155], v13 offset:9216
    ds_read_b128 v[156:159], v13 offset:11264
    s_add_u32 m0, s55, 41984
    v_lshrrev_b32 v208, 5, v248
    buffer_load_dwordx4 v3, s[32:35], s61 offen lds
    s_waitcnt lgkmcnt(6)
    v_mfma_f32_32x32x16_bf16 v[16:31], v[192:195], v[144:147], v[16:31]
    ds_read_b64_tr_b16 v[184:185], v8 offset:16384
    v_lshl_add_u32 v207, v208, 4, v207
    v_mfma_f32_32x32x16_bf16 v[32:47], v[192:195], v[148:151], v[32:47]
    ds_read_b64_tr_b16 v[186:187], v8 offset:16896
    ds_read_b64_tr_b16 v[188:189], v9 offset:16384
    v_add_u32 v230, s87, v207
    v_mfma_f32_32x32x16_bf16 v[48:63], v[196:199], v[144:147], v[48:63]
    ds_read_b64_tr_b16 v[190:191], v9 offset:16896
    v_add_u32 v231, s87, v1
    v_mfma_f32_32x32x16_bf16 v[64:79], v[196:199], v[148:151], v[64:79]
    ds_read_b128 v[160:163], v13 offset:16384
    ds_read_b128 v[164:167], v13 offset:18432
    v_lshrrev_b32 v207, 3, v248
    s_waitcnt lgkmcnt(6)
    v_mfma_f32_32x32x16_bf16 v[16:31], v[176:179], v[152:155], v[16:31]
    ds_read_b64_tr_b16 v[192:193], v8 offset:18432
    v_lshlrev_b32 v207, 13, v207
    v_mfma_f32_32x32x16_bf16 v[32:47], v[176:179], v[156:159], v[32:47]
    ds_read_b64_tr_b16 v[194:195], v8 offset:18944
    ds_read_b64_tr_b16 v[196:197], v9 offset:18432
    v_and_b32 v208, 7, v248
    v_mfma_f32_32x32x16_bf16 v[48:63], v[180:183], v[152:155], v[48:63]
    ds_read_b64_tr_b16 v[198:199], v9 offset:18944
    v_lshl_add_u32 v254, v208, 4, v207
    v_mfma_f32_32x32x16_bf16 v[64:79], v[180:183], v[156:159], v[64:79]
    ds_read_b128 v[168:171], v13 offset:17408
    ds_read_b128 v[172:175], v13 offset:19456
    s_waitcnt lgkmcnt(6)
    v_mfma_f32_32x32x16_bf16 v[16:31], v[184:187], v[160:163], v[16:31]
    s_waitcnt vmcnt(8)
    s_barrier
    ds_read_b64_tr_b16 v[176:177], v6 offset:0
    v_mfma_f32_32x32x16_bf16 v[32:47], v[184:187], v[164:167], v[32:47]
    ds_read_b64_tr_b16 v[178:179], v6 offset:512
    s_mul_i32 s61, s10, 294912
    s_add_u32 m0, s55, 49152
    s_add_u32 s61, s61, s57
    buffer_load_dwordx4 v2, s[32:35], s61 offen lds
    v_mfma_f32_32x32x16_bf16 v[48:63], v[188:191], v[160:163], v[48:63]
    ds_read_b64_tr_b16 v[180:181], v7 offset:0
    v_mfma_f32_32x32x16_bf16 v[64:79], v[188:191], v[164:167], v[64:79]
    ds_read_b64_tr_b16 v[182:183], v7 offset:512
    s_add_u32 m0, s55, 50176
    s_nop 0
    buffer_load_dwordx4 v3, s[32:35], s61 offen lds
    s_waitcnt lgkmcnt(4)
    v_mfma_f32_32x32x16_bf16 v[16:31], v[192:195], v[168:171], v[16:31]
    ds_read_b64_tr_b16 v[184:185], v6 offset:2048
    v_mfma_f32_32x32x16_bf16 v[32:47], v[192:195], v[172:175], v[32:47]
    ds_read_b64_tr_b16 v[186:187], v6 offset:2560
    s_mul_i32 s61, s11, 294912
    s_add_u32 m0, s55, 57344
    s_add_u32 s61, s61, s57
    buffer_load_dwordx4 v2, s[32:35], s61 offen lds
    v_mfma_f32_32x32x16_bf16 v[48:63], v[196:199], v[168:171], v[48:63]
    ds_read_b64_tr_b16 v[188:189], v7 offset:2048
    v_mfma_f32_32x32x16_bf16 v[64:79], v[196:199], v[172:175], v[64:79]
    ds_read_b64_tr_b16 v[190:191], v7 offset:2560
    s_add_u32 m0, s55, 58368
    s_nop 0
    buffer_load_dwordx4 v3, s[32:35], s61 offen lds
    s_mul_i32 s87, s49, 36
    s_add_u32 s22, s87, 16
    s_add_u32 s22, s22, s50
    s_lshl_b32 s22, s22, 10
    s_add_u32 s22, s22, 73728
    v_add_u32 v13, s22, v1
    s_lshl_b32 s22, s87, 10
    s_add_u32 s22, s22, 73728
    v_add_u32 v229, s22, v1
    s_waitcnt lgkmcnt(4)
    v_mfma_f32_32x32x16_bf16 v[80:95], v[176:179], a[0:3], 0
    ds_read_b64_tr_b16 v[192:193], v6 offset:8192
    v_mfma_f32_32x32x16_bf16 v[96:111], v[176:179], a[4:7], 0
    ds_read_b64_tr_b16 v[194:195], v6 offset:8704
    v_mfma_f32_32x32x16_bf16 v[112:127], v[180:183], a[0:3], 0
    ds_read_b64_tr_b16 v[196:197], v7 offset:8192
    v_mfma_f32_32x32x16_bf16 v[128:143], v[180:183], a[4:7], 0
    ds_read_b64_tr_b16 v[198:199], v7 offset:8704
    s_waitcnt lgkmcnt(4)
    v_mfma_f32_32x32x16_bf16 v[80:95], v[184:187], a[8:11], v[80:95]
    ds_read_b64_tr_b16 v[176:177], v6 offset:10240
    v_mfma_f32_32x32x16_bf16 v[96:111], v[184:187], a[12:15], v[96:111]
    ds_read_b64_tr_b16 v[178:179], v6 offset:10752
    v_mfma_f32_32x32x16_bf16 v[112:127], v[188:191], a[8:11], v[112:127]
    ds_read_b64_tr_b16 v[180:181], v7 offset:10240
    v_mul_f32 v200, v16, v16
    v_mul_f32 v201, v17, v17
    v_mfma_f32_32x32x16_bf16 v[128:143], v[188:191], a[12:15], v[128:143]
    ds_read_b64_tr_b16 v[182:183], v7 offset:10752
    v_fma_f32 v200, v200, s64, v14
    v_fma_f32 v201, v201, s64, v14
    s_waitcnt lgkmcnt(4)
    v_mfma_f32_32x32x16_bf16 v[80:95], v[192:195], a[16:19], v[80:95]
    s_waitcnt vmcnt(8)
    s_barrier
    ds_read_b64_tr_b16 v[184:185], v6 offset:16384
    v_mul_f32 v200, v200, v16
    v_mul_f32 v201, v201, v17
    v_mfma_f32_32x32x16_bf16 v[96:111], v[192:195], a[20:23], v[96:111]
    ds_read_b64_tr_b16 v[186:187], v6 offset:16896
    s_mul_i32 s61, s12, 294912
    s_add_u32 m0, s55, 65536
    s_add_u32 s61, s61, s57
    buffer_load_dwordx4 v2, s[32:35], s61 offen lds
    v_exp_f32 v200, v200
    v_mfma_f32_32x32x16_bf16 v[112:127], v[196:199], a[16:19], v[112:127]
    ds_read_b64_tr_b16 v[188:189], v7 offset:16384
    v_exp_f32 v201, v201
    v_mul_f32 v202, v16, v24
    v_mul_f32 v203, v17, v25
    v_mfma_f32_32x32x16_bf16 v[128:143], v[196:199], a[20:23], v[128:143]
    ds_read_b64_tr_b16 v[190:191], v7 offset:16896
    v_add_f32 v200, 1.0, v200
    v_add_f32 v201, 1.0, v201
    s_waitcnt lgkmcnt(4)
    v_mfma_f32_32x32x16_bf16 v[80:95], v[176:179], a[24:27], v[80:95]
    ds_read_b64_tr_b16 v[192:193], v6 offset:18432
    v_rcp_f32 v200, v200
    v_rcp_f32 v201, v201
    v_mfma_f32_32x32x16_bf16 v[96:111], v[176:179], a[28:31], v[96:111]
    ds_read_b64_tr_b16 v[194:195], v6 offset:18944
    s_add_u32 m0, s55, 66560
    v_mul_f32 v202, v202, v200
    buffer_load_dwordx4 v3, s[32:35], s61 offen lds
    v_mul_f32 v203, v203, v201
    v_mfma_f32_32x32x16_bf16 v[112:127], v[180:183], a[24:27], v[112:127]
    ds_read_b64_tr_b16 v[196:197], v7 offset:18432
    v_cvt_pk_bf16_f32 v216, v202, v203
    v_mul_f32 v204, v18, v18
    v_mfma_f32_32x32x16_bf16 v[128:143], v[180:183], a[28:31], v[128:143]
    ds_read_b64_tr_b16 v[198:199], v7 offset:18944
    v_mul_f32 v205, v19, v19
    v_fma_f32 v204, v204, s64, v14
    s_waitcnt lgkmcnt(4)
    v_mfma_f32_32x32x16_bf16 v[80:95], v[184:187], a[32:35], v[80:95]
    ds_read_b64_tr_b16 v[176:177], v6 offset:24576
    v_fma_f32 v205, v205, s64, v14
    v_mul_f32 v204, v204, v18
    v_mfma_f32_32x32x16_bf16 v[96:111], v[184:187], a[36:39], v[96:111]
    ds_read_b64_tr_b16 v[178:179], v6 offset:25088
    s_mul_i32 s61, s13, 294912
    s_add_u32 m0, s55, 0
    s_add_u32 s61, s61, s57
    buffer_load_dwordx4 v2, s[32:35], s61 offen lds
    v_mul_f32 v205, v205, v19
    v_mfma_f32_32x32x16_bf16 v[112:127], v[188:191], a[32:35], v[112:127]
    ds_read_b64_tr_b16 v[180:181], v7 offset:24576
    v_exp_f32 v204, v204
    v_exp_f32 v205, v205
    v_mul_f32 v206, v18, v26
    v_mfma_f32_32x32x16_bf16 v[128:143], v[188:191], a[36:39], v[128:143]
    ds_read_b64_tr_b16 v[182:183], v7 offset:25088
    v_mul_f32 v207, v19, v27
    v_add_f32 v204, 1.0, v204
    s_waitcnt lgkmcnt(4)
    v_mfma_f32_32x32x16_bf16 v[80:95], v[192:195], a[40:43], v[80:95]
    ds_read_b64_tr_b16 v[184:185], v6 offset:26624
    v_add_f32 v205, 1.0, v205
    v_rcp_f32 v204, v204
    v_mfma_f32_32x32x16_bf16 v[96:111], v[192:195], a[44:47], v[96:111]
    ds_read_b64_tr_b16 v[186:187], v6 offset:27136
    s_add_u32 m0, s55, 1024
    v_rcp_f32 v205, v205
    buffer_load_dwordx4 v3, s[32:35], s61 offen lds
    v_mul_f32 v206, v206, v204
    v_mfma_f32_32x32x16_bf16 v[112:127], v[196:199], a[40:43], v[112:127]
    ds_read_b64_tr_b16 v[188:189], v7 offset:26624
    v_mul_f32 v207, v207, v205
    v_cvt_pk_bf16_f32 v217, v206, v207
    v_mfma_f32_32x32x16_bf16 v[128:143], v[196:199], a[44:47], v[128:143]
    ds_read_b64_tr_b16 v[190:191], v7 offset:27136
    v_mul_f32 v200, v20, v20
    v_mul_f32 v201, v21, v21
    s_waitcnt lgkmcnt(4)
    v_mfma_f32_32x32x16_bf16 v[80:95], v[176:179], a[48:51], v[80:95]
    s_waitcnt vmcnt(8)
    s_barrier
    ds_read_b64_tr_b16 v[192:193], v6 offset:32768
    v_fma_f32 v200, v200, s64, v14
    v_fma_f32 v201, v201, s64, v14
    v_mfma_f32_32x32x16_bf16 v[96:111], v[176:179], a[52:55], v[96:111]
    ds_read_b64_tr_b16 v[194:195], v6 offset:33280
    s_mul_i32 s61, s14, 294912
    s_add_u32 m0, s55, 8192
    s_add_u32 s61, s61, s57
    buffer_load_dwordx4 v2, s[32:35], s61 offen lds
    v_mul_f32 v200, v200, v20
    v_mfma_f32_32x32x16_bf16 v[112:127], v[180:183], a[48:51], v[112:127]
    ds_read_b64_tr_b16 v[196:197], v7 offset:32768
    v_mul_f32 v201, v201, v21
    v_exp_f32 v200, v200
    v_exp_f32 v201, v201
    v_mfma_f32_32x32x16_bf16 v[128:143], v[180:183], a[52:55], v[128:143]
    ds_read_b64_tr_b16 v[198:199], v7 offset:33280
    v_mul_f32 v202, v20, v28
    v_mul_f32 v203, v21, v29
    s_waitcnt lgkmcnt(4)
    v_mfma_f32_32x32x16_bf16 v[80:95], v[184:187], a[56:59], v[80:95]
    ds_read_b64_tr_b16 v[176:177], v6 offset:34816
    v_add_f32 v200, 1.0, v200
    v_add_f32 v201, 1.0, v201
    v_mfma_f32_32x32x16_bf16 v[96:111], v[184:187], a[60:63], v[96:111]
    ds_read_b64_tr_b16 v[178:179], v6 offset:35328
    s_add_u32 m0, s55, 9216
    v_rcp_f32 v200, v200
    buffer_load_dwordx4 v3, s[32:35], s61 offen lds
    v_rcp_f32 v201, v201
    v_mfma_f32_32x32x16_bf16 v[112:127], v[188:191], a[56:59], v[112:127]
    ds_read_b64_tr_b16 v[180:181], v7 offset:34816
    v_mul_f32 v202, v202, v200
    v_mul_f32 v203, v203, v201
    v_mfma_f32_32x32x16_bf16 v[128:143], v[188:191], a[60:63], v[128:143]
    ds_read_b64_tr_b16 v[182:183], v7 offset:35328
    v_cvt_pk_bf16_f32 v218, v202, v203
    v_mul_f32 v204, v22, v22
    s_waitcnt lgkmcnt(4)
    v_mfma_f32_32x32x16_bf16 v[80:95], v[192:195], a[64:67], v[80:95]
    ds_read_b64_tr_b16 v[184:185], v6 offset:40960
    v_mul_f32 v205, v23, v23
    v_fma_f32 v204, v204, s64, v14
    v_mfma_f32_32x32x16_bf16 v[96:111], v[192:195], a[68:71], v[96:111]
    ds_read_b64_tr_b16 v[186:187], v6 offset:41472
    s_mul_i32 s61, s15, 294912
    s_add_u32 m0, s55, 16384
    s_add_u32 s61, s61, s57
    buffer_load_dwordx4 v2, s[32:35], s61 offen lds
    v_fma_f32 v205, v205, s64, v14
    v_mfma_f32_32x32x16_bf16 v[112:127], v[196:199], a[64:67], v[112:127]
    ds_read_b64_tr_b16 v[188:189], v7 offset:40960
    v_mul_f32 v204, v204, v22
    v_mul_f32 v205, v205, v23
    v_exp_f32 v204, v204
    v_mfma_f32_32x32x16_bf16 v[128:143], v[196:199], a[68:71], v[128:143]
    ds_read_b64_tr_b16 v[190:191], v7 offset:41472
    v_exp_f32 v205, v205
    v_mul_f32 v206, v22, v30
    s_waitcnt lgkmcnt(4)
    v_mfma_f32_32x32x16_bf16 v[80:95], v[176:179], a[72:75], v[80:95]
    ds_read_b64_tr_b16 v[192:193], v6 offset:43008
    v_mul_f32 v207, v23, v31
    v_add_f32 v204, 1.0, v204
    v_mfma_f32_32x32x16_bf16 v[96:111], v[176:179], a[76:79], v[96:111]
    ds_read_b64_tr_b16 v[194:195], v6 offset:43520
    s_add_u32 m0, s55, 17408
    v_add_f32 v205, 1.0, v205
    buffer_load_dwordx4 v3, s[32:35], s61 offen lds
    v_rcp_f32 v204, v204
    v_mfma_f32_32x32x16_bf16 v[112:127], v[180:183], a[72:75], v[112:127]
    ds_read_b64_tr_b16 v[196:197], v7 offset:43008
    v_rcp_f32 v205, v205
    v_mul_f32 v206, v206, v204
    v_mfma_f32_32x32x16_bf16 v[128:143], v[180:183], a[76:79], v[128:143]
    ds_read_b64_tr_b16 v[198:199], v7 offset:43520
    v_mul_f32 v207, v207, v205
    v_cvt_pk_bf16_f32 v219, v206, v207
    s_waitcnt lgkmcnt(4)
    v_mfma_f32_32x32x16_bf16 v[80:95], v[184:187], a[80:83], v[80:95]
    s_waitcnt vmcnt(8)
    s_barrier
    ds_read_b64_tr_b16 v[176:177], v8 offset:0
    ds_write_b128 v12, v[216:219] offset:0
    v_mul_f32 v200, v32, v32
    v_mfma_f32_32x32x16_bf16 v[96:111], v[184:187], a[84:87], v[96:111]
    ds_read_b64_tr_b16 v[178:179], v8 offset:512
    s_mul_i32 s61, s16, 294912
    s_add_u32 m0, s55, 24576
    s_add_u32 s61, s61, s57
    buffer_load_dwordx4 v2, s[32:35], s61 offen lds
    v_mul_f32 v201, v33, v33
    v_mfma_f32_32x32x16_bf16 v[112:127], v[188:191], a[80:83], v[112:127]
    ds_read_b64_tr_b16 v[180:181], v9 offset:0
    v_fma_f32 v200, v200, s64, v14
    v_fma_f32 v201, v201, s64, v14
    v_mul_f32 v200, v200, v32
    v_mfma_f32_32x32x16_bf16 v[128:143], v[188:191], a[84:87], v[128:143]
    ds_read_b64_tr_b16 v[182:183], v9 offset:512
    v_mul_f32 v201, v201, v33
    v_exp_f32 v200, v200
    s_waitcnt lgkmcnt(5)
    v_mfma_f32_32x32x16_bf16 v[80:95], v[192:195], a[88:91], v[80:95]
    ds_read_b64_tr_b16 v[184:185], v8 offset:2048
    v_exp_f32 v201, v201
    v_mul_f32 v202, v32, v40
    v_mfma_f32_32x32x16_bf16 v[96:111], v[192:195], a[92:95], v[96:111]
    ds_read_b64_tr_b16 v[186:187], v8 offset:2560
    s_add_u32 m0, s55, 25600
    v_mul_f32 v203, v33, v41
    buffer_load_dwordx4 v3, s[32:35], s61 offen lds
    v_add_f32 v200, 1.0, v200
    v_mfma_f32_32x32x16_bf16 v[112:127], v[196:199], a[88:91], v[112:127]
    ds_read_b64_tr_b16 v[188:189], v9 offset:2048
    v_add_f32 v201, 1.0, v201
    v_rcp_f32 v200, v200
    v_mfma_f32_32x32x16_bf16 v[128:143], v[196:199], a[92:95], v[128:143]
    ds_read_b64_tr_b16 v[190:191], v9 offset:2560
    v_rcp_f32 v201, v201
    v_mul_f32 v202, v202, v200
    s_waitcnt lgkmcnt(4)
    v_mfma_f32_32x32x16_bf16 v[80:95], v[176:179], a[96:99], v[80:95]
    ds_read_b64_tr_b16 v[192:193], v8 offset:8192
    v_mul_f32 v203, v203, v201
    v_cvt_pk_bf16_f32 v220, v202, v203
    v_mfma_f32_32x32x16_bf16 v[96:111], v[176:179], a[100:103], v[96:111]
    ds_read_b64_tr_b16 v[194:195], v8 offset:8704
    s_mul_i32 s61, s17, 294912
    s_add_u32 m0, s55, 32768
    s_add_u32 s61, s61, s57
    buffer_load_dwordx4 v2, s[32:35], s61 offen lds
    v_mul_f32 v204, v34, v34
    v_mfma_f32_32x32x16_bf16 v[112:127], v[180:183], a[96:99], v[112:127]
    ds_read_b64_tr_b16 v[196:197], v9 offset:8192
    v_mul_f32 v205, v35, v35
    v_fma_f32 v204, v204, s64, v14
    v_fma_f32 v205, v205, s64, v14
    v_mfma_f32_32x32x16_bf16 v[128:143], v[180:183], a[100:103], v[128:143]
    ds_read_b64_tr_b16 v[198:199], v9 offset:8704
    v_mul_f32 v204, v204, v34
    v_mul_f32 v205, v205, v35
    s_waitcnt lgkmcnt(4)
    v_mfma_f32_32x32x16_bf16 v[80:95], v[184:187], a[104:107], v[80:95]
    ds_read_b64_tr_b16 v[176:177], v8 offset:10240
    v_exp_f32 v204, v204
    v_exp_f32 v205, v205
    v_mfma_f32_32x32x16_bf16 v[96:111], v[184:187], a[108:111], v[96:111]
    ds_read_b64_tr_b16 v[178:179], v8 offset:10752
    s_add_u32 m0, s55, 33792
    v_mul_f32 v206, v34, v42
    buffer_load_dwordx4 v3, s[32:35], s61 offen lds
    v_mul_f32 v207, v35, v43
    v_mfma_f32_32x32x16_bf16 v[112:127], v[188:191], a[104:107], v[112:127]
    ds_read_b64_tr_b16 v[180:181], v9 offset:10240
    v_add_f32 v204, 1.0, v204
    v_add_f32 v205, 1.0, v205
    v_mfma_f32_32x32x16_bf16 v[128:143], v[188:191], a[108:111], v[128:143]
    ds_read_b64_tr_b16 v[182:183], v9 offset:10752
    v_rcp_f32 v204, v204
    v_rcp_f32 v205, v205
    s_waitcnt lgkmcnt(4)
    v_mfma_f32_32x32x16_bf16 v[80:95], v[192:195], a[112:115], v[80:95]
    s_waitcnt vmcnt(8)
    s_barrier
    ds_read_b64_tr_b16 v[184:185], v8 offset:16384
    v_mul_f32 v206, v206, v204
    v_mul_f32 v207, v207, v205
    v_mfma_f32_32x32x16_bf16 v[96:111], v[192:195], a[116:119], v[96:111]
    ds_read_b64_tr_b16 v[186:187], v8 offset:16896
    s_mul_i32 s61, s18, 294912
    s_add_u32 m0, s55, 40960
    s_add_u32 s61, s61, s57
    buffer_load_dwordx4 v2, s[32:35], s61 offen lds
    v_cvt_pk_bf16_f32 v221, v206, v207
    v_mfma_f32_32x32x16_bf16 v[112:127], v[196:199], a[112:115], v[112:127]
    ds_read_b64_tr_b16 v[188:189], v9 offset:16384
    v_mul_f32 v200, v36, v36
    v_mul_f32 v201, v37, v37
    v_fma_f32 v200, v200, s64, v14
    v_mfma_f32_32x32x16_bf16 v[128:143], v[196:199], a[116:119], v[128:143]
    ds_read_b64_tr_b16 v[190:191], v9 offset:16896
    v_fma_f32 v201, v201, s64, v14
    v_mul_f32 v200, v200, v36
    s_waitcnt lgkmcnt(4)
    v_mfma_f32_32x32x16_bf16 v[80:95], v[176:179], a[120:123], v[80:95]
    ds_read_b64_tr_b16 v[192:193], v8 offset:18432
    v_mul_f32 v201, v201, v37
    v_exp_f32 v200, v200
    v_mfma_f32_32x32x16_bf16 v[96:111], v[176:179], a[124:127], v[96:111]
    ds_read_b64_tr_b16 v[194:195], v8 offset:18944
    s_add_u32 m0, s55, 41984
    v_exp_f32 v201, v201
    buffer_load_dwordx4 v3, s[32:35], s61 offen lds
    v_mul_f32 v202, v36, v44
    v_mfma_f32_32x32x16_bf16 v[112:127], v[180:183], a[120:123], v[112:127]
    ds_read_b64_tr_b16 v[196:197], v9 offset:18432
    v_mul_f32 v203, v37, v45
    v_add_f32 v200, 1.0, v200
    v_mfma_f32_32x32x16_bf16 v[128:143], v[180:183], a[124:127], v[128:143]
    ds_read_b64_tr_b16 v[198:199], v9 offset:18944
    v_add_f32 v201, 1.0, v201
    v_rcp_f32 v200, v200
    s_waitcnt lgkmcnt(4)
    v_mfma_f32_32x32x16_bf16 v[80:95], v[184:187], a[128:131], v[80:95]
    ds_read_b64_tr_b16 v[176:177], v6 offset:0
    v_rcp_f32 v201, v201
    v_mul_f32 v202, v202, v200
    v_mfma_f32_32x32x16_bf16 v[96:111], v[184:187], a[132:135], v[96:111]
    ds_read_b64_tr_b16 v[178:179], v6 offset:512
    s_mul_i32 s61, s19, 294912
    s_add_u32 m0, s55, 49152
    s_add_u32 s61, s61, s57
    buffer_load_dwordx4 v2, s[32:35], s61 offen lds
    v_mul_f32 v203, v203, v201
    v_mfma_f32_32x32x16_bf16 v[112:127], v[188:191], a[128:131], v[112:127]
    ds_read_b64_tr_b16 v[180:181], v7 offset:0
    v_cvt_pk_bf16_f32 v222, v202, v203
    v_mul_f32 v204, v38, v38
    v_mul_f32 v205, v39, v39
    v_mfma_f32_32x32x16_bf16 v[128:143], v[188:191], a[132:135], v[128:143]
    ds_read_b64_tr_b16 v[182:183], v7 offset:512
    v_fma_f32 v204, v204, s64, v14
    v_fma_f32 v205, v205, s64, v14
    s_waitcnt lgkmcnt(4)
    v_mfma_f32_32x32x16_bf16 v[80:95], v[192:195], a[136:139], v[80:95]
    ds_read_b64_tr_b16 v[184:185], v6 offset:2048
    v_mul_f32 v204, v204, v38
    v_mul_f32 v205, v205, v39
    v_mfma_f32_32x32x16_bf16 v[96:111], v[192:195], a[140:143], v[96:111]
    ds_read_b64_tr_b16 v[186:187], v6 offset:2560
    s_add_u32 m0, s55, 50176
    v_exp_f32 v204, v204
    buffer_load_dwordx4 v3, s[32:35], s61 offen lds
    v_exp_f32 v205, v205
    v_mfma_f32_32x32x16_bf16 v[112:127], v[196:199], a[136:139], v[112:127]
    ds_read_b64_tr_b16 v[188:189], v7 offset:2048
    v_mul_f32 v206, v38, v46
    v_mul_f32 v207, v39, v47
    v_mfma_f32_32x32x16_bf16 v[128:143], v[196:199], a[140:143], v[128:143]
    ds_read_b64_tr_b16 v[190:191], v7 offset:2560
    v_add_f32 v204, 1.0, v204
    v_add_f32 v205, 1.0, v205
    s_waitcnt lgkmcnt(4)
    v_mfma_f32_32x32x16_bf16 v[80:95], v[176:179], a[144:147], v[80:95]
    s_waitcnt vmcnt(8)
    s_barrier
    ds_read_b64_tr_b16 v[192:193], v6 offset:8192
    v_rcp_f32 v204, v204
    v_rcp_f32 v205, v205
    v_mfma_f32_32x32x16_bf16 v[96:111], v[176:179], a[148:151], v[96:111]
    ds_read_b64_tr_b16 v[194:195], v6 offset:8704
    s_mul_i32 s61, s20, 294912
    s_add_u32 m0, s55, 57344
    s_add_u32 s61, s61, s57
    buffer_load_dwordx4 v2, s[32:35], s61 offen lds
    v_mul_f32 v206, v206, v204
    v_mfma_f32_32x32x16_bf16 v[112:127], v[180:183], a[144:147], v[112:127]
    ds_read_b64_tr_b16 v[196:197], v7 offset:8192
    v_mul_f32 v207, v207, v205
    v_cvt_pk_bf16_f32 v223, v206, v207
    ds_write_b128 v12, v[220:223] offset:18432
    v_mfma_f32_32x32x16_bf16 v[128:143], v[180:183], a[148:151], v[128:143]
    ds_read_b64_tr_b16 v[198:199], v7 offset:8704
    v_mul_f32 v200, v48, v48
    v_mul_f32 v201, v49, v49
    s_waitcnt lgkmcnt(5)
    v_mfma_f32_32x32x16_bf16 v[80:95], v[184:187], a[152:155], v[80:95]
    ds_read_b64_tr_b16 v[176:177], v6 offset:10240
    v_fma_f32 v200, v200, s64, v14
    v_fma_f32 v201, v201, s64, v14
    v_mfma_f32_32x32x16_bf16 v[96:111], v[184:187], a[156:159], v[96:111]
    ds_read_b64_tr_b16 v[178:179], v6 offset:10752
    s_add_u32 m0, s55, 58368
    v_mul_f32 v200, v200, v48
    buffer_load_dwordx4 v3, s[32:35], s61 offen lds
    v_mul_f32 v201, v201, v49
    v_mfma_f32_32x32x16_bf16 v[112:127], v[188:191], a[152:155], v[112:127]
    ds_read_b64_tr_b16 v[180:181], v7 offset:10240
    v_exp_f32 v200, v200
    v_exp_f32 v201, v201
    v_mfma_f32_32x32x16_bf16 v[128:143], v[188:191], a[156:159], v[128:143]
    ds_read_b64_tr_b16 v[182:183], v7 offset:10752
    v_mul_f32 v202, v48, v56
    v_mul_f32 v203, v49, v57
    s_waitcnt lgkmcnt(4)
    v_mfma_f32_32x32x16_bf16 v[80:95], v[192:195], a[160:163], v[80:95]
    ds_read_b64_tr_b16 v[184:185], v6 offset:16384
    v_add_f32 v200, 1.0, v200
    v_add_f32 v201, 1.0, v201
    v_mfma_f32_32x32x16_bf16 v[96:111], v[192:195], a[164:167], v[96:111]
    ds_read_b64_tr_b16 v[186:187], v6 offset:16896
    s_mul_i32 s61, s21, 294912
    s_add_u32 m0, s55, 65536
    s_add_u32 s61, s61, s57
    buffer_load_dwordx4 v2, s[32:35], s61 offen lds
    v_rcp_f32 v200, v200
    v_mfma_f32_32x32x16_bf16 v[112:127], v[196:199], a[160:163], v[112:127]
    ds_read_b64_tr_b16 v[188:189], v7 offset:16384
    v_rcp_f32 v201, v201
    v_mul_f32 v202, v202, v200
    v_mul_f32 v203, v203, v201
    v_mfma_f32_32x32x16_bf16 v[128:143], v[196:199], a[164:167], v[128:143]
    ds_read_b64_tr_b16 v[190:191], v7 offset:16896
    v_cvt_pk_bf16_f32 v216, v202, v203
    v_mul_f32 v204, v50, v50
    s_waitcnt lgkmcnt(4)
    v_mfma_f32_32x32x16_bf16 v[80:95], v[176:179], a[168:171], v[80:95]
    ds_read_b64_tr_b16 v[192:193], v6 offset:18432
    v_mul_f32 v205, v51, v51
    v_fma_f32 v204, v204, s64, v14
    v_mfma_f32_32x32x16_bf16 v[96:111], v[176:179], a[172:175], v[96:111]
    ds_read_b64_tr_b16 v[194:195], v6 offset:18944
    s_add_u32 m0, s55, 66560
    v_fma_f32 v205, v205, s64, v14
    buffer_load_dwordx4 v3, s[32:35], s61 offen lds
    v_mul_f32 v204, v204, v50
    v_mfma_f32_32x32x16_bf16 v[112:127], v[180:183], a[168:171], v[112:127]
    ds_read_b64_tr_b16 v[196:197], v7 offset:18432
    v_mul_f32 v205, v205, v51
    v_exp_f32 v204, v204
    v_mfma_f32_32x32x16_bf16 v[128:143], v[180:183], a[172:175], v[128:143]
    ds_read_b64_tr_b16 v[198:199], v7 offset:18944
    v_exp_f32 v205, v205
    v_mul_f32 v206, v50, v58
    s_waitcnt lgkmcnt(4)
    v_mfma_f32_32x32x16_bf16 v[80:95], v[184:187], a[176:179], v[80:95]
    s_waitcnt vmcnt(8)
    s_barrier
    ds_read_b64_tr_b16 v[176:177], v6 offset:24576
    v_mul_f32 v207, v51, v59
    v_add_f32 v204, 1.0, v204
    v_mfma_f32_32x32x16_bf16 v[96:111], v[184:187], a[180:183], v[96:111]
    ds_read_b64_tr_b16 v[178:179], v6 offset:25088
    s_mul_i32 s61, s4, 294912
    s_add_u32 m0, s55, 0
    s_add_u32 s61, s61, s58
    buffer_load_dwordx4 v2, s[32:35], s61 offen lds
    v_add_f32 v205, 1.0, v205
    v_mfma_f32_32x32x16_bf16 v[112:127], v[188:191], a[176:179], v[112:127]
    ds_read_b64_tr_b16 v[180:181], v7 offset:24576
    v_rcp_f32 v204, v204
    v_rcp_f32 v205, v205
    v_mul_f32 v206, v206, v204
    v_mfma_f32_32x32x16_bf16 v[128:143], v[188:191], a[180:183], v[128:143]
    ds_read_b64_tr_b16 v[182:183], v7 offset:25088
    v_mul_f32 v207, v207, v205
    v_cvt_pk_bf16_f32 v217, v206, v207
    s_waitcnt lgkmcnt(4)
    v_mfma_f32_32x32x16_bf16 v[80:95], v[192:195], a[184:187], v[80:95]
    ds_read_b64_tr_b16 v[184:185], v6 offset:26624
    v_mul_f32 v200, v52, v52
    v_mul_f32 v201, v53, v53
    v_mfma_f32_32x32x16_bf16 v[96:111], v[192:195], a[188:191], v[96:111]
    ds_read_b64_tr_b16 v[186:187], v6 offset:27136
    s_add_u32 m0, s55, 1024
    v_fma_f32 v200, v200, s64, v14
    buffer_load_dwordx4 v3, s[32:35], s61 offen lds
    v_fma_f32 v201, v201, s64, v14
    v_mfma_f32_32x32x16_bf16 v[112:127], v[196:199], a[184:187], v[112:127]
    ds_read_b64_tr_b16 v[188:189], v7 offset:26624
    v_mul_f32 v200, v200, v52
    v_mul_f32 v201, v201, v53
    v_mfma_f32_32x32x16_bf16 v[128:143], v[196:199], a[188:191], v[128:143]
    ds_read_b64_tr_b16 v[190:191], v7 offset:27136
    v_exp_f32 v200, v200
    v_exp_f32 v201, v201
    s_waitcnt lgkmcnt(4)
    v_mfma_f32_32x32x16_bf16 v[80:95], v[176:179], a[192:195], v[80:95]
    ds_read_b64_tr_b16 v[192:193], v6 offset:32768
    v_mul_f32 v202, v52, v60
    v_mul_f32 v203, v53, v61
    v_mfma_f32_32x32x16_bf16 v[96:111], v[176:179], a[196:199], v[96:111]
    ds_read_b64_tr_b16 v[194:195], v6 offset:33280
    s_mul_i32 s61, s5, 294912
    s_add_u32 m0, s55, 8192
    s_add_u32 s61, s61, s58
    buffer_load_dwordx4 v2, s[32:35], s61 offen lds
    v_add_f32 v200, 1.0, v200
    v_mfma_f32_32x32x16_bf16 v[112:127], v[180:183], a[192:195], v[112:127]
    ds_read_b64_tr_b16 v[196:197], v7 offset:32768
    v_add_f32 v201, 1.0, v201
    v_rcp_f32 v200, v200
    v_rcp_f32 v201, v201
    v_mfma_f32_32x32x16_bf16 v[128:143], v[180:183], a[196:199], v[128:143]
    ds_read_b64_tr_b16 v[198:199], v7 offset:33280
    v_mul_f32 v202, v202, v200
    v_mul_f32 v203, v203, v201
    s_waitcnt lgkmcnt(4)
    v_mfma_f32_32x32x16_bf16 v[80:95], v[184:187], a[200:203], v[80:95]
    ds_read_b64_tr_b16 v[176:177], v6 offset:34816
    v_cvt_pk_bf16_f32 v218, v202, v203
    v_mul_f32 v204, v54, v54
    v_mfma_f32_32x32x16_bf16 v[96:111], v[184:187], a[204:207], v[96:111]
    ds_read_b64_tr_b16 v[178:179], v6 offset:35328
    s_add_u32 m0, s55, 9216
    v_mul_f32 v205, v55, v55
    buffer_load_dwordx4 v3, s[32:35], s61 offen lds
    v_fma_f32 v204, v204, s64, v14
    v_mfma_f32_32x32x16_bf16 v[112:127], v[188:191], a[200:203], v[112:127]
    ds_read_b64_tr_b16 v[180:181], v7 offset:34816
    v_fma_f32 v205, v205, s64, v14
    v_mul_f32 v204, v204, v54
    v_mfma_f32_32x32x16_bf16 v[128:143], v[188:191], a[204:207], v[128:143]
    ds_read_b64_tr_b16 v[182:183], v7 offset:35328
    v_mul_f32 v205, v205, v55
    v_exp_f32 v204, v204
    s_waitcnt lgkmcnt(4)
    v_mfma_f32_32x32x16_bf16 v[80:95], v[192:195], a[208:211], v[80:95]
    s_waitcnt vmcnt(8)
    s_barrier
    ds_read_b64_tr_b16 v[184:185], v6 offset:40960
    v_exp_f32 v205, v205
    v_mul_f32 v206, v54, v62
    v_mfma_f32_32x32x16_bf16 v[96:111], v[192:195], a[212:215], v[96:111]
    ds_read_b64_tr_b16 v[186:187], v6 offset:41472
    s_mul_i32 s61, s6, 294912
    s_add_u32 m0, s55, 16384
    s_add_u32 s61, s61, s58
    buffer_load_dwordx4 v2, s[32:35], s61 offen lds
    v_mul_f32 v207, v55, v63
    v_mfma_f32_32x32x16_bf16 v[112:127], v[196:199], a[208:211], v[112:127]
    ds_read_b64_tr_b16 v[188:189], v7 offset:40960
    v_add_f32 v204, 1.0, v204
    v_add_f32 v205, 1.0, v205
    v_rcp_f32 v204, v204
    v_mfma_f32_32x32x16_bf16 v[128:143], v[196:199], a[212:215], v[128:143]
    ds_read_b64_tr_b16 v[190:191], v7 offset:41472
    v_rcp_f32 v205, v205
    v_mul_f32 v206, v206, v204
    s_waitcnt lgkmcnt(4)
    v_mfma_f32_32x32x16_bf16 v[80:95], v[176:179], a[216:219], v[80:95]
    ds_read_b64_tr_b16 v[192:193], v6 offset:43008
    v_mul_f32 v207, v207, v205
    v_cvt_pk_bf16_f32 v219, v206, v207
    v_mfma_f32_32x32x16_bf16 v[96:111], v[176:179], a[220:223], v[96:111]
    ds_read_b64_tr_b16 v[194:195], v6 offset:43520
    s_add_u32 m0, s55, 17408
    ds_write_b128 v12, v[216:219] offset:1024
    buffer_load_dwordx4 v3, s[32:35], s61 offen lds
    v_mul_f32 v200, v64, v64
    v_mfma_f32_32x32x16_bf16 v[112:127], v[180:183], a[216:219], v[112:127]
    ds_read_b64_tr_b16 v[196:197], v7 offset:43008
    v_mul_f32 v201, v65, v65
    v_fma_f32 v200, v200, s64, v14
    v_mfma_f32_32x32x16_bf16 v[128:143], v[180:183], a[220:223], v[128:143]
    ds_read_b64_tr_b16 v[198:199], v7 offset:43520
    v_fma_f32 v201, v201, s64, v14
    v_mul_f32 v200, v200, v64
    s_waitcnt lgkmcnt(5)
    v_mfma_f32_32x32x16_bf16 v[80:95], v[184:187], a[224:227], v[80:95]
    ds_read_b64_tr_b16 v[176:177], v8 offset:0
    v_mul_f32 v201, v201, v65
    v_exp_f32 v200, v200
    v_mfma_f32_32x32x16_bf16 v[96:111], v[184:187], a[228:231], v[96:111]
    ds_read_b64_tr_b16 v[178:179], v8 offset:512
    s_mul_i32 s61, s7, 294912
    s_add_u32 m0, s55, 24576
    s_add_u32 s61, s61, s58
    buffer_load_dwordx4 v2, s[32:35], s61 offen lds
    v_exp_f32 v201, v201
    v_mfma_f32_32x32x16_bf16 v[112:127], v[188:191], a[224:227], v[112:127]
    ds_read_b64_tr_b16 v[180:181], v9 offset:0
    v_mul_f32 v202, v64, v72
    v_mul_f32 v203, v65, v73
    v_add_f32 v200, 1.0, v200
    v_mfma_f32_32x32x16_bf16 v[128:143], v[188:191], a[228:231], v[128:143]
    ds_read_b64_tr_b16 v[182:183], v9 offset:512
    v_add_f32 v201, 1.0, v201
    v_rcp_f32 v200, v200
    s_waitcnt lgkmcnt(4)
    v_mfma_f32_32x32x16_bf16 v[80:95], v[192:195], a[232:235], v[80:95]
    ds_read_b64_tr_b16 v[184:185], v8 offset:2048
    v_rcp_f32 v201, v201
    v_mul_f32 v202, v202, v200
    v_mfma_f32_32x32x16_bf16 v[96:111], v[192:195], a[236:239], v[96:111]
    ds_read_b64_tr_b16 v[186:187], v8 offset:2560
    s_add_u32 m0, s55, 25600
    v_mul_f32 v203, v203, v201
    buffer_load_dwordx4 v3, s[32:35], s61 offen lds
    v_cvt_pk_bf16_f32 v220, v202, v203
    v_mfma_f32_32x32x16_bf16 v[112:127], v[196:199], a[232:235], v[112:127]
    ds_read_b64_tr_b16 v[188:189], v9 offset:2048
    v_mul_f32 v204, v66, v66
    v_mul_f32 v205, v67, v67
    v_mfma_f32_32x32x16_bf16 v[128:143], v[196:199], a[236:239], v[128:143]
    ds_read_b64_tr_b16 v[190:191], v9 offset:2560
    v_fma_f32 v204, v204, s64, v14
    v_fma_f32 v205, v205, s64, v14
    s_waitcnt lgkmcnt(4)
    v_mfma_f32_32x32x16_bf16 v[80:95], v[176:179], a[240:243], v[80:95]
    s_waitcnt vmcnt(8)
    s_barrier
    ds_read_b64_tr_b16 v[192:193], v8 offset:8192
    v_mul_f32 v204, v204, v66
    v_mul_f32 v205, v205, v67
    v_mfma_f32_32x32x16_bf16 v[96:111], v[176:179], a[244:247], v[96:111]
    ds_read_b64_tr_b16 v[194:195], v8 offset:8704
    s_mul_i32 s61, s8, 294912
    s_add_u32 m0, s55, 32768
    s_add_u32 s61, s61, s58
    buffer_load_dwordx4 v2, s[32:35], s61 offen lds
    v_exp_f32 v204, v204
    v_mfma_f32_32x32x16_bf16 v[112:127], v[180:183], a[240:243], v[112:127]
    ds_read_b64_tr_b16 v[196:197], v9 offset:8192
    v_exp_f32 v205, v205
    v_mul_f32 v206, v66, v74
    v_mul_f32 v207, v67, v75
    v_mfma_f32_32x32x16_bf16 v[128:143], v[180:183], a[244:247], v[128:143]
    ds_read_b64_tr_b16 v[198:199], v9 offset:8704
    v_add_f32 v204, 1.0, v204
    v_add_f32 v205, 1.0, v205
    s_waitcnt lgkmcnt(4)
    v_mfma_f32_32x32x16_bf16 v[80:95], v[184:187], a[248:251], v[80:95]
    ds_read_b64_tr_b16 v[176:177], v8 offset:10240
    v_rcp_f32 v204, v204
    v_rcp_f32 v205, v205
    v_mfma_f32_32x32x16_bf16 v[96:111], v[184:187], a[252:255], v[96:111]
    ds_read_b64_tr_b16 v[178:179], v8 offset:10752
    s_add_u32 m0, s55, 33792
    v_mul_f32 v206, v206, v204
    buffer_load_dwordx4 v3, s[32:35], s61 offen lds
    v_mul_f32 v207, v207, v205
    v_mfma_f32_32x32x16_bf16 v[112:127], v[188:191], a[248:251], v[112:127]
    ds_read_b64_tr_b16 v[180:181], v9 offset:10240
    v_cvt_pk_bf16_f32 v221, v206, v207
    v_mul_f32 v200, v68, v68
    v_mfma_f32_32x32x16_bf16 v[128:143], v[188:191], a[252:255], v[128:143]
    ds_read_b64_tr_b16 v[182:183], v9 offset:10752
    v_mul_f32 v201, v69, v69
    v_fma_f32 v200, v200, s64, v14
    s_waitcnt lgkmcnt(4)
    v_mfma_f32_32x32x16_bf16 v[80:95], v[192:195], v[144:147], v[80:95]
    ds_read_b64_tr_b16 v[184:185], v8 offset:16384
    v_fma_f32 v201, v201, s64, v14
    v_mul_f32 v200, v200, v68
    v_mfma_f32_32x32x16_bf16 v[96:111], v[192:195], v[148:151], v[96:111]
    ds_read_b64_tr_b16 v[186:187], v8 offset:16896
    s_mul_i32 s61, s9, 294912
    s_add_u32 m0, s55, 40960
    s_add_u32 s61, s61, s58
    buffer_load_dwordx4 v2, s[32:35], s61 offen lds
    v_mul_f32 v201, v201, v69
    v_mfma_f32_32x32x16_bf16 v[112:127], v[196:199], v[144:147], v[112:127]
    ds_read_b64_tr_b16 v[188:189], v9 offset:16384
    v_exp_f32 v200, v200
    v_exp_f32 v201, v201
    v_mul_f32 v202, v68, v76
    v_mfma_f32_32x32x16_bf16 v[128:143], v[196:199], v[148:151], v[128:143]
    ds_read_b64_tr_b16 v[190:191], v9 offset:16896
    v_mul_f32 v203, v69, v77
    v_add_f32 v200, 1.0, v200
    s_waitcnt lgkmcnt(4)
    v_mfma_f32_32x32x16_bf16 v[80:95], v[176:179], v[152:155], v[80:95]
    ds_read_b64_tr_b16 v[192:193], v8 offset:18432
    v_add_f32 v201, 1.0, v201
    v_rcp_f32 v200, v200
    v_mfma_f32_32x32x16_bf16 v[96:111], v[176:179], v[156:159], v[96:111]
    ds_read_b64_tr_b16 v[194:195], v8 offset:18944
    s_add_u32 m0, s55, 41984
    v_rcp_f32 v201, v201
    buffer_load_dwordx4 v3, s[32:35], s61 offen lds
    v_mul_f32 v202, v202, v200
    v_mfma_f32_32x32x16_bf16 v[112:127], v[180:183], v[152:155], v[112:127]
    ds_read_b64_tr_b16 v[196:197], v9 offset:18432
    v_mul_f32 v203, v203, v201
    v_cvt_pk_bf16_f32 v222, v202, v203
    v_mfma_f32_32x32x16_bf16 v[128:143], v[180:183], v[156:159], v[128:143]
    ds_read_b64_tr_b16 v[198:199], v9 offset:18944
    v_mul_f32 v204, v70, v70
    v_mul_f32 v205, v71, v71
    s_waitcnt lgkmcnt(4)
    v_mfma_f32_32x32x16_bf16 v[80:95], v[184:187], v[160:163], v[80:95]
    s_waitcnt vmcnt(8)
    s_barrier
    ds_read_b64_tr_b16 v[176:177], v6 offset:0
    v_fma_f32 v204, v204, s64, v14
    v_fma_f32 v205, v205, s64, v14
    v_mfma_f32_32x32x16_bf16 v[96:111], v[184:187], v[164:167], v[96:111]
    ds_read_b64_tr_b16 v[178:179], v6 offset:512
    s_mul_i32 s61, s10, 294912
    s_add_u32 m0, s55, 49152
    s_add_u32 s61, s61, s58
    buffer_load_dwordx4 v2, s[32:35], s61 offen lds
    v_mul_f32 v204, v204, v70
    v_mfma_f32_32x32x16_bf16 v[112:127], v[188:191], v[160:163], v[112:127]
    ds_read_b64_tr_b16 v[180:181], v7 offset:0
    v_mul_f32 v205, v205, v71
    v_exp_f32 v204, v204
    v_exp_f32 v205, v205
    v_mfma_f32_32x32x16_bf16 v[128:143], v[188:191], v[164:167], v[128:143]
    ds_read_b64_tr_b16 v[182:183], v7 offset:512
    v_mul_f32 v206, v70, v78
    v_mul_f32 v207, v71, v79
    s_waitcnt lgkmcnt(4)
    v_mfma_f32_32x32x16_bf16 v[80:95], v[192:195], v[168:171], v[80:95]
    ds_read_b64_tr_b16 v[184:185], v6 offset:2048
    v_add_f32 v204, 1.0, v204
    v_add_f32 v205, 1.0, v205
    v_mfma_f32_32x32x16_bf16 v[96:111], v[192:195], v[172:175], v[96:111]
    ds_read_b64_tr_b16 v[186:187], v6 offset:2560
    s_add_u32 m0, s55, 50176
    v_rcp_f32 v204, v204
    buffer_load_dwordx4 v3, s[32:35], s61 offen lds
    v_rcp_f32 v205, v205
    v_mfma_f32_32x32x16_bf16 v[112:127], v[196:199], v[168:171], v[112:127]
    ds_read_b64_tr_b16 v[188:189], v7 offset:2048
    v_mul_f32 v206, v206, v204
    v_mul_f32 v207, v207, v205
    v_mfma_f32_32x32x16_bf16 v[128:143], v[196:199], v[172:175], v[128:143]
    ds_read_b64_tr_b16 v[190:191], v7 offset:2560
    v_cvt_pk_bf16_f32 v223, v206, v207
    ds_write_b128 v12, v[220:223] offset:19456
    s_waitcnt lgkmcnt(5)
    v_mfma_f32_32x32x16_bf16 v[16:31], v[176:179], a[0:3], 0
    ds_read_b64_tr_b16 v[192:193], v6 offset:8192
    s_mul_i32 s61, s11, 294912
    s_add_u32 m0, s55, 57344
    s_add_u32 s61, s61, s58
    buffer_load_dwordx4 v2, s[32:35], s61 offen lds
    v_mfma_f32_32x32x16_bf16 v[32:47], v[176:179], a[4:7], 0
    ds_read_b64_tr_b16 v[194:195], v6 offset:8704
    v_mfma_f32_32x32x16_bf16 v[48:63], v[180:183], a[0:3], 0
    ds_read_b64_tr_b16 v[196:197], v7 offset:8192
    v_mfma_f32_32x32x16_bf16 v[64:79], v[180:183], a[4:7], 0
    ds_read_b64_tr_b16 v[198:199], v7 offset:8704
    s_waitcnt lgkmcnt(5)
    v_mfma_f32_32x32x16_bf16 v[16:31], v[184:187], a[8:11], v[16:31]
    ds_read_b64_tr_b16 v[176:177], v6 offset:10240
    s_add_u32 m0, s55, 58368
    s_nop 0
    buffer_load_dwordx4 v3, s[32:35], s61 offen lds
    v_mfma_f32_32x32x16_bf16 v[32:47], v[184:187], a[12:15], v[32:47]
    ds_read_b64_tr_b16 v[178:179], v6 offset:10752
    v_mfma_f32_32x32x16_bf16 v[48:63], v[188:191], a[8:11], v[48:63]
    ds_read_b64_tr_b16 v[180:181], v7 offset:10240
    v_mul_f32 v200, v80, v80
    v_mul_f32 v201, v81, v81
    v_mfma_f32_32x32x16_bf16 v[64:79], v[188:191], a[12:15], v[64:79]
    ds_read_b64_tr_b16 v[182:183], v7 offset:10752
    v_fma_f32 v200, v200, s64, v14
    v_fma_f32 v201, v201, s64, v14
    s_waitcnt lgkmcnt(4)
    v_mfma_f32_32x32x16_bf16 v[16:31], v[192:195], a[16:19], v[16:31]
    s_waitcnt vmcnt(8)
    s_barrier
    ds_read_b64_tr_b16 v[184:185], v6 offset:16384
    v_mul_f32 v200, v200, v80
    v_mul_f32 v201, v201, v81
    v_mfma_f32_32x32x16_bf16 v[32:47], v[192:195], a[20:23], v[32:47]
    ds_read_b64_tr_b16 v[186:187], v6 offset:16896
    s_mul_i32 s61, s12, 294912
    s_add_u32 m0, s55, 65536
    s_add_u32 s61, s61, s58
    buffer_load_dwordx4 v2, s[32:35], s61 offen lds
    v_exp_f32 v200, v200
    v_mfma_f32_32x32x16_bf16 v[48:63], v[196:199], a[16:19], v[48:63]
    ds_read_b64_tr_b16 v[188:189], v7 offset:16384
    v_exp_f32 v201, v201
    v_mul_f32 v202, v80, v88
    v_mul_f32 v203, v81, v89
    v_mfma_f32_32x32x16_bf16 v[64:79], v[196:199], a[20:23], v[64:79]
    ds_read_b64_tr_b16 v[190:191], v7 offset:16896
    v_add_f32 v200, 1.0, v200
    v_add_f32 v201, 1.0, v201
    s_waitcnt lgkmcnt(4)
    v_mfma_f32_32x32x16_bf16 v[16:31], v[176:179], a[24:27], v[16:31]
    ds_read_b64_tr_b16 v[192:193], v6 offset:18432
    v_rcp_f32 v200, v200
    v_rcp_f32 v201, v201
    v_mfma_f32_32x32x16_bf16 v[32:47], v[176:179], a[28:31], v[32:47]
    ds_read_b64_tr_b16 v[194:195], v6 offset:18944
    s_add_u32 m0, s55, 66560
    v_mul_f32 v202, v202, v200
    buffer_load_dwordx4 v3, s[32:35], s61 offen lds
    v_mul_f32 v203, v203, v201
    v_mfma_f32_32x32x16_bf16 v[48:63], v[180:183], a[24:27], v[48:63]
    ds_read_b64_tr_b16 v[196:197], v7 offset:18432
    v_cvt_pk_bf16_f32 v216, v202, v203
    v_mul_f32 v204, v82, v82
    v_mfma_f32_32x32x16_bf16 v[64:79], v[180:183], a[28:31], v[64:79]
    ds_read_b64_tr_b16 v[198:199], v7 offset:18944
    v_mul_f32 v205, v83, v83
    v_fma_f32 v204, v204, s64, v14
    s_waitcnt lgkmcnt(4)
    v_mfma_f32_32x32x16_bf16 v[16:31], v[184:187], a[32:35], v[16:31]
    ds_read_b64_tr_b16 v[176:177], v6 offset:24576
    v_fma_f32 v205, v205, s64, v14
    v_mul_f32 v204, v204, v82
    v_mfma_f32_32x32x16_bf16 v[32:47], v[184:187], a[36:39], v[32:47]
    ds_read_b64_tr_b16 v[178:179], v6 offset:25088
    s_mul_i32 s61, s13, 294912
    s_add_u32 m0, s55, 0
    s_add_u32 s61, s61, s58
    buffer_load_dwordx4 v2, s[32:35], s61 offen lds
    v_mul_f32 v205, v205, v83
    v_mfma_f32_32x32x16_bf16 v[48:63], v[188:191], a[32:35], v[48:63]
    ds_read_b64_tr_b16 v[180:181], v7 offset:24576
    v_exp_f32 v204, v204
    v_exp_f32 v205, v205
    v_mul_f32 v206, v82, v90
    v_mfma_f32_32x32x16_bf16 v[64:79], v[188:191], a[36:39], v[64:79]
    ds_read_b64_tr_b16 v[182:183], v7 offset:25088
    v_mul_f32 v207, v83, v91
    v_add_f32 v204, 1.0, v204
    s_waitcnt lgkmcnt(4)
    v_mfma_f32_32x32x16_bf16 v[16:31], v[192:195], a[40:43], v[16:31]
    ds_read_b64_tr_b16 v[184:185], v6 offset:26624
    v_add_f32 v205, 1.0, v205
    v_rcp_f32 v204, v204
    v_mfma_f32_32x32x16_bf16 v[32:47], v[192:195], a[44:47], v[32:47]
    ds_read_b64_tr_b16 v[186:187], v6 offset:27136
    s_add_u32 m0, s55, 1024
    v_rcp_f32 v205, v205
    buffer_load_dwordx4 v3, s[32:35], s61 offen lds
    v_mul_f32 v206, v206, v204
    v_mfma_f32_32x32x16_bf16 v[48:63], v[196:199], a[40:43], v[48:63]
    ds_read_b64_tr_b16 v[188:189], v7 offset:26624
    v_mul_f32 v207, v207, v205
    v_cvt_pk_bf16_f32 v217, v206, v207
    v_mfma_f32_32x32x16_bf16 v[64:79], v[196:199], a[44:47], v[64:79]
    ds_read_b64_tr_b16 v[190:191], v7 offset:27136
    v_mul_f32 v200, v84, v84
    v_mul_f32 v201, v85, v85
    s_waitcnt lgkmcnt(4)
    v_mfma_f32_32x32x16_bf16 v[16:31], v[176:179], a[48:51], v[16:31]
    s_waitcnt vmcnt(8)
    s_barrier
    ds_read_b64_tr_b16 v[192:193], v6 offset:32768
    v_fma_f32 v200, v200, s64, v14
    v_fma_f32 v201, v201, s64, v14
    v_mfma_f32_32x32x16_bf16 v[32:47], v[176:179], a[52:55], v[32:47]
    ds_read_b64_tr_b16 v[194:195], v6 offset:33280
    s_mul_i32 s61, s14, 294912
    s_add_u32 m0, s55, 8192
    s_add_u32 s61, s61, s58
    buffer_load_dwordx4 v2, s[32:35], s61 offen lds
    v_mul_f32 v200, v200, v84
    v_mfma_f32_32x32x16_bf16 v[48:63], v[180:183], a[48:51], v[48:63]
    ds_read_b64_tr_b16 v[196:197], v7 offset:32768
    v_mul_f32 v201, v201, v85
    v_exp_f32 v200, v200
    v_exp_f32 v201, v201
    v_mfma_f32_32x32x16_bf16 v[64:79], v[180:183], a[52:55], v[64:79]
    ds_read_b64_tr_b16 v[198:199], v7 offset:33280
    v_mul_f32 v202, v84, v92
    v_mul_f32 v203, v85, v93
    s_waitcnt lgkmcnt(4)
    v_mfma_f32_32x32x16_bf16 v[16:31], v[184:187], a[56:59], v[16:31]
    ds_read_b64_tr_b16 v[176:177], v6 offset:34816
    v_add_f32 v200, 1.0, v200
    v_add_f32 v201, 1.0, v201
    v_mfma_f32_32x32x16_bf16 v[32:47], v[184:187], a[60:63], v[32:47]
    ds_read_b64_tr_b16 v[178:179], v6 offset:35328
    s_add_u32 m0, s55, 9216
    v_rcp_f32 v200, v200
    buffer_load_dwordx4 v3, s[32:35], s61 offen lds
    v_rcp_f32 v201, v201
    v_mfma_f32_32x32x16_bf16 v[48:63], v[188:191], a[56:59], v[48:63]
    ds_read_b64_tr_b16 v[180:181], v7 offset:34816
    v_mul_f32 v202, v202, v200
    v_mul_f32 v203, v203, v201
    v_mfma_f32_32x32x16_bf16 v[64:79], v[188:191], a[60:63], v[64:79]
    ds_read_b64_tr_b16 v[182:183], v7 offset:35328
    v_cvt_pk_bf16_f32 v218, v202, v203
    v_mul_f32 v204, v86, v86
    s_waitcnt lgkmcnt(4)
    v_mfma_f32_32x32x16_bf16 v[16:31], v[192:195], a[64:67], v[16:31]
    ds_read_b64_tr_b16 v[184:185], v6 offset:40960
    v_mul_f32 v205, v87, v87
    v_fma_f32 v204, v204, s64, v14
    v_mfma_f32_32x32x16_bf16 v[32:47], v[192:195], a[68:71], v[32:47]
    ds_read_b64_tr_b16 v[186:187], v6 offset:41472
    s_mul_i32 s61, s15, 294912
    s_add_u32 m0, s55, 16384
    s_add_u32 s61, s61, s58
    buffer_load_dwordx4 v2, s[32:35], s61 offen lds
    v_fma_f32 v205, v205, s64, v14
    v_mfma_f32_32x32x16_bf16 v[48:63], v[196:199], a[64:67], v[48:63]
    ds_read_b64_tr_b16 v[188:189], v7 offset:40960
    v_mul_f32 v204, v204, v86
    v_mul_f32 v205, v205, v87
    v_exp_f32 v204, v204
    v_mfma_f32_32x32x16_bf16 v[64:79], v[196:199], a[68:71], v[64:79]
    ds_read_b64_tr_b16 v[190:191], v7 offset:41472
    v_exp_f32 v205, v205
    v_mul_f32 v206, v86, v94
    s_waitcnt lgkmcnt(4)
    v_mfma_f32_32x32x16_bf16 v[16:31], v[176:179], a[72:75], v[16:31]
    ds_read_b64_tr_b16 v[192:193], v6 offset:43008
    v_mul_f32 v207, v87, v95
    v_add_f32 v204, 1.0, v204
    v_mfma_f32_32x32x16_bf16 v[32:47], v[176:179], a[76:79], v[32:47]
    ds_read_b64_tr_b16 v[194:195], v6 offset:43520
    s_add_u32 m0, s55, 17408
    v_add_f32 v205, 1.0, v205
    buffer_load_dwordx4 v3, s[32:35], s61 offen lds
    v_rcp_f32 v204, v204
    v_mfma_f32_32x32x16_bf16 v[48:63], v[180:183], a[72:75], v[48:63]
    ds_read_b64_tr_b16 v[196:197], v7 offset:43008
    v_rcp_f32 v205, v205
    v_mul_f32 v206, v206, v204
    v_mfma_f32_32x32x16_bf16 v[64:79], v[180:183], a[76:79], v[64:79]
    ds_read_b64_tr_b16 v[198:199], v7 offset:43520
    v_mul_f32 v207, v207, v205
    v_cvt_pk_bf16_f32 v219, v206, v207
    s_waitcnt lgkmcnt(4)
    v_mfma_f32_32x32x16_bf16 v[16:31], v[184:187], a[80:83], v[16:31]
    s_waitcnt vmcnt(8)
    s_barrier
    ds_read_b64_tr_b16 v[176:177], v8 offset:0
    ds_write_b128 v12, v[216:219] offset:4096
    v_mul_f32 v200, v96, v96
    v_mfma_f32_32x32x16_bf16 v[32:47], v[184:187], a[84:87], v[32:47]
    ds_read_b64_tr_b16 v[178:179], v8 offset:512
    s_mul_i32 s61, s16, 294912
    s_add_u32 m0, s55, 24576
    s_add_u32 s61, s61, s58
    buffer_load_dwordx4 v2, s[32:35], s61 offen lds
    v_mul_f32 v201, v97, v97
    v_mfma_f32_32x32x16_bf16 v[48:63], v[188:191], a[80:83], v[48:63]
    ds_read_b64_tr_b16 v[180:181], v9 offset:0
    v_fma_f32 v200, v200, s64, v14
    v_fma_f32 v201, v201, s64, v14
    v_mul_f32 v200, v200, v96
    v_mfma_f32_32x32x16_bf16 v[64:79], v[188:191], a[84:87], v[64:79]
    ds_read_b64_tr_b16 v[182:183], v9 offset:512
    v_mul_f32 v201, v201, v97
    v_exp_f32 v200, v200
    s_waitcnt lgkmcnt(5)
    v_mfma_f32_32x32x16_bf16 v[16:31], v[192:195], a[88:91], v[16:31]
    ds_read_b64_tr_b16 v[184:185], v8 offset:2048
    v_exp_f32 v201, v201
    v_mul_f32 v202, v96, v104
    v_mfma_f32_32x32x16_bf16 v[32:47], v[192:195], a[92:95], v[32:47]
    ds_read_b64_tr_b16 v[186:187], v8 offset:2560
    s_add_u32 m0, s55, 25600
    v_mul_f32 v203, v97, v105
    buffer_load_dwordx4 v3, s[32:35], s61 offen lds
    v_add_f32 v200, 1.0, v200
    v_mfma_f32_32x32x16_bf16 v[48:63], v[196:199], a[88:91], v[48:63]
    ds_read_b64_tr_b16 v[188:189], v9 offset:2048
    v_add_f32 v201, 1.0, v201
    v_rcp_f32 v200, v200
    v_mfma_f32_32x32x16_bf16 v[64:79], v[196:199], a[92:95], v[64:79]
    ds_read_b64_tr_b16 v[190:191], v9 offset:2560
    v_rcp_f32 v201, v201
    v_mul_f32 v202, v202, v200
    s_waitcnt lgkmcnt(4)
    v_mfma_f32_32x32x16_bf16 v[16:31], v[176:179], a[96:99], v[16:31]
    ds_read_b64_tr_b16 v[192:193], v8 offset:8192
    v_mul_f32 v203, v203, v201
    v_cvt_pk_bf16_f32 v220, v202, v203
    v_mfma_f32_32x32x16_bf16 v[32:47], v[176:179], a[100:103], v[32:47]
    ds_read_b64_tr_b16 v[194:195], v8 offset:8704
    s_mul_i32 s61, s17, 294912
    s_add_u32 m0, s55, 32768
    s_add_u32 s61, s61, s58
    buffer_load_dwordx4 v2, s[32:35], s61 offen lds
    v_mul_f32 v204, v98, v98
    v_mfma_f32_32x32x16_bf16 v[48:63], v[180:183], a[96:99], v[48:63]
    ds_read_b64_tr_b16 v[196:197], v9 offset:8192
    v_mul_f32 v205, v99, v99
    v_fma_f32 v204, v204, s64, v14
    v_fma_f32 v205, v205, s64, v14
    v_mfma_f32_32x32x16_bf16 v[64:79], v[180:183], a[100:103], v[64:79]
    ds_read_b64_tr_b16 v[198:199], v9 offset:8704
    v_mul_f32 v204, v204, v98
    v_mul_f32 v205, v205, v99
    s_waitcnt lgkmcnt(4)
    v_mfma_f32_32x32x16_bf16 v[16:31], v[184:187], a[104:107], v[16:31]
    ds_read_b64_tr_b16 v[176:177], v8 offset:10240
    v_exp_f32 v204, v204
    v_exp_f32 v205, v205
    v_mfma_f32_32x32x16_bf16 v[32:47], v[184:187], a[108:111], v[32:47]
    ds_read_b64_tr_b16 v[178:179], v8 offset:10752
    s_add_u32 m0, s55, 33792
    v_mul_f32 v206, v98, v106
    buffer_load_dwordx4 v3, s[32:35], s61 offen lds
    v_mul_f32 v207, v99, v107
    v_mfma_f32_32x32x16_bf16 v[48:63], v[188:191], a[104:107], v[48:63]
    ds_read_b64_tr_b16 v[180:181], v9 offset:10240
    v_add_f32 v204, 1.0, v204
    v_add_f32 v205, 1.0, v205
    v_mfma_f32_32x32x16_bf16 v[64:79], v[188:191], a[108:111], v[64:79]
    ds_read_b64_tr_b16 v[182:183], v9 offset:10752
    v_rcp_f32 v204, v204
    v_rcp_f32 v205, v205
    s_waitcnt lgkmcnt(4)
    v_mfma_f32_32x32x16_bf16 v[16:31], v[192:195], a[112:115], v[16:31]
    s_waitcnt vmcnt(8)
    s_barrier
    ds_read_b64_tr_b16 v[184:185], v8 offset:16384
    v_mul_f32 v206, v206, v204
    v_mul_f32 v207, v207, v205
    v_mfma_f32_32x32x16_bf16 v[32:47], v[192:195], a[116:119], v[32:47]
    ds_read_b64_tr_b16 v[186:187], v8 offset:16896
    s_mul_i32 s61, s18, 294912
    s_add_u32 m0, s55, 40960
    s_add_u32 s61, s61, s58
    buffer_load_dwordx4 v2, s[32:35], s61 offen lds
    v_cvt_pk_bf16_f32 v221, v206, v207
    v_mfma_f32_32x32x16_bf16 v[48:63], v[196:199], a[112:115], v[48:63]
    ds_read_b64_tr_b16 v[188:189], v9 offset:16384
    v_mul_f32 v200, v100, v100
    v_mul_f32 v201, v101, v101
    v_fma_f32 v200, v200, s64, v14
    v_mfma_f32_32x32x16_bf16 v[64:79], v[196:199], a[116:119], v[64:79]
    ds_read_b64_tr_b16 v[190:191], v9 offset:16896
    v_fma_f32 v201, v201, s64, v14
    v_mul_f32 v200, v200, v100
    s_waitcnt lgkmcnt(4)
    v_mfma_f32_32x32x16_bf16 v[16:31], v[176:179], a[120:123], v[16:31]
    ds_read_b64_tr_b16 v[192:193], v8 offset:18432
    v_mul_f32 v201, v201, v101
    v_exp_f32 v200, v200
    v_mfma_f32_32x32x16_bf16 v[32:47], v[176:179], a[124:127], v[32:47]
    ds_read_b64_tr_b16 v[194:195], v8 offset:18944
    s_add_u32 m0, s55, 41984
    v_exp_f32 v201, v201
    buffer_load_dwordx4 v3, s[32:35], s61 offen lds
    v_mul_f32 v202, v100, v108
    v_mfma_f32_32x32x16_bf16 v[48:63], v[180:183], a[120:123], v[48:63]
    ds_read_b64_tr_b16 v[196:197], v9 offset:18432
    v_mul_f32 v203, v101, v109
    v_add_f32 v200, 1.0, v200
    v_mfma_f32_32x32x16_bf16 v[64:79], v[180:183], a[124:127], v[64:79]
    ds_read_b64_tr_b16 v[198:199], v9 offset:18944
    v_add_f32 v201, 1.0, v201
    v_rcp_f32 v200, v200
    s_waitcnt lgkmcnt(4)
    v_mfma_f32_32x32x16_bf16 v[16:31], v[184:187], a[128:131], v[16:31]
    ds_read_b64_tr_b16 v[176:177], v6 offset:0
    v_rcp_f32 v201, v201
    v_mul_f32 v202, v202, v200
    v_mfma_f32_32x32x16_bf16 v[32:47], v[184:187], a[132:135], v[32:47]
    ds_read_b64_tr_b16 v[178:179], v6 offset:512
    s_mul_i32 s61, s19, 294912
    s_add_u32 m0, s55, 49152
    s_add_u32 s61, s61, s58
    buffer_load_dwordx4 v2, s[32:35], s61 offen lds
    v_mul_f32 v203, v203, v201
    v_mfma_f32_32x32x16_bf16 v[48:63], v[188:191], a[128:131], v[48:63]
    ds_read_b64_tr_b16 v[180:181], v7 offset:0
    v_cvt_pk_bf16_f32 v222, v202, v203
    v_mul_f32 v204, v102, v102
    v_mul_f32 v205, v103, v103
    v_mfma_f32_32x32x16_bf16 v[64:79], v[188:191], a[132:135], v[64:79]
    ds_read_b64_tr_b16 v[182:183], v7 offset:512
    v_fma_f32 v204, v204, s64, v14
    v_fma_f32 v205, v205, s64, v14
    s_waitcnt lgkmcnt(4)
    v_mfma_f32_32x32x16_bf16 v[16:31], v[192:195], a[136:139], v[16:31]
    ds_read_b64_tr_b16 v[184:185], v6 offset:2048
    v_mul_f32 v204, v204, v102
    v_mul_f32 v205, v205, v103
    v_mfma_f32_32x32x16_bf16 v[32:47], v[192:195], a[140:143], v[32:47]
    ds_read_b64_tr_b16 v[186:187], v6 offset:2560
    s_add_u32 m0, s55, 50176
    v_exp_f32 v204, v204
    buffer_load_dwordx4 v3, s[32:35], s61 offen lds
    v_exp_f32 v205, v205
    v_mfma_f32_32x32x16_bf16 v[48:63], v[196:199], a[136:139], v[48:63]
    ds_read_b64_tr_b16 v[188:189], v7 offset:2048
    v_mul_f32 v206, v102, v110
    v_mul_f32 v207, v103, v111
    v_mfma_f32_32x32x16_bf16 v[64:79], v[196:199], a[140:143], v[64:79]
    ds_read_b64_tr_b16 v[190:191], v7 offset:2560
    v_add_f32 v204, 1.0, v204
    v_add_f32 v205, 1.0, v205
    s_waitcnt lgkmcnt(4)
    v_mfma_f32_32x32x16_bf16 v[16:31], v[176:179], a[144:147], v[16:31]
    s_waitcnt vmcnt(8)
    s_barrier
    ds_read_b64_tr_b16 v[192:193], v6 offset:8192
    v_rcp_f32 v204, v204
    v_rcp_f32 v205, v205
    v_mfma_f32_32x32x16_bf16 v[32:47], v[176:179], a[148:151], v[32:47]
    ds_read_b64_tr_b16 v[194:195], v6 offset:8704
    s_mul_i32 s61, s20, 294912
    s_add_u32 m0, s55, 57344
    s_add_u32 s61, s61, s58
    buffer_load_dwordx4 v2, s[32:35], s61 offen lds
    v_mul_f32 v206, v206, v204
    v_mfma_f32_32x32x16_bf16 v[48:63], v[180:183], a[144:147], v[48:63]
    ds_read_b64_tr_b16 v[196:197], v7 offset:8192
    v_mul_f32 v207, v207, v205
    v_cvt_pk_bf16_f32 v223, v206, v207
    ds_write_b128 v12, v[220:223] offset:22528
    v_mfma_f32_32x32x16_bf16 v[64:79], v[180:183], a[148:151], v[64:79]
    ds_read_b64_tr_b16 v[198:199], v7 offset:8704
    v_mul_f32 v200, v112, v112
    v_mul_f32 v201, v113, v113
    s_waitcnt lgkmcnt(5)
    v_mfma_f32_32x32x16_bf16 v[16:31], v[184:187], a[152:155], v[16:31]
    ds_read_b64_tr_b16 v[176:177], v6 offset:10240
    v_fma_f32 v200, v200, s64, v14
    v_fma_f32 v201, v201, s64, v14
    v_mfma_f32_32x32x16_bf16 v[32:47], v[184:187], a[156:159], v[32:47]
    ds_read_b64_tr_b16 v[178:179], v6 offset:10752
    s_add_u32 m0, s55, 58368
    v_mul_f32 v200, v200, v112
    buffer_load_dwordx4 v3, s[32:35], s61 offen lds
    v_mul_f32 v201, v201, v113
    v_mfma_f32_32x32x16_bf16 v[48:63], v[188:191], a[152:155], v[48:63]
    ds_read_b64_tr_b16 v[180:181], v7 offset:10240
    v_exp_f32 v200, v200
    v_exp_f32 v201, v201
    v_mfma_f32_32x32x16_bf16 v[64:79], v[188:191], a[156:159], v[64:79]
    ds_read_b64_tr_b16 v[182:183], v7 offset:10752
    v_mul_f32 v202, v112, v120
    v_mul_f32 v203, v113, v121
    s_waitcnt lgkmcnt(4)
    v_mfma_f32_32x32x16_bf16 v[16:31], v[192:195], a[160:163], v[16:31]
    ds_read_b64_tr_b16 v[184:185], v6 offset:16384
    v_add_f32 v200, 1.0, v200
    v_add_f32 v201, 1.0, v201
    v_mfma_f32_32x32x16_bf16 v[32:47], v[192:195], a[164:167], v[32:47]
    ds_read_b64_tr_b16 v[186:187], v6 offset:16896
    s_mul_i32 s61, s21, 294912
    s_add_u32 m0, s55, 65536
    s_add_u32 s61, s61, s58
    buffer_load_dwordx4 v2, s[32:35], s61 offen lds
    v_rcp_f32 v200, v200
    v_mfma_f32_32x32x16_bf16 v[48:63], v[196:199], a[160:163], v[48:63]
    ds_read_b64_tr_b16 v[188:189], v7 offset:16384
    v_rcp_f32 v201, v201
    v_mul_f32 v202, v202, v200
    v_mul_f32 v203, v203, v201
    v_mfma_f32_32x32x16_bf16 v[64:79], v[196:199], a[164:167], v[64:79]
    ds_read_b64_tr_b16 v[190:191], v7 offset:16896
    v_cvt_pk_bf16_f32 v216, v202, v203
    v_mul_f32 v204, v114, v114
    s_waitcnt lgkmcnt(4)
    v_mfma_f32_32x32x16_bf16 v[16:31], v[176:179], a[168:171], v[16:31]
    ds_read_b64_tr_b16 v[192:193], v6 offset:18432
    v_mul_f32 v205, v115, v115
    v_fma_f32 v204, v204, s64, v14
    v_mfma_f32_32x32x16_bf16 v[32:47], v[176:179], a[172:175], v[32:47]
    ds_read_b64_tr_b16 v[194:195], v6 offset:18944
    s_add_u32 m0, s55, 66560
    v_fma_f32 v205, v205, s64, v14
    buffer_load_dwordx4 v3, s[32:35], s61 offen lds
    v_mul_f32 v204, v204, v114
    v_mfma_f32_32x32x16_bf16 v[48:63], v[180:183], a[168:171], v[48:63]
    ds_read_b64_tr_b16 v[196:197], v7 offset:18432
    v_mul_f32 v205, v205, v115
    v_exp_f32 v204, v204
    v_mfma_f32_32x32x16_bf16 v[64:79], v[180:183], a[172:175], v[64:79]
    ds_read_b64_tr_b16 v[198:199], v7 offset:18944
    v_exp_f32 v205, v205
    v_mul_f32 v206, v114, v122
    s_waitcnt lgkmcnt(4)
    v_mfma_f32_32x32x16_bf16 v[16:31], v[184:187], a[176:179], v[16:31]
    s_waitcnt vmcnt(8)
    s_barrier
    ds_read_b64_tr_b16 v[176:177], v6 offset:24576
    v_mul_f32 v207, v115, v123
    v_add_f32 v204, 1.0, v204
    v_mfma_f32_32x32x16_bf16 v[32:47], v[184:187], a[180:183], v[32:47]
    ds_read_b64_tr_b16 v[178:179], v6 offset:25088
    s_mul_i32 s61, s4, 294912
    s_add_u32 m0, s55, 0
    s_add_u32 s61, s61, s59
    buffer_load_dwordx4 v2, s[32:35], s61 offen lds
    v_add_f32 v205, 1.0, v205
    v_mfma_f32_32x32x16_bf16 v[48:63], v[188:191], a[176:179], v[48:63]
    ds_read_b64_tr_b16 v[180:181], v7 offset:24576
    v_rcp_f32 v204, v204
    v_rcp_f32 v205, v205
    v_mul_f32 v206, v206, v204
    v_mfma_f32_32x32x16_bf16 v[64:79], v[188:191], a[180:183], v[64:79]
    ds_read_b64_tr_b16 v[182:183], v7 offset:25088
    v_mul_f32 v207, v207, v205
    v_cvt_pk_bf16_f32 v217, v206, v207
    s_waitcnt lgkmcnt(4)
    v_mfma_f32_32x32x16_bf16 v[16:31], v[192:195], a[184:187], v[16:31]
    ds_read_b64_tr_b16 v[184:185], v6 offset:26624
    v_mul_f32 v200, v116, v116
    v_mul_f32 v201, v117, v117
    v_mfma_f32_32x32x16_bf16 v[32:47], v[192:195], a[188:191], v[32:47]
    ds_read_b64_tr_b16 v[186:187], v6 offset:27136
    s_add_u32 m0, s55, 1024
    v_fma_f32 v200, v200, s64, v14
    buffer_load_dwordx4 v3, s[32:35], s61 offen lds
    v_fma_f32 v201, v201, s64, v14
    v_mfma_f32_32x32x16_bf16 v[48:63], v[196:199], a[184:187], v[48:63]
    ds_read_b64_tr_b16 v[188:189], v7 offset:26624
    v_mul_f32 v200, v200, v116
    v_mul_f32 v201, v201, v117
    v_mfma_f32_32x32x16_bf16 v[64:79], v[196:199], a[188:191], v[64:79]
    ds_read_b64_tr_b16 v[190:191], v7 offset:27136
    v_exp_f32 v200, v200
    v_exp_f32 v201, v201
    s_waitcnt lgkmcnt(4)
    v_mfma_f32_32x32x16_bf16 v[16:31], v[176:179], a[192:195], v[16:31]
    ds_read_b64_tr_b16 v[192:193], v6 offset:32768
    v_mul_f32 v202, v116, v124
    v_mul_f32 v203, v117, v125
    v_mfma_f32_32x32x16_bf16 v[32:47], v[176:179], a[196:199], v[32:47]
    ds_read_b64_tr_b16 v[194:195], v6 offset:33280
    s_mul_i32 s61, s5, 294912
    s_add_u32 m0, s55, 8192
    s_add_u32 s61, s61, s59
    buffer_load_dwordx4 v2, s[32:35], s61 offen lds
    v_add_f32 v200, 1.0, v200
    v_mfma_f32_32x32x16_bf16 v[48:63], v[180:183], a[192:195], v[48:63]
    ds_read_b64_tr_b16 v[196:197], v7 offset:32768
    v_add_f32 v201, 1.0, v201
    v_rcp_f32 v200, v200
    v_rcp_f32 v201, v201
    v_mfma_f32_32x32x16_bf16 v[64:79], v[180:183], a[196:199], v[64:79]
    ds_read_b64_tr_b16 v[198:199], v7 offset:33280
    v_mul_f32 v202, v202, v200
    v_mul_f32 v203, v203, v201
    s_waitcnt lgkmcnt(4)
    v_mfma_f32_32x32x16_bf16 v[16:31], v[184:187], a[200:203], v[16:31]
    ds_read_b64_tr_b16 v[176:177], v6 offset:34816
    v_cvt_pk_bf16_f32 v218, v202, v203
    v_mul_f32 v204, v118, v118
    v_mfma_f32_32x32x16_bf16 v[32:47], v[184:187], a[204:207], v[32:47]
    ds_read_b64_tr_b16 v[178:179], v6 offset:35328
    s_add_u32 m0, s55, 9216
    v_mul_f32 v205, v119, v119
    buffer_load_dwordx4 v3, s[32:35], s61 offen lds
    v_fma_f32 v204, v204, s64, v14
    v_mfma_f32_32x32x16_bf16 v[48:63], v[188:191], a[200:203], v[48:63]
    ds_read_b64_tr_b16 v[180:181], v7 offset:34816
    v_fma_f32 v205, v205, s64, v14
    v_mul_f32 v204, v204, v118
    v_mfma_f32_32x32x16_bf16 v[64:79], v[188:191], a[204:207], v[64:79]
    ds_read_b64_tr_b16 v[182:183], v7 offset:35328
    v_mul_f32 v205, v205, v119
    v_exp_f32 v204, v204
    s_waitcnt lgkmcnt(4)
    v_mfma_f32_32x32x16_bf16 v[16:31], v[192:195], a[208:211], v[16:31]
    s_waitcnt vmcnt(8)
    s_barrier
    ds_read_b64_tr_b16 v[184:185], v6 offset:40960
    v_exp_f32 v205, v205
    v_mul_f32 v206, v118, v126
    v_mfma_f32_32x32x16_bf16 v[32:47], v[192:195], a[212:215], v[32:47]
    ds_read_b64_tr_b16 v[186:187], v6 offset:41472
    s_mul_i32 s61, s6, 294912
    s_add_u32 m0, s55, 16384
    s_add_u32 s61, s61, s59
    buffer_load_dwordx4 v2, s[32:35], s61 offen lds
    v_mul_f32 v207, v119, v127
    v_mfma_f32_32x32x16_bf16 v[48:63], v[196:199], a[208:211], v[48:63]
    ds_read_b64_tr_b16 v[188:189], v7 offset:40960
    v_add_f32 v204, 1.0, v204
    v_add_f32 v205, 1.0, v205
    v_rcp_f32 v204, v204
    v_mfma_f32_32x32x16_bf16 v[64:79], v[196:199], a[212:215], v[64:79]
    ds_read_b64_tr_b16 v[190:191], v7 offset:41472
    v_rcp_f32 v205, v205
    v_mul_f32 v206, v206, v204
    s_waitcnt lgkmcnt(4)
    v_mfma_f32_32x32x16_bf16 v[16:31], v[176:179], a[216:219], v[16:31]
    ds_read_b64_tr_b16 v[192:193], v6 offset:43008
    v_mul_f32 v207, v207, v205
    v_cvt_pk_bf16_f32 v219, v206, v207
    v_mfma_f32_32x32x16_bf16 v[32:47], v[176:179], a[220:223], v[32:47]
    ds_read_b64_tr_b16 v[194:195], v6 offset:43520
    s_add_u32 m0, s55, 17408
    ds_write_b128 v12, v[216:219] offset:5120
    buffer_load_dwordx4 v3, s[32:35], s61 offen lds
    v_mul_f32 v200, v128, v128
    v_mfma_f32_32x32x16_bf16 v[48:63], v[180:183], a[216:219], v[48:63]
    ds_read_b64_tr_b16 v[196:197], v7 offset:43008
    v_mul_f32 v201, v129, v129
    v_fma_f32 v200, v200, s64, v14
    v_mfma_f32_32x32x16_bf16 v[64:79], v[180:183], a[220:223], v[64:79]
    ds_read_b64_tr_b16 v[198:199], v7 offset:43520
    v_fma_f32 v201, v201, s64, v14
    v_mul_f32 v200, v200, v128
    s_waitcnt lgkmcnt(5)
    v_mfma_f32_32x32x16_bf16 v[16:31], v[184:187], a[224:227], v[16:31]
    ds_read_b64_tr_b16 v[176:177], v8 offset:0
    v_mul_f32 v201, v201, v129
    v_exp_f32 v200, v200
    v_mfma_f32_32x32x16_bf16 v[32:47], v[184:187], a[228:231], v[32:47]
    ds_read_b64_tr_b16 v[178:179], v8 offset:512
    s_mul_i32 s61, s7, 294912
    s_add_u32 m0, s55, 24576
    s_add_u32 s61, s61, s59
    buffer_load_dwordx4 v2, s[32:35], s61 offen lds
    v_exp_f32 v201, v201
    v_mfma_f32_32x32x16_bf16 v[48:63], v[188:191], a[224:227], v[48:63]
    ds_read_b64_tr_b16 v[180:181], v9 offset:0
    v_mul_f32 v202, v128, v136
    v_mul_f32 v203, v129, v137
    v_add_f32 v200, 1.0, v200
    v_mfma_f32_32x32x16_bf16 v[64:79], v[188:191], a[228:231], v[64:79]
    ds_read_b64_tr_b16 v[182:183], v9 offset:512
    v_add_f32 v201, 1.0, v201
    v_rcp_f32 v200, v200
    s_waitcnt lgkmcnt(4)
    v_mfma_f32_32x32x16_bf16 v[16:31], v[192:195], a[232:235], v[16:31]
    ds_read_b64_tr_b16 v[184:185], v8 offset:2048
    v_rcp_f32 v201, v201
    v_mul_f32 v202, v202, v200
    v_mfma_f32_32x32x16_bf16 v[32:47], v[192:195], a[236:239], v[32:47]
    ds_read_b64_tr_b16 v[186:187], v8 offset:2560
    s_add_u32 m0, s55, 25600
    v_mul_f32 v203, v203, v201
    buffer_load_dwordx4 v3, s[32:35], s61 offen lds
    v_cvt_pk_bf16_f32 v220, v202, v203
    v_mfma_f32_32x32x16_bf16 v[48:63], v[196:199], a[232:235], v[48:63]
    ds_read_b64_tr_b16 v[188:189], v9 offset:2048
    v_mul_f32 v204, v130, v130
    v_mul_f32 v205, v131, v131
    v_mfma_f32_32x32x16_bf16 v[64:79], v[196:199], a[236:239], v[64:79]
    ds_read_b64_tr_b16 v[190:191], v9 offset:2560
    v_fma_f32 v204, v204, s64, v14
    v_fma_f32 v205, v205, s64, v14
    s_waitcnt lgkmcnt(4)
    v_mfma_f32_32x32x16_bf16 v[16:31], v[176:179], a[240:243], v[16:31]
    s_waitcnt vmcnt(8)
    s_barrier
    ds_read_b64_tr_b16 v[192:193], v8 offset:8192
    v_mul_f32 v204, v204, v130
    v_mul_f32 v205, v205, v131
    v_mfma_f32_32x32x16_bf16 v[32:47], v[176:179], a[244:247], v[32:47]
    ds_read_b64_tr_b16 v[194:195], v8 offset:8704
    s_mul_i32 s61, s8, 294912
    s_add_u32 m0, s55, 32768
    s_add_u32 s61, s61, s59
    buffer_load_dwordx4 v2, s[32:35], s61 offen lds
    v_exp_f32 v204, v204
    v_mfma_f32_32x32x16_bf16 v[48:63], v[180:183], a[240:243], v[48:63]
    ds_read_b64_tr_b16 v[196:197], v9 offset:8192
    v_exp_f32 v205, v205
    v_mul_f32 v206, v130, v138
    v_mul_f32 v207, v131, v139
    v_mfma_f32_32x32x16_bf16 v[64:79], v[180:183], a[244:247], v[64:79]
    ds_read_b64_tr_b16 v[198:199], v9 offset:8704
    v_add_f32 v204, 1.0, v204
    v_add_f32 v205, 1.0, v205
    s_waitcnt lgkmcnt(4)
    v_mfma_f32_32x32x16_bf16 v[16:31], v[184:187], a[248:251], v[16:31]
    ds_read_b64_tr_b16 v[176:177], v8 offset:10240
    v_rcp_f32 v204, v204
    v_rcp_f32 v205, v205
    v_mfma_f32_32x32x16_bf16 v[32:47], v[184:187], a[252:255], v[32:47]
    ds_read_b64_tr_b16 v[178:179], v8 offset:10752
    s_add_u32 m0, s55, 33792
    v_mul_f32 v206, v206, v204
    buffer_load_dwordx4 v3, s[32:35], s61 offen lds
    v_mul_f32 v207, v207, v205
    v_mfma_f32_32x32x16_bf16 v[48:63], v[188:191], a[248:251], v[48:63]
    ds_read_b64_tr_b16 v[180:181], v9 offset:10240
    v_cvt_pk_bf16_f32 v221, v206, v207
    v_mul_f32 v200, v132, v132
    v_mfma_f32_32x32x16_bf16 v[64:79], v[188:191], a[252:255], v[64:79]
    ds_read_b64_tr_b16 v[182:183], v9 offset:10752
    v_mul_f32 v201, v133, v133
    v_fma_f32 v200, v200, s64, v14
    s_waitcnt lgkmcnt(4)
    v_mfma_f32_32x32x16_bf16 v[16:31], v[192:195], v[144:147], v[16:31]
    ds_read_b64_tr_b16 v[184:185], v8 offset:16384
    v_fma_f32 v201, v201, s64, v14
    v_mul_f32 v200, v200, v132
    v_mfma_f32_32x32x16_bf16 v[32:47], v[192:195], v[148:151], v[32:47]
    ds_read_b64_tr_b16 v[186:187], v8 offset:16896
    s_mul_i32 s61, s9, 294912
    s_add_u32 m0, s55, 40960
    s_add_u32 s61, s61, s59
    buffer_load_dwordx4 v2, s[32:35], s61 offen lds
    v_mul_f32 v201, v201, v133
    v_mfma_f32_32x32x16_bf16 v[48:63], v[196:199], v[144:147], v[48:63]
    ds_read_b64_tr_b16 v[188:189], v9 offset:16384
    v_exp_f32 v200, v200
    v_exp_f32 v201, v201
    v_mul_f32 v202, v132, v140
    v_mfma_f32_32x32x16_bf16 v[64:79], v[196:199], v[148:151], v[64:79]
    ds_read_b64_tr_b16 v[190:191], v9 offset:16896
    v_mul_f32 v203, v133, v141
    v_add_f32 v200, 1.0, v200
    s_waitcnt lgkmcnt(4)
    v_mfma_f32_32x32x16_bf16 v[16:31], v[176:179], v[152:155], v[16:31]
    ds_read_b64_tr_b16 v[192:193], v8 offset:18432
    v_add_f32 v201, 1.0, v201
    v_rcp_f32 v200, v200
    v_mfma_f32_32x32x16_bf16 v[32:47], v[176:179], v[156:159], v[32:47]
    ds_read_b64_tr_b16 v[194:195], v8 offset:18944
    s_add_u32 m0, s55, 41984
    v_rcp_f32 v201, v201
    buffer_load_dwordx4 v3, s[32:35], s61 offen lds
    v_mul_f32 v202, v202, v200
    v_mfma_f32_32x32x16_bf16 v[48:63], v[180:183], v[152:155], v[48:63]
    ds_read_b64_tr_b16 v[196:197], v9 offset:18432
    v_mul_f32 v203, v203, v201
    v_cvt_pk_bf16_f32 v222, v202, v203
    v_mfma_f32_32x32x16_bf16 v[64:79], v[180:183], v[156:159], v[64:79]
    ds_read_b64_tr_b16 v[198:199], v9 offset:18944
    v_mul_f32 v204, v134, v134
    v_mul_f32 v205, v135, v135
    s_waitcnt lgkmcnt(4)
    v_mfma_f32_32x32x16_bf16 v[16:31], v[184:187], v[160:163], v[16:31]
    s_waitcnt vmcnt(8)
    s_barrier
    ds_read_b64_tr_b16 v[176:177], v6 offset:0
    v_fma_f32 v204, v204, s64, v14
    v_fma_f32 v205, v205, s64, v14
    v_mfma_f32_32x32x16_bf16 v[32:47], v[184:187], v[164:167], v[32:47]
    ds_read_b64_tr_b16 v[178:179], v6 offset:512
    s_mul_i32 s61, s10, 294912
    s_add_u32 m0, s55, 49152
    s_add_u32 s61, s61, s59
    buffer_load_dwordx4 v2, s[32:35], s61 offen lds
    v_mul_f32 v204, v204, v134
    v_mfma_f32_32x32x16_bf16 v[48:63], v[188:191], v[160:163], v[48:63]
    ds_read_b64_tr_b16 v[180:181], v7 offset:0
    v_mul_f32 v205, v205, v135
    v_exp_f32 v204, v204
    v_exp_f32 v205, v205
    v_mfma_f32_32x32x16_bf16 v[64:79], v[188:191], v[164:167], v[64:79]
    ds_read_b64_tr_b16 v[182:183], v7 offset:512
    v_mul_f32 v206, v134, v142
    v_mul_f32 v207, v135, v143
    s_waitcnt lgkmcnt(4)
    v_mfma_f32_32x32x16_bf16 v[16:31], v[192:195], v[168:171], v[16:31]
    ds_read_b64_tr_b16 v[184:185], v6 offset:2048
    v_add_f32 v204, 1.0, v204
    v_add_f32 v205, 1.0, v205
    v_mfma_f32_32x32x16_bf16 v[32:47], v[192:195], v[172:175], v[32:47]
    ds_read_b64_tr_b16 v[186:187], v6 offset:2560
    s_add_u32 m0, s55, 50176
    v_rcp_f32 v204, v204
    buffer_load_dwordx4 v3, s[32:35], s61 offen lds
    v_rcp_f32 v205, v205
    v_mfma_f32_32x32x16_bf16 v[48:63], v[196:199], v[168:171], v[48:63]
    ds_read_b64_tr_b16 v[188:189], v7 offset:2048
    v_mul_f32 v206, v206, v204
    v_mul_f32 v207, v207, v205
    v_mfma_f32_32x32x16_bf16 v[64:79], v[196:199], v[172:175], v[64:79]
    ds_read_b64_tr_b16 v[190:191], v7 offset:2560
    v_cvt_pk_bf16_f32 v223, v206, v207
    ds_write_b128 v12, v[220:223] offset:23552
    s_waitcnt lgkmcnt(5)
    v_mfma_f32_32x32x16_bf16 v[80:95], v[176:179], a[0:3], 0
    ds_read_b64_tr_b16 v[192:193], v6 offset:8192
    s_mul_i32 s61, s11, 294912
    s_add_u32 m0, s55, 57344
    s_add_u32 s61, s61, s59
    buffer_load_dwordx4 v2, s[32:35], s61 offen lds
    v_mfma_f32_32x32x16_bf16 v[96:111], v[176:179], a[4:7], 0
    ds_read_b64_tr_b16 v[194:195], v6 offset:8704
    v_mfma_f32_32x32x16_bf16 v[112:127], v[180:183], a[0:3], 0
    ds_read_b64_tr_b16 v[196:197], v7 offset:8192
    v_mfma_f32_32x32x16_bf16 v[128:143], v[180:183], a[4:7], 0
    ds_read_b64_tr_b16 v[198:199], v7 offset:8704
    s_waitcnt lgkmcnt(5)
    v_mfma_f32_32x32x16_bf16 v[80:95], v[184:187], a[8:11], v[80:95]
    ds_read_b64_tr_b16 v[176:177], v6 offset:10240
    s_add_u32 m0, s55, 58368
    s_nop 0
    buffer_load_dwordx4 v3, s[32:35], s61 offen lds
    v_mfma_f32_32x32x16_bf16 v[96:111], v[184:187], a[12:15], v[96:111]
    ds_read_b64_tr_b16 v[178:179], v6 offset:10752
    v_mfma_f32_32x32x16_bf16 v[112:127], v[188:191], a[8:11], v[112:127]
    ds_read_b64_tr_b16 v[180:181], v7 offset:10240
    v_mul_f32 v200, v16, v16
    v_mul_f32 v201, v17, v17
    v_mfma_f32_32x32x16_bf16 v[128:143], v[188:191], a[12:15], v[128:143]
    ds_read_b64_tr_b16 v[182:183], v7 offset:10752
    v_fma_f32 v200, v200, s64, v14
    v_fma_f32 v201, v201, s64, v14
    s_waitcnt lgkmcnt(4)
    v_mfma_f32_32x32x16_bf16 v[80:95], v[192:195], a[16:19], v[80:95]
    s_waitcnt vmcnt(8)
    s_barrier
    ds_read_b64_tr_b16 v[184:185], v6 offset:16384
    v_mul_f32 v200, v200, v16
    v_mul_f32 v201, v201, v17
    v_mfma_f32_32x32x16_bf16 v[96:111], v[192:195], a[20:23], v[96:111]
    ds_read_b64_tr_b16 v[186:187], v6 offset:16896
    s_mul_i32 s61, s12, 294912
    s_add_u32 m0, s55, 65536
    s_add_u32 s61, s61, s59
    buffer_load_dwordx4 v2, s[32:35], s61 offen lds
    v_exp_f32 v200, v200
    v_mfma_f32_32x32x16_bf16 v[112:127], v[196:199], a[16:19], v[112:127]
    ds_read_b64_tr_b16 v[188:189], v7 offset:16384
    v_exp_f32 v201, v201
    v_mul_f32 v202, v16, v24
    v_mul_f32 v203, v17, v25
    v_mfma_f32_32x32x16_bf16 v[128:143], v[196:199], a[20:23], v[128:143]
    ds_read_b64_tr_b16 v[190:191], v7 offset:16896
    v_add_f32 v200, 1.0, v200
    v_add_f32 v201, 1.0, v201
    s_waitcnt lgkmcnt(4)
    v_mfma_f32_32x32x16_bf16 v[80:95], v[176:179], a[24:27], v[80:95]
    ds_read_b64_tr_b16 v[192:193], v6 offset:18432
    v_rcp_f32 v200, v200
    v_rcp_f32 v201, v201
    v_mfma_f32_32x32x16_bf16 v[96:111], v[176:179], a[28:31], v[96:111]
    ds_read_b64_tr_b16 v[194:195], v6 offset:18944
    s_add_u32 m0, s55, 66560
    v_mul_f32 v202, v202, v200
    buffer_load_dwordx4 v3, s[32:35], s61 offen lds
    v_mul_f32 v203, v203, v201
    v_mfma_f32_32x32x16_bf16 v[112:127], v[180:183], a[24:27], v[112:127]
    ds_read_b64_tr_b16 v[196:197], v7 offset:18432
    v_cvt_pk_bf16_f32 v216, v202, v203
    v_mul_f32 v204, v18, v18
    v_mfma_f32_32x32x16_bf16 v[128:143], v[180:183], a[28:31], v[128:143]
    ds_read_b64_tr_b16 v[198:199], v7 offset:18944
    v_mul_f32 v205, v19, v19
    v_fma_f32 v204, v204, s64, v14
    s_waitcnt lgkmcnt(4)
    v_mfma_f32_32x32x16_bf16 v[80:95], v[184:187], a[32:35], v[80:95]
    ds_read_b64_tr_b16 v[176:177], v6 offset:24576
    v_fma_f32 v205, v205, s64, v14
    v_mul_f32 v204, v204, v18
    v_mfma_f32_32x32x16_bf16 v[96:111], v[184:187], a[36:39], v[96:111]
    ds_read_b64_tr_b16 v[178:179], v6 offset:25088
    s_mul_i32 s61, s13, 294912
    s_add_u32 m0, s55, 0
    s_add_u32 s61, s61, s59
    buffer_load_dwordx4 v2, s[32:35], s61 offen lds
    v_mul_f32 v205, v205, v19
    v_mfma_f32_32x32x16_bf16 v[112:127], v[188:191], a[32:35], v[112:127]
    ds_read_b64_tr_b16 v[180:181], v7 offset:24576
    v_exp_f32 v204, v204
    v_exp_f32 v205, v205
    v_mul_f32 v206, v18, v26
    v_mfma_f32_32x32x16_bf16 v[128:143], v[188:191], a[36:39], v[128:143]
    ds_read_b64_tr_b16 v[182:183], v7 offset:25088
    v_mul_f32 v207, v19, v27
    v_add_f32 v204, 1.0, v204
    s_waitcnt lgkmcnt(4)
    v_mfma_f32_32x32x16_bf16 v[80:95], v[192:195], a[40:43], v[80:95]
    ds_read_b64_tr_b16 v[184:185], v6 offset:26624
    v_add_f32 v205, 1.0, v205
    v_rcp_f32 v204, v204
    v_mfma_f32_32x32x16_bf16 v[96:111], v[192:195], a[44:47], v[96:111]
    ds_read_b64_tr_b16 v[186:187], v6 offset:27136
    s_add_u32 m0, s55, 1024
    v_rcp_f32 v205, v205
    buffer_load_dwordx4 v3, s[32:35], s61 offen lds
    v_mul_f32 v206, v206, v204
    v_mfma_f32_32x32x16_bf16 v[112:127], v[196:199], a[40:43], v[112:127]
    ds_read_b64_tr_b16 v[188:189], v7 offset:26624
    v_mul_f32 v207, v207, v205
    v_cvt_pk_bf16_f32 v217, v206, v207
    v_mfma_f32_32x32x16_bf16 v[128:143], v[196:199], a[44:47], v[128:143]
    ds_read_b64_tr_b16 v[190:191], v7 offset:27136
    v_mul_f32 v200, v20, v20
    v_mul_f32 v201, v21, v21
    s_waitcnt lgkmcnt(4)
    v_mfma_f32_32x32x16_bf16 v[80:95], v[176:179], a[48:51], v[80:95]
    s_waitcnt vmcnt(8)
    s_barrier
    ds_read_b64_tr_b16 v[192:193], v6 offset:32768
    v_fma_f32 v200, v200, s64, v14
    v_fma_f32 v201, v201, s64, v14
    v_mfma_f32_32x32x16_bf16 v[96:111], v[176:179], a[52:55], v[96:111]
    ds_read_b64_tr_b16 v[194:195], v6 offset:33280
    s_mul_i32 s61, s14, 294912
    s_add_u32 m0, s55, 8192
    s_add_u32 s61, s61, s59
    buffer_load_dwordx4 v2, s[32:35], s61 offen lds
    v_mul_f32 v200, v200, v20
    v_mfma_f32_32x32x16_bf16 v[112:127], v[180:183], a[48:51], v[112:127]
    ds_read_b64_tr_b16 v[196:197], v7 offset:32768
    v_mul_f32 v201, v201, v21
    v_exp_f32 v200, v200
    v_exp_f32 v201, v201
    v_mfma_f32_32x32x16_bf16 v[128:143], v[180:183], a[52:55], v[128:143]
    ds_read_b64_tr_b16 v[198:199], v7 offset:33280
    v_mul_f32 v202, v20, v28
    v_mul_f32 v203, v21, v29
    s_waitcnt lgkmcnt(4)
    v_mfma_f32_32x32x16_bf16 v[80:95], v[184:187], a[56:59], v[80:95]
    ds_read_b64_tr_b16 v[176:177], v6 offset:34816
    v_add_f32 v200, 1.0, v200
    v_add_f32 v201, 1.0, v201
    v_mfma_f32_32x32x16_bf16 v[96:111], v[184:187], a[60:63], v[96:111]
    ds_read_b64_tr_b16 v[178:179], v6 offset:35328
    s_add_u32 m0, s55, 9216
    v_rcp_f32 v200, v200
    buffer_load_dwordx4 v3, s[32:35], s61 offen lds
    v_rcp_f32 v201, v201
    v_mfma_f32_32x32x16_bf16 v[112:127], v[188:191], a[56:59], v[112:127]
    ds_read_b64_tr_b16 v[180:181], v7 offset:34816
    v_mul_f32 v202, v202, v200
    v_mul_f32 v203, v203, v201
    v_mfma_f32_32x32x16_bf16 v[128:143], v[188:191], a[60:63], v[128:143]
    ds_read_b64_tr_b16 v[182:183], v7 offset:35328
    v_cvt_pk_bf16_f32 v218, v202, v203
    v_mul_f32 v204, v22, v22
    s_waitcnt lgkmcnt(4)
    v_mfma_f32_32x32x16_bf16 v[80:95], v[192:195], a[64:67], v[80:95]
    ds_read_b64_tr_b16 v[184:185], v6 offset:40960
    v_mul_f32 v205, v23, v23
    v_fma_f32 v204, v204, s64, v14
    v_mfma_f32_32x32x16_bf16 v[96:111], v[192:195], a[68:71], v[96:111]
    ds_read_b64_tr_b16 v[186:187], v6 offset:41472
    s_mul_i32 s61, s15, 294912
    s_add_u32 m0, s55, 16384
    s_add_u32 s61, s61, s59
    buffer_load_dwordx4 v2, s[32:35], s61 offen lds
    v_fma_f32 v205, v205, s64, v14
    v_mfma_f32_32x32x16_bf16 v[112:127], v[196:199], a[64:67], v[112:127]
    ds_read_b64_tr_b16 v[188:189], v7 offset:40960
    v_mul_f32 v204, v204, v22
    v_mul_f32 v205, v205, v23
    v_exp_f32 v204, v204
    v_mfma_f32_32x32x16_bf16 v[128:143], v[196:199], a[68:71], v[128:143]
    ds_read_b64_tr_b16 v[190:191], v7 offset:41472
    v_exp_f32 v205, v205
    v_mul_f32 v206, v22, v30
    s_waitcnt lgkmcnt(4)
    v_mfma_f32_32x32x16_bf16 v[80:95], v[176:179], a[72:75], v[80:95]
    ds_read_b64_tr_b16 v[192:193], v6 offset:43008
    v_mul_f32 v207, v23, v31
    v_add_f32 v204, 1.0, v204
    v_mfma_f32_32x32x16_bf16 v[96:111], v[176:179], a[76:79], v[96:111]
    ds_read_b64_tr_b16 v[194:195], v6 offset:43520
    s_add_u32 m0, s55, 17408
    v_add_f32 v205, 1.0, v205
    buffer_load_dwordx4 v3, s[32:35], s61 offen lds
    v_rcp_f32 v204, v204
    v_mfma_f32_32x32x16_bf16 v[112:127], v[180:183], a[72:75], v[112:127]
    ds_read_b64_tr_b16 v[196:197], v7 offset:43008
    v_rcp_f32 v205, v205
    v_mul_f32 v206, v206, v204
    v_mfma_f32_32x32x16_bf16 v[128:143], v[180:183], a[76:79], v[128:143]
    ds_read_b64_tr_b16 v[198:199], v7 offset:43520
    v_mul_f32 v207, v207, v205
    v_cvt_pk_bf16_f32 v219, v206, v207
    s_waitcnt lgkmcnt(4)
    v_mfma_f32_32x32x16_bf16 v[80:95], v[184:187], a[80:83], v[80:95]
    s_waitcnt vmcnt(8)
    s_barrier
    ds_read_b64_tr_b16 v[176:177], v8 offset:0
    ds_write_b128 v12, v[216:219] offset:8192
    v_mul_f32 v200, v32, v32
    v_mfma_f32_32x32x16_bf16 v[96:111], v[184:187], a[84:87], v[96:111]
    ds_read_b64_tr_b16 v[178:179], v8 offset:512
    s_mul_i32 s61, s16, 294912
    s_add_u32 m0, s55, 24576
    s_add_u32 s61, s61, s59
    buffer_load_dwordx4 v2, s[32:35], s61 offen lds
    v_mul_f32 v201, v33, v33
    v_mfma_f32_32x32x16_bf16 v[112:127], v[188:191], a[80:83], v[112:127]
    ds_read_b64_tr_b16 v[180:181], v9 offset:0
    v_fma_f32 v200, v200, s64, v14
    v_fma_f32 v201, v201, s64, v14
    v_mul_f32 v200, v200, v32
    v_mfma_f32_32x32x16_bf16 v[128:143], v[188:191], a[84:87], v[128:143]
    ds_read_b64_tr_b16 v[182:183], v9 offset:512
    v_mul_f32 v201, v201, v33
    v_exp_f32 v200, v200
    s_waitcnt lgkmcnt(5)
    v_mfma_f32_32x32x16_bf16 v[80:95], v[192:195], a[88:91], v[80:95]
    ds_read_b64_tr_b16 v[184:185], v8 offset:2048
    v_exp_f32 v201, v201
    v_mul_f32 v202, v32, v40
    v_mfma_f32_32x32x16_bf16 v[96:111], v[192:195], a[92:95], v[96:111]
    ds_read_b64_tr_b16 v[186:187], v8 offset:2560
    s_add_u32 m0, s55, 25600
    v_mul_f32 v203, v33, v41
    buffer_load_dwordx4 v3, s[32:35], s61 offen lds
    v_add_f32 v200, 1.0, v200
    v_mfma_f32_32x32x16_bf16 v[112:127], v[196:199], a[88:91], v[112:127]
    ds_read_b64_tr_b16 v[188:189], v9 offset:2048
    v_add_f32 v201, 1.0, v201
    v_rcp_f32 v200, v200
    v_mfma_f32_32x32x16_bf16 v[128:143], v[196:199], a[92:95], v[128:143]
    ds_read_b64_tr_b16 v[190:191], v9 offset:2560
    v_rcp_f32 v201, v201
    v_mul_f32 v202, v202, v200
    s_waitcnt lgkmcnt(4)
    v_mfma_f32_32x32x16_bf16 v[80:95], v[176:179], a[96:99], v[80:95]
    ds_read_b64_tr_b16 v[192:193], v8 offset:8192
    v_mul_f32 v203, v203, v201
    v_cvt_pk_bf16_f32 v220, v202, v203
    v_mfma_f32_32x32x16_bf16 v[96:111], v[176:179], a[100:103], v[96:111]
    ds_read_b64_tr_b16 v[194:195], v8 offset:8704
    s_mul_i32 s61, s17, 294912
    s_add_u32 m0, s55, 32768
    s_add_u32 s61, s61, s59
    buffer_load_dwordx4 v2, s[32:35], s61 offen lds
    v_mul_f32 v204, v34, v34
    v_mfma_f32_32x32x16_bf16 v[112:127], v[180:183], a[96:99], v[112:127]
    ds_read_b64_tr_b16 v[196:197], v9 offset:8192
    v_mul_f32 v205, v35, v35
    v_fma_f32 v204, v204, s64, v14
    v_fma_f32 v205, v205, s64, v14
    v_mfma_f32_32x32x16_bf16 v[128:143], v[180:183], a[100:103], v[128:143]
    ds_read_b64_tr_b16 v[198:199], v9 offset:8704
    v_mul_f32 v204, v204, v34
    v_mul_f32 v205, v205, v35
    s_waitcnt lgkmcnt(4)
    v_mfma_f32_32x32x16_bf16 v[80:95], v[184:187], a[104:107], v[80:95]
    ds_read_b64_tr_b16 v[176:177], v8 offset:10240
    v_exp_f32 v204, v204
    v_exp_f32 v205, v205
    v_mfma_f32_32x32x16_bf16 v[96:111], v[184:187], a[108:111], v[96:111]
    ds_read_b64_tr_b16 v[178:179], v8 offset:10752
    s_add_u32 m0, s55, 33792
    v_mul_f32 v206, v34, v42
    buffer_load_dwordx4 v3, s[32:35], s61 offen lds
    v_mul_f32 v207, v35, v43
    v_mfma_f32_32x32x16_bf16 v[112:127], v[188:191], a[104:107], v[112:127]
    ds_read_b64_tr_b16 v[180:181], v9 offset:10240
    v_add_f32 v204, 1.0, v204
    v_add_f32 v205, 1.0, v205
    v_mfma_f32_32x32x16_bf16 v[128:143], v[188:191], a[108:111], v[128:143]
    ds_read_b64_tr_b16 v[182:183], v9 offset:10752
    v_rcp_f32 v204, v204
    v_rcp_f32 v205, v205
    s_waitcnt lgkmcnt(4)
    v_mfma_f32_32x32x16_bf16 v[80:95], v[192:195], a[112:115], v[80:95]
    s_waitcnt vmcnt(8)
    s_barrier
    ds_read_b64_tr_b16 v[184:185], v8 offset:16384
    v_mul_f32 v206, v206, v204
    v_mul_f32 v207, v207, v205
    v_mfma_f32_32x32x16_bf16 v[96:111], v[192:195], a[116:119], v[96:111]
    ds_read_b64_tr_b16 v[186:187], v8 offset:16896
    s_mul_i32 s61, s18, 294912
    s_add_u32 m0, s55, 40960
    s_add_u32 s61, s61, s59
    buffer_load_dwordx4 v2, s[32:35], s61 offen lds
    v_cvt_pk_bf16_f32 v221, v206, v207
    v_mfma_f32_32x32x16_bf16 v[112:127], v[196:199], a[112:115], v[112:127]
    ds_read_b64_tr_b16 v[188:189], v9 offset:16384
    v_mul_f32 v200, v36, v36
    v_mul_f32 v201, v37, v37
    v_fma_f32 v200, v200, s64, v14
    v_mfma_f32_32x32x16_bf16 v[128:143], v[196:199], a[116:119], v[128:143]
    ds_read_b64_tr_b16 v[190:191], v9 offset:16896
    v_fma_f32 v201, v201, s64, v14
    v_mul_f32 v200, v200, v36
    s_waitcnt lgkmcnt(4)
    v_mfma_f32_32x32x16_bf16 v[80:95], v[176:179], a[120:123], v[80:95]
    ds_read_b64_tr_b16 v[192:193], v8 offset:18432
    v_mul_f32 v201, v201, v37
    v_exp_f32 v200, v200
    v_mfma_f32_32x32x16_bf16 v[96:111], v[176:179], a[124:127], v[96:111]
    ds_read_b64_tr_b16 v[194:195], v8 offset:18944
    s_add_u32 m0, s55, 41984
    v_exp_f32 v201, v201
    buffer_load_dwordx4 v3, s[32:35], s61 offen lds
    v_mul_f32 v202, v36, v44
    v_mfma_f32_32x32x16_bf16 v[112:127], v[180:183], a[120:123], v[112:127]
    ds_read_b64_tr_b16 v[196:197], v9 offset:18432
    v_mul_f32 v203, v37, v45
    v_add_f32 v200, 1.0, v200
    v_mfma_f32_32x32x16_bf16 v[128:143], v[180:183], a[124:127], v[128:143]
    ds_read_b64_tr_b16 v[198:199], v9 offset:18944
    v_add_f32 v201, 1.0, v201
    v_rcp_f32 v200, v200
    s_waitcnt lgkmcnt(4)
    v_mfma_f32_32x32x16_bf16 v[80:95], v[184:187], a[128:131], v[80:95]
    ds_read_b64_tr_b16 v[176:177], v6 offset:0
    v_rcp_f32 v201, v201
    v_mul_f32 v202, v202, v200
    v_mfma_f32_32x32x16_bf16 v[96:111], v[184:187], a[132:135], v[96:111]
    ds_read_b64_tr_b16 v[178:179], v6 offset:512
    s_mul_i32 s61, s19, 294912
    s_add_u32 m0, s55, 49152
    s_add_u32 s61, s61, s59
    buffer_load_dwordx4 v2, s[32:35], s61 offen lds
    v_mul_f32 v203, v203, v201
    v_mfma_f32_32x32x16_bf16 v[112:127], v[188:191], a[128:131], v[112:127]
    ds_read_b64_tr_b16 v[180:181], v7 offset:0
    v_cvt_pk_bf16_f32 v222, v202, v203
    v_mul_f32 v204, v38, v38
    v_mul_f32 v205, v39, v39
    v_mfma_f32_32x32x16_bf16 v[128:143], v[188:191], a[132:135], v[128:143]
    ds_read_b64_tr_b16 v[182:183], v7 offset:512
    v_fma_f32 v204, v204, s64, v14
    v_fma_f32 v205, v205, s64, v14
    s_waitcnt lgkmcnt(4)
    v_mfma_f32_32x32x16_bf16 v[80:95], v[192:195], a[136:139], v[80:95]
    ds_read_b64_tr_b16 v[184:185], v6 offset:2048
    v_mul_f32 v204, v204, v38
    v_mul_f32 v205, v205, v39
    v_mfma_f32_32x32x16_bf16 v[96:111], v[192:195], a[140:143], v[96:111]
    ds_read_b64_tr_b16 v[186:187], v6 offset:2560
    s_add_u32 m0, s55, 50176
    v_exp_f32 v204, v204
    buffer_load_dwordx4 v3, s[32:35], s61 offen lds
    v_exp_f32 v205, v205
    v_mfma_f32_32x32x16_bf16 v[112:127], v[196:199], a[136:139], v[112:127]
    ds_read_b64_tr_b16 v[188:189], v7 offset:2048
    v_mul_f32 v206, v38, v46
    v_mul_f32 v207, v39, v47
    v_mfma_f32_32x32x16_bf16 v[128:143], v[196:199], a[140:143], v[128:143]
    ds_read_b64_tr_b16 v[190:191], v7 offset:2560
    v_add_f32 v204, 1.0, v204
    v_add_f32 v205, 1.0, v205
    s_waitcnt lgkmcnt(4)
    v_mfma_f32_32x32x16_bf16 v[80:95], v[176:179], a[144:147], v[80:95]
    s_waitcnt vmcnt(8)
    s_barrier
    ds_read_b64_tr_b16 v[192:193], v6 offset:8192
    v_rcp_f32 v204, v204
    v_rcp_f32 v205, v205
    v_mfma_f32_32x32x16_bf16 v[96:111], v[176:179], a[148:151], v[96:111]
    ds_read_b64_tr_b16 v[194:195], v6 offset:8704
    s_mul_i32 s61, s20, 294912
    s_add_u32 m0, s55, 57344
    s_add_u32 s61, s61, s59
    buffer_load_dwordx4 v2, s[32:35], s61 offen lds
    v_mul_f32 v206, v206, v204
    v_mfma_f32_32x32x16_bf16 v[112:127], v[180:183], a[144:147], v[112:127]
    ds_read_b64_tr_b16 v[196:197], v7 offset:8192
    v_mul_f32 v207, v207, v205
    v_cvt_pk_bf16_f32 v223, v206, v207
    ds_write_b128 v12, v[220:223] offset:26624
    v_mfma_f32_32x32x16_bf16 v[128:143], v[180:183], a[148:151], v[128:143]
    ds_read_b64_tr_b16 v[198:199], v7 offset:8704
    v_mul_f32 v200, v48, v48
    v_mul_f32 v201, v49, v49
    s_waitcnt lgkmcnt(5)
    v_mfma_f32_32x32x16_bf16 v[80:95], v[184:187], a[152:155], v[80:95]
    ds_read_b64_tr_b16 v[176:177], v6 offset:10240
    v_fma_f32 v200, v200, s64, v14
    v_fma_f32 v201, v201, s64, v14
    v_mfma_f32_32x32x16_bf16 v[96:111], v[184:187], a[156:159], v[96:111]
    ds_read_b64_tr_b16 v[178:179], v6 offset:10752
    s_add_u32 m0, s55, 58368
    v_mul_f32 v200, v200, v48
    buffer_load_dwordx4 v3, s[32:35], s61 offen lds
    v_mul_f32 v201, v201, v49
    v_mfma_f32_32x32x16_bf16 v[112:127], v[188:191], a[152:155], v[112:127]
    ds_read_b64_tr_b16 v[180:181], v7 offset:10240
    v_exp_f32 v200, v200
    v_exp_f32 v201, v201
    v_mfma_f32_32x32x16_bf16 v[128:143], v[188:191], a[156:159], v[128:143]
    ds_read_b64_tr_b16 v[182:183], v7 offset:10752
    v_mul_f32 v202, v48, v56
    v_mul_f32 v203, v49, v57
    s_waitcnt lgkmcnt(4)
    v_mfma_f32_32x32x16_bf16 v[80:95], v[192:195], a[160:163], v[80:95]
    ds_read_b64_tr_b16 v[184:185], v6 offset:16384
    v_add_f32 v200, 1.0, v200
    v_add_f32 v201, 1.0, v201
    v_mfma_f32_32x32x16_bf16 v[96:111], v[192:195], a[164:167], v[96:111]
    ds_read_b64_tr_b16 v[186:187], v6 offset:16896
    s_mul_i32 s61, s21, 294912
    s_add_u32 m0, s55, 65536
    s_add_u32 s61, s61, s59
    buffer_load_dwordx4 v2, s[32:35], s61 offen lds
    v_rcp_f32 v200, v200
    v_mfma_f32_32x32x16_bf16 v[112:127], v[196:199], a[160:163], v[112:127]
    ds_read_b64_tr_b16 v[188:189], v7 offset:16384
    v_rcp_f32 v201, v201
    v_mul_f32 v202, v202, v200
    v_mul_f32 v203, v203, v201
    v_mfma_f32_32x32x16_bf16 v[128:143], v[196:199], a[164:167], v[128:143]
    ds_read_b64_tr_b16 v[190:191], v7 offset:16896
    v_cvt_pk_bf16_f32 v216, v202, v203
    v_mul_f32 v204, v50, v50
    s_waitcnt lgkmcnt(4)
    v_mfma_f32_32x32x16_bf16 v[80:95], v[176:179], a[168:171], v[80:95]
    ds_read_b64_tr_b16 v[192:193], v6 offset:18432
    v_mul_f32 v205, v51, v51
    v_fma_f32 v204, v204, s64, v14
    v_mfma_f32_32x32x16_bf16 v[96:111], v[176:179], a[172:175], v[96:111]
    ds_read_b64_tr_b16 v[194:195], v6 offset:18944
    s_add_u32 m0, s55, 66560
    v_fma_f32 v205, v205, s64, v14
    buffer_load_dwordx4 v3, s[32:35], s61 offen lds
    v_mul_f32 v204, v204, v50
    v_mfma_f32_32x32x16_bf16 v[112:127], v[180:183], a[168:171], v[112:127]
    ds_read_b64_tr_b16 v[196:197], v7 offset:18432
    v_mul_f32 v205, v205, v51
    v_exp_f32 v204, v204
    v_mfma_f32_32x32x16_bf16 v[128:143], v[180:183], a[172:175], v[128:143]
    ds_read_b64_tr_b16 v[198:199], v7 offset:18944
    v_exp_f32 v205, v205
    v_mul_f32 v206, v50, v58
    s_waitcnt lgkmcnt(4)
    v_mfma_f32_32x32x16_bf16 v[80:95], v[184:187], a[176:179], v[80:95]
    s_waitcnt vmcnt(8)
    s_barrier
    ds_read_b64_tr_b16 v[176:177], v6 offset:24576
    v_mul_f32 v207, v51, v59
    v_add_f32 v204, 1.0, v204
    v_mfma_f32_32x32x16_bf16 v[96:111], v[184:187], a[180:183], v[96:111]
    ds_read_b64_tr_b16 v[178:179], v6 offset:25088
    s_mul_i32 s61, s4, 294912
    s_add_u32 m0, s66, 0
    s_add_u32 s61, s61, s60
    buffer_load_dwordx4 v4, s[32:35], s61 offen lds
    v_add_f32 v205, 1.0, v205
    v_mfma_f32_32x32x16_bf16 v[112:127], v[188:191], a[176:179], v[112:127]
    ds_read_b64_tr_b16 v[180:181], v7 offset:24576
    v_rcp_f32 v204, v204
    v_rcp_f32 v205, v205
    v_mul_f32 v206, v206, v204
    v_mfma_f32_32x32x16_bf16 v[128:143], v[188:191], a[180:183], v[128:143]
    ds_read_b64_tr_b16 v[182:183], v7 offset:25088
    v_mul_f32 v207, v207, v205
    v_cvt_pk_bf16_f32 v217, v206, v207
    s_waitcnt lgkmcnt(4)
    v_mfma_f32_32x32x16_bf16 v[80:95], v[192:195], a[184:187], v[80:95]
    ds_read_b64_tr_b16 v[184:185], v6 offset:26624
    v_mul_f32 v200, v52, v52
    v_mul_f32 v201, v53, v53
    v_mfma_f32_32x32x16_bf16 v[96:111], v[192:195], a[188:191], v[96:111]
    ds_read_b64_tr_b16 v[186:187], v6 offset:27136
    s_mul_i32 s61, s5, 294912
    s_add_u32 m0, s66, 8192
    s_add_u32 s61, s61, s60
    buffer_load_dwordx4 v4, s[32:35], s61 offen lds
    v_fma_f32 v200, v200, s64, v14
    v_mfma_f32_32x32x16_bf16 v[112:127], v[196:199], a[184:187], v[112:127]
    ds_read_b64_tr_b16 v[188:189], v7 offset:26624
    v_fma_f32 v201, v201, s64, v14
    v_mul_f32 v200, v200, v52
    v_mul_f32 v201, v201, v53
    v_mfma_f32_32x32x16_bf16 v[128:143], v[196:199], a[188:191], v[128:143]
    ds_read_b64_tr_b16 v[190:191], v7 offset:27136
    v_exp_f32 v200, v200
    v_exp_f32 v201, v201
    s_waitcnt lgkmcnt(4)
    v_mfma_f32_32x32x16_bf16 v[80:95], v[176:179], a[192:195], v[80:95]
    ds_read_b64_tr_b16 v[192:193], v6 offset:32768
    v_mul_f32 v202, v52, v60
    v_mul_f32 v203, v53, v61
    v_mfma_f32_32x32x16_bf16 v[96:111], v[176:179], a[196:199], v[96:111]
    ds_read_b64_tr_b16 v[194:195], v6 offset:33280
    v_add_f32 v200, 1.0, v200
    v_add_f32 v201, 1.0, v201
    v_mfma_f32_32x32x16_bf16 v[112:127], v[180:183], a[192:195], v[112:127]
    ds_read_b64_tr_b16 v[196:197], v7 offset:32768
    v_rcp_f32 v200, v200
    v_rcp_f32 v201, v201
    v_mfma_f32_32x32x16_bf16 v[128:143], v[180:183], a[196:199], v[128:143]
    ds_read_b64_tr_b16 v[198:199], v7 offset:33280
    v_mul_f32 v202, v202, v200
    v_mul_f32 v203, v203, v201
    s_waitcnt lgkmcnt(4)
    v_mfma_f32_32x32x16_bf16 v[80:95], v[184:187], a[200:203], v[80:95]
    ds_read_b64_tr_b16 v[176:177], v6 offset:34816
    v_cvt_pk_bf16_f32 v218, v202, v203
    v_mul_f32 v204, v54, v54
    v_mfma_f32_32x32x16_bf16 v[96:111], v[184:187], a[204:207], v[96:111]
    ds_read_b64_tr_b16 v[178:179], v6 offset:35328
    v_mul_f32 v205, v55, v55
    v_fma_f32 v204, v204, s64, v14
    v_mfma_f32_32x32x16_bf16 v[112:127], v[188:191], a[200:203], v[112:127]
    ds_read_b64_tr_b16 v[180:181], v7 offset:34816
    v_fma_f32 v205, v205, s64, v14
    v_mul_f32 v204, v204, v54
    v_mfma_f32_32x32x16_bf16 v[128:143], v[188:191], a[204:207], v[128:143]
    ds_read_b64_tr_b16 v[182:183], v7 offset:35328
    v_mul_f32 v205, v205, v55
    v_exp_f32 v204, v204
    s_waitcnt lgkmcnt(4)
    v_mfma_f32_32x32x16_bf16 v[80:95], v[192:195], a[208:211], v[80:95]
    s_waitcnt vmcnt(6)
    s_barrier
    ds_read_b64_tr_b16 v[184:185], v6 offset:40960
    v_exp_f32 v205, v205
    v_mul_f32 v206, v54, v62
    v_mfma_f32_32x32x16_bf16 v[96:111], v[192:195], a[212:215], v[96:111]
    ds_read_b64_tr_b16 v[186:187], v6 offset:41472
    s_mul_i32 s61, s6, 294912
    s_add_u32 m0, s66, 16384
    s_add_u32 s61, s61, s60
    buffer_load_dwordx4 v4, s[32:35], s61 offen lds
    v_mul_f32 v207, v55, v63
    v_mfma_f32_32x32x16_bf16 v[112:127], v[196:199], a[208:211], v[112:127]
    ds_read_b64_tr_b16 v[188:189], v7 offset:40960
    v_add_f32 v204, 1.0, v204
    v_add_f32 v205, 1.0, v205
    v_rcp_f32 v204, v204
    v_mfma_f32_32x32x16_bf16 v[128:143], v[196:199], a[212:215], v[128:143]
    ds_read_b64_tr_b16 v[190:191], v7 offset:41472
    v_rcp_f32 v205, v205
    v_mul_f32 v206, v206, v204
    s_waitcnt lgkmcnt(4)
    v_mfma_f32_32x32x16_bf16 v[80:95], v[176:179], a[216:219], v[80:95]
    ds_read_b64_tr_b16 v[192:193], v6 offset:43008
    v_mul_f32 v207, v207, v205
    v_cvt_pk_bf16_f32 v219, v206, v207
    v_mfma_f32_32x32x16_bf16 v[96:111], v[176:179], a[220:223], v[96:111]
    ds_read_b64_tr_b16 v[194:195], v6 offset:43520
    s_mul_i32 s61, s7, 294912
    s_add_u32 m0, s66, 24576
    s_add_u32 s61, s61, s60
    buffer_load_dwordx4 v4, s[32:35], s61 offen lds
    ds_write_b128 v12, v[216:219] offset:9216
    v_mfma_f32_32x32x16_bf16 v[112:127], v[180:183], a[216:219], v[112:127]
    ds_read_b64_tr_b16 v[196:197], v7 offset:43008
    v_mul_f32 v200, v64, v64
    v_mul_f32 v201, v65, v65
    v_fma_f32 v200, v200, s64, v14
    v_mfma_f32_32x32x16_bf16 v[128:143], v[180:183], a[220:223], v[128:143]
    ds_read_b64_tr_b16 v[198:199], v7 offset:43520
    v_fma_f32 v201, v201, s64, v14
    v_mul_f32 v200, v200, v64
    s_waitcnt lgkmcnt(5)
    v_mfma_f32_32x32x16_bf16 v[80:95], v[184:187], a[224:227], v[80:95]
    ds_read_b64_tr_b16 v[176:177], v8 offset:0
    v_mul_f32 v201, v201, v65
    v_exp_f32 v200, v200
    v_mfma_f32_32x32x16_bf16 v[96:111], v[184:187], a[228:231], v[96:111]
    ds_read_b64_tr_b16 v[178:179], v8 offset:512
    v_exp_f32 v201, v201
    v_mul_f32 v202, v64, v72
    v_mfma_f32_32x32x16_bf16 v[112:127], v[188:191], a[224:227], v[112:127]
    ds_read_b64_tr_b16 v[180:181], v9 offset:0
    v_mul_f32 v203, v65, v73
    v_add_f32 v200, 1.0, v200
    v_mfma_f32_32x32x16_bf16 v[128:143], v[188:191], a[228:231], v[128:143]
    ds_read_b64_tr_b16 v[182:183], v9 offset:512
    v_add_f32 v201, 1.0, v201
    v_rcp_f32 v200, v200
    s_waitcnt lgkmcnt(4)
    v_mfma_f32_32x32x16_bf16 v[80:95], v[192:195], a[232:235], v[80:95]
    ds_read_b64_tr_b16 v[184:185], v8 offset:2048
    v_rcp_f32 v201, v201
    v_mul_f32 v202, v202, v200
    v_mfma_f32_32x32x16_bf16 v[96:111], v[192:195], a[236:239], v[96:111]
    ds_read_b64_tr_b16 v[186:187], v8 offset:2560
    v_mul_f32 v203, v203, v201
    v_cvt_pk_bf16_f32 v220, v202, v203
    v_mfma_f32_32x32x16_bf16 v[112:127], v[196:199], a[232:235], v[112:127]
    ds_read_b64_tr_b16 v[188:189], v9 offset:2048
    v_mul_f32 v204, v66, v66
    v_mul_f32 v205, v67, v67
    v_mfma_f32_32x32x16_bf16 v[128:143], v[196:199], a[236:239], v[128:143]
    ds_read_b64_tr_b16 v[190:191], v9 offset:2560
    v_fma_f32 v204, v204, s64, v14
    v_fma_f32 v205, v205, s64, v14
    s_waitcnt lgkmcnt(4)
    v_mfma_f32_32x32x16_bf16 v[80:95], v[176:179], a[240:243], v[80:95]
    s_waitcnt vmcnt(4)
    s_barrier
    ds_read_b64_tr_b16 v[192:193], v8 offset:8192
    v_mul_f32 v204, v204, v66
    v_mul_f32 v205, v205, v67
    v_mfma_f32_32x32x16_bf16 v[96:111], v[176:179], a[244:247], v[96:111]
    ds_read_b64_tr_b16 v[194:195], v8 offset:8704
    s_mul_i32 s61, s8, 294912
    s_add_u32 m0, s66, 32768
    s_add_u32 s61, s61, s60
    buffer_load_dwordx4 v4, s[32:35], s61 offen lds
    v_exp_f32 v204, v204
    v_mfma_f32_32x32x16_bf16 v[112:127], v[180:183], a[240:243], v[112:127]
    ds_read_b64_tr_b16 v[196:197], v9 offset:8192
    v_exp_f32 v205, v205
    v_mul_f32 v206, v66, v74
    v_mul_f32 v207, v67, v75
    v_mfma_f32_32x32x16_bf16 v[128:143], v[180:183], a[244:247], v[128:143]
    ds_read_b64_tr_b16 v[198:199], v9 offset:8704
    v_add_f32 v204, 1.0, v204
    v_add_f32 v205, 1.0, v205
    s_waitcnt lgkmcnt(4)
    v_mfma_f32_32x32x16_bf16 v[80:95], v[184:187], a[248:251], v[80:95]
    ds_read_b64_tr_b16 v[176:177], v8 offset:10240
    v_rcp_f32 v204, v204
    v_rcp_f32 v205, v205
    v_mfma_f32_32x32x16_bf16 v[96:111], v[184:187], a[252:255], v[96:111]
    ds_read_b64_tr_b16 v[178:179], v8 offset:10752
    s_mul_i32 s61, s9, 294912
    s_add_u32 m0, s66, 40960
    s_add_u32 s61, s61, s60
    buffer_load_dwordx4 v4, s[32:35], s61 offen lds
    v_mul_f32 v206, v206, v204
    v_mfma_f32_32x32x16_bf16 v[112:127], v[188:191], a[248:251], v[112:127]
    ds_read_b64_tr_b16 v[180:181], v9 offset:10240
    v_mul_f32 v207, v207, v205
    v_cvt_pk_bf16_f32 v221, v206, v207
    v_mul_f32 v200, v68, v68
    v_mfma_f32_32x32x16_bf16 v[128:143], v[188:191], a[252:255], v[128:143]
    ds_read_b64_tr_b16 v[182:183], v9 offset:10752
    v_mul_f32 v201, v69, v69
    v_fma_f32 v200, v200, s64, v14
    s_waitcnt lgkmcnt(4)
    v_mfma_f32_32x32x16_bf16 v[80:95], v[192:195], v[144:147], v[80:95]
    ds_read_b64_tr_b16 v[184:185], v8 offset:16384
    v_fma_f32 v201, v201, s64, v14
    v_mul_f32 v200, v200, v68
    v_mfma_f32_32x32x16_bf16 v[96:111], v[192:195], v[148:151], v[96:111]
    ds_read_b64_tr_b16 v[186:187], v8 offset:16896
    v_mul_f32 v201, v201, v69
    v_exp_f32 v200, v200
    v_mfma_f32_32x32x16_bf16 v[112:127], v[196:199], v[144:147], v[112:127]
    ds_read_b64_tr_b16 v[188:189], v9 offset:16384
    v_exp_f32 v201, v201
    v_mul_f32 v202, v68, v76
    v_mfma_f32_32x32x16_bf16 v[128:143], v[196:199], v[148:151], v[128:143]
    ds_read_b64_tr_b16 v[190:191], v9 offset:16896
    v_mul_f32 v203, v69, v77
    v_add_f32 v200, 1.0, v200
    s_waitcnt lgkmcnt(4)
    v_mfma_f32_32x32x16_bf16 v[80:95], v[176:179], v[152:155], v[80:95]
    ds_read_b64_tr_b16 v[192:193], v8 offset:18432
    v_add_f32 v201, 1.0, v201
    v_rcp_f32 v200, v200
    v_mfma_f32_32x32x16_bf16 v[96:111], v[176:179], v[156:159], v[96:111]
    ds_read_b64_tr_b16 v[194:195], v8 offset:18944
    v_rcp_f32 v201, v201
    v_mul_f32 v202, v202, v200
    v_mfma_f32_32x32x16_bf16 v[112:127], v[180:183], v[152:155], v[112:127]
    ds_read_b64_tr_b16 v[196:197], v9 offset:18432
    v_mul_f32 v203, v203, v201
    v_cvt_pk_bf16_f32 v222, v202, v203
    v_mfma_f32_32x32x16_bf16 v[128:143], v[180:183], v[156:159], v[128:143]
    ds_read_b64_tr_b16 v[198:199], v9 offset:18944
    v_mul_f32 v204, v70, v70
    v_mul_f32 v205, v71, v71
    s_waitcnt lgkmcnt(4)
    v_mfma_f32_32x32x16_bf16 v[80:95], v[184:187], v[160:163], v[80:95]
    s_waitcnt vmcnt(4)
    s_barrier
    v_fma_f32 v204, v204, s64, v14
    v_fma_f32 v205, v205, s64, v14
    v_mfma_f32_32x32x16_bf16 v[96:111], v[184:187], v[164:167], v[96:111]
    ds_read_b64_tr_b16 v[176:177], v10 offset:0
    s_mul_i32 s61, s10, 294912
    s_add_u32 m0, s66, 49152
    s_add_u32 s61, s61, s60
    buffer_load_dwordx4 v4, s[32:35], s61 offen lds
    v_mul_f32 v204, v204, v70
    v_mfma_f32_32x32x16_bf16 v[112:127], v[188:191], v[160:163], v[112:127]
    v_mul_f32 v205, v205, v71
    v_exp_f32 v204, v204
    v_exp_f32 v205, v205
    v_mfma_f32_32x32x16_bf16 v[128:143], v[188:191], v[164:167], v[128:143]
    ds_read_b64_tr_b16 v[178:179], v10 offset:256
    v_mul_f32 v206, v70, v78
    v_mul_f32 v207, v71, v79
    s_waitcnt lgkmcnt(2)
    v_mfma_f32_32x32x16_bf16 v[80:95], v[192:195], v[168:171], v[80:95]
    v_add_f32 v204, 1.0, v204
    v_add_f32 v205, 1.0, v205
    v_mfma_f32_32x32x16_bf16 v[96:111], v[192:195], v[172:175], v[96:111]
    ds_read_b64_tr_b16 v[184:185], v10 offset:1024
    s_mul_i32 s61, s11, 294912
    s_add_u32 m0, s66, 57344
    s_add_u32 s61, s61, s60
    buffer_load_dwordx4 v4, s[32:35], s61 offen lds
    v_rcp_f32 v204, v204
    v_mfma_f32_32x32x16_bf16 v[112:127], v[196:199], v[168:171], v[112:127]
    v_rcp_f32 v205, v205
    v_mul_f32 v206, v206, v204
    v_mul_f32 v207, v207, v205
    v_mfma_f32_32x32x16_bf16 v[128:143], v[196:199], v[172:175], v[128:143]
    ds_read_b64_tr_b16 v[186:187], v10 offset:1280
    v_cvt_pk_bf16_f32 v223, v206, v207
    ds_write_b128 v12, v[220:223] offset:27648
    s_waitcnt lgkmcnt(3)
    v_mfma_f32_32x32x16_bf16 v[16:31], v[176:179], a[0:3], 0
    ds_read_b64_tr_b16 v[192:193], v10 offset:8192
    v_mfma_f32_32x32x16_bf16 v[32:47], v[176:179], a[4:7], 0
    ds_read_b64_tr_b16 v[194:195], v10 offset:8448
    s_waitcnt lgkmcnt(3)
    v_mfma_f32_32x32x16_bf16 v[16:31], v[184:187], a[8:11], v[16:31]
    ds_read_b64_tr_b16 v[176:177], v10 offset:9216
    v_mfma_f32_32x32x16_bf16 v[32:47], v[184:187], a[12:15], v[32:47]
    ds_read_b64_tr_b16 v[178:179], v10 offset:9472
    s_waitcnt lgkmcnt(2)
    v_mfma_f32_32x32x16_bf16 v[16:31], v[192:195], a[16:19], v[16:31]
    s_waitcnt vmcnt(4)
    s_barrier
    ds_read_b64_tr_b16 v[184:185], v10 offset:16384
    v_mfma_f32_32x32x16_bf16 v[32:47], v[192:195], a[20:23], v[32:47]
    ds_read_b64_tr_b16 v[186:187], v10 offset:16640
    s_mul_i32 s61, s12, 294912
    s_add_u32 m0, s66, 65536
    s_add_u32 s61, s61, s60
    buffer_load_dwordx4 v4, s[32:35], s61 offen lds
    s_waitcnt lgkmcnt(2)
    v_mfma_f32_32x32x16_bf16 v[16:31], v[176:179], a[24:27], v[16:31]
    ds_read_b64_tr_b16 v[192:193], v10 offset:17408
    v_mul_f32 v200, v112, v112
    v_mul_f32 v201, v113, v113
    v_fma_f32 v200, v200, s64, v14
    v_fma_f32 v201, v201, s64, v14
    v_mul_f32 v200, v200, v112
    v_mfma_f32_32x32x16_bf16 v[32:47], v[176:179], a[28:31], v[32:47]
    ds_read_b64_tr_b16 v[194:195], v10 offset:17664
    s_mul_i32 s61, s13, 294912
    s_add_u32 m0, s66, 0
    s_add_u32 s61, s61, s60
    buffer_load_dwordx4 v4, s[32:35], s61 offen lds
    v_mul_f32 v201, v201, v113
    v_exp_f32 v200, v200
    v_exp_f32 v201, v201
    s_waitcnt lgkmcnt(2)
    v_mfma_f32_32x32x16_bf16 v[16:31], v[184:187], a[32:35], v[16:31]
    ds_read_b64_tr_b16 v[176:177], v10 offset:24576
    v_mul_f32 v202, v112, v120
    v_mul_f32 v203, v113, v121
    v_add_f32 v200, 1.0, v200
    v_add_f32 v201, 1.0, v201
    v_rcp_f32 v200, v200
    v_mfma_f32_32x32x16_bf16 v[32:47], v[184:187], a[36:39], v[32:47]
    ds_read_b64_tr_b16 v[178:179], v10 offset:24832
    v_rcp_f32 v201, v201
    v_mul_f32 v202, v202, v200
    v_mul_f32 v203, v203, v201
    v_cvt_pk_bf16_f32 v216, v202, v203
    s_waitcnt lgkmcnt(2)
    v_mfma_f32_32x32x16_bf16 v[16:31], v[192:195], a[40:43], v[16:31]
    ds_read_b64_tr_b16 v[184:185], v10 offset:25600
    v_mul_f32 v204, v114, v114
    v_mul_f32 v205, v115, v115
    v_fma_f32 v204, v204, s64, v14
    v_fma_f32 v205, v205, s64, v14
    v_mfma_f32_32x32x16_bf16 v[32:47], v[192:195], a[44:47], v[32:47]
    ds_read_b64_tr_b16 v[186:187], v10 offset:25856
    v_mul_f32 v204, v204, v114
    v_mul_f32 v205, v205, v115
    v_exp_f32 v204, v204
    v_exp_f32 v205, v205
    v_mul_f32 v206, v114, v122
    s_waitcnt lgkmcnt(2)
    v_mfma_f32_32x32x16_bf16 v[16:31], v[176:179], a[48:51], v[16:31]
    s_waitcnt vmcnt(4)
    s_barrier
    ds_read_b64_tr_b16 v[192:193], v10 offset:32768
    v_mul_f32 v207, v115, v123
    v_add_f32 v204, 1.0, v204
    v_add_f32 v205, 1.0, v205
    v_rcp_f32 v204, v204
    v_mfma_f32_32x32x16_bf16 v[32:47], v[176:179], a[52:55], v[32:47]
    ds_read_b64_tr_b16 v[194:195], v10 offset:33024
    s_mul_i32 s61, s14, 294912
    s_add_u32 m0, s66, 8192
    s_add_u32 s61, s61, s60
    buffer_load_dwordx4 v4, s[32:35], s61 offen lds
    v_rcp_f32 v205, v205
    v_mul_f32 v206, v206, v204
    v_mul_f32 v207, v207, v205
    s_waitcnt lgkmcnt(2)
    v_mfma_f32_32x32x16_bf16 v[16:31], v[184:187], a[56:59], v[16:31]
    ds_read_b64_tr_b16 v[176:177], v10 offset:33792
    v_cvt_pk_bf16_f32 v217, v206, v207
    v_mul_f32 v200, v116, v116
    v_mul_f32 v201, v117, v117
    v_fma_f32 v200, v200, s64, v14
    v_fma_f32 v201, v201, s64, v14
    v_mfma_f32_32x32x16_bf16 v[32:47], v[184:187], a[60:63], v[32:47]
    ds_read_b64_tr_b16 v[178:179], v10 offset:34048
    s_mul_i32 s61, s15, 294912
    s_add_u32 m0, s66, 16384
    s_add_u32 s61, s61, s60
    buffer_load_dwordx4 v4, s[32:35], s61 offen lds
    v_mul_f32 v200, v200, v116
    v_mul_f32 v201, v201, v117
    v_exp_f32 v200, v200
    s_waitcnt lgkmcnt(2)
    v_mfma_f32_32x32x16_bf16 v[16:31], v[192:195], a[64:67], v[16:31]
    ds_read_b64_tr_b16 v[184:185], v10 offset:40960
    v_exp_f32 v201, v201
    v_mul_f32 v202, v116, v124
    v_mul_f32 v203, v117, v125
    v_add_f32 v200, 1.0, v200
    v_add_f32 v201, 1.0, v201
    v_mfma_f32_32x32x16_bf16 v[32:47], v[192:195], a[68:71], v[32:47]
    ds_read_b64_tr_b16 v[186:187], v10 offset:41216
    v_rcp_f32 v200, v200
    v_rcp_f32 v201, v201
    v_mul_f32 v202, v202, v200
    v_mul_f32 v203, v203, v201
    v_cvt_pk_bf16_f32 v218, v202, v203
    s_waitcnt lgkmcnt(2)
    v_mfma_f32_32x32x16_bf16 v[16:31], v[176:179], a[72:75], v[16:31]
    ds_read_b64_tr_b16 v[192:193], v10 offset:41984
    v_mul_f32 v204, v118, v118
    v_mul_f32 v205, v119, v119
    v_fma_f32 v204, v204, s64, v14
    v_fma_f32 v205, v205, s64, v14
    v_mfma_f32_32x32x16_bf16 v[32:47], v[176:179], a[76:79], v[32:47]
    ds_read_b64_tr_b16 v[194:195], v10 offset:42240
    v_mul_f32 v204, v204, v118
    v_mul_f32 v205, v205, v119
    v_exp_f32 v204, v204
    v_exp_f32 v205, v205
    s_waitcnt lgkmcnt(2)
    v_mfma_f32_32x32x16_bf16 v[16:31], v[184:187], a[80:83], v[16:31]
    s_waitcnt vmcnt(4)
    s_barrier
    ds_read_b64_tr_b16 v[176:177], v11 offset:0
    v_mul_f32 v206, v118, v126
    v_mul_f32 v207, v119, v127
    v_add_f32 v204, 1.0, v204
    v_add_f32 v205, 1.0, v205
    v_mfma_f32_32x32x16_bf16 v[32:47], v[184:187], a[84:87], v[32:47]
    ds_read_b64_tr_b16 v[178:179], v11 offset:256
    s_mul_i32 s61, s16, 294912
    s_add_u32 m0, s66, 24576
    s_add_u32 s61, s61, s60
    buffer_load_dwordx4 v4, s[32:35], s61 offen lds
    v_rcp_f32 v204, v204
    v_rcp_f32 v205, v205
    v_mul_f32 v206, v206, v204
    s_waitcnt lgkmcnt(2)
    v_mfma_f32_32x32x16_bf16 v[16:31], v[192:195], a[88:91], v[16:31]
    ds_read_b64_tr_b16 v[184:185], v11 offset:1024
    v_mul_f32 v207, v207, v205
    v_cvt_pk_bf16_f32 v219, v206, v207
    ds_write_b128 v12, v[216:219] offset:13312
    v_mul_f32 v200, v128, v128
    v_mul_f32 v201, v129, v129
    v_mfma_f32_32x32x16_bf16 v[32:47], v[192:195], a[92:95], v[32:47]
    ds_read_b64_tr_b16 v[186:187], v11 offset:1280
    s_mul_i32 s61, s17, 294912
    s_add_u32 m0, s66, 32768
    s_add_u32 s61, s61, s60
    buffer_load_dwordx4 v4, s[32:35], s61 offen lds
    v_fma_f32 v200, v200, s64, v14
    v_fma_f32 v201, v201, s64, v14
    v_mul_f32 v200, v200, v128
    s_waitcnt lgkmcnt(3)
    v_mfma_f32_32x32x16_bf16 v[16:31], v[176:179], a[96:99], v[16:31]
    ds_read_b64_tr_b16 v[192:193], v11 offset:8192
    v_mul_f32 v201, v201, v129
    v_exp_f32 v200, v200
    v_exp_f32 v201, v201
    v_mul_f32 v202, v128, v136
    v_mul_f32 v203, v129, v137
    v_mfma_f32_32x32x16_bf16 v[32:47], v[176:179], a[100:103], v[32:47]
    ds_read_b64_tr_b16 v[194:195], v11 offset:8448
    v_add_f32 v200, 1.0, v200
    v_add_f32 v201, 1.0, v201
    v_rcp_f32 v200, v200
    v_rcp_f32 v201, v201
    v_mul_f32 v202, v202, v200
    s_waitcnt lgkmcnt(2)
    v_mfma_f32_32x32x16_bf16 v[16:31], v[184:187], a[104:107], v[16:31]
    ds_read_b64_tr_b16 v[176:177], v11 offset:9216
    v_mul_f32 v203, v203, v201
    v_cvt_pk_bf16_f32 v220, v202, v203
    v_mul_f32 v204, v130, v130
    v_mul_f32 v205, v131, v131
    v_mfma_f32_32x32x16_bf16 v[32:47], v[184:187], a[108:111], v[32:47]
    ds_read_b64_tr_b16 v[178:179], v11 offset:9472
    v_fma_f32 v204, v204, s64, v14
    v_fma_f32 v205, v205, s64, v14
    v_mul_f32 v204, v204, v130
    v_mul_f32 v205, v205, v131
    v_exp_f32 v204, v204
    s_waitcnt lgkmcnt(2)
    v_mfma_f32_32x32x16_bf16 v[16:31], v[192:195], a[112:115], v[16:31]
    s_waitcnt vmcnt(4)
    s_barrier
    ds_read_b64_tr_b16 v[184:185], v11 offset:16384
    v_exp_f32 v205, v205
    v_mul_f32 v206, v130, v138
    v_mul_f32 v207, v131, v139
    v_add_f32 v204, 1.0, v204
    v_mfma_f32_32x32x16_bf16 v[32:47], v[192:195], a[116:119], v[32:47]
    ds_read_b64_tr_b16 v[186:187], v11 offset:16640
    s_mul_i32 s61, s18, 294912
    s_add_u32 m0, s66, 40960
    s_add_u32 s61, s61, s60
    buffer_load_dwordx4 v4, s[32:35], s61 offen lds
    v_add_f32 v205, 1.0, v205
    v_rcp_f32 v204, v204
    v_rcp_f32 v205, v205
    s_waitcnt lgkmcnt(2)
    v_mfma_f32_32x32x16_bf16 v[16:31], v[176:179], a[120:123], v[16:31]
    ds_read_b64_tr_b16 v[192:193], v11 offset:17408
    v_mul_f32 v206, v206, v204
    v_mul_f32 v207, v207, v205
    v_cvt_pk_bf16_f32 v221, v206, v207
    v_mul_f32 v200, v132, v132
    v_mul_f32 v201, v133, v133
    v_mfma_f32_32x32x16_bf16 v[32:47], v[176:179], a[124:127], v[32:47]
    ds_read_b64_tr_b16 v[194:195], v11 offset:17664
    s_mul_i32 s61, s19, 294912
    s_add_u32 m0, s66, 49152
    s_add_u32 s61, s61, s60
    buffer_load_dwordx4 v4, s[32:35], s61 offen lds
    v_fma_f32 v200, v200, s64, v14
    v_fma_f32 v201, v201, s64, v14
    v_mul_f32 v200, v200, v132
    s_waitcnt lgkmcnt(2)
    v_mfma_f32_32x32x16_bf16 v[16:31], v[184:187], a[128:131], v[16:31]
    ds_read_b64_tr_b16 v[176:177], v10 offset:0
    v_mul_f32 v201, v201, v133
    v_exp_f32 v200, v200
    v_exp_f32 v201, v201
    v_mul_f32 v202, v132, v140
    v_mul_f32 v203, v133, v141
    v_mfma_f32_32x32x16_bf16 v[32:47], v[184:187], a[132:135], v[32:47]
    ds_read_b64_tr_b16 v[178:179], v10 offset:256
    v_add_f32 v200, 1.0, v200
    v_add_f32 v201, 1.0, v201
    v_rcp_f32 v200, v200
    v_rcp_f32 v201, v201
    v_mul_f32 v202, v202, v200
    s_waitcnt lgkmcnt(2)
    v_mfma_f32_32x32x16_bf16 v[16:31], v[192:195], a[136:139], v[16:31]
    ds_read_b64_tr_b16 v[184:185], v10 offset:1024
    v_mul_f32 v203, v203, v201
    v_cvt_pk_bf16_f32 v222, v202, v203
    v_mul_f32 v204, v134, v134
    v_mul_f32 v205, v135, v135
    v_mfma_f32_32x32x16_bf16 v[32:47], v[192:195], a[140:143], v[32:47]
    ds_read_b64_tr_b16 v[186:187], v10 offset:1280
    v_fma_f32 v204, v204, s64, v14
    v_fma_f32 v205, v205, s64, v14
    v_mul_f32 v204, v204, v134
    v_mul_f32 v205, v205, v135
    s_waitcnt lgkmcnt(2)
    v_mfma_f32_32x32x16_bf16 v[16:31], v[176:179], a[144:147], v[16:31]
    s_waitcnt vmcnt(4)
    s_barrier
    ds_read_b64_tr_b16 v[192:193], v10 offset:8192
    v_exp_f32 v204, v204
    v_exp_f32 v205, v205
    v_mul_f32 v206, v134, v142
    v_mul_f32 v207, v135, v143
    v_mfma_f32_32x32x16_bf16 v[32:47], v[176:179], a[148:151], v[32:47]
    ds_read_b64_tr_b16 v[194:195], v10 offset:8448
    s_mul_i32 s61, s20, 294912
    s_add_u32 m0, s66, 57344
    s_add_u32 s61, s61, s60
    buffer_load_dwordx4 v4, s[32:35], s61 offen lds
    v_add_f32 v204, 1.0, v204
    v_add_f32 v205, 1.0, v205
    v_rcp_f32 v204, v204
    s_waitcnt lgkmcnt(2)
    v_mfma_f32_32x32x16_bf16 v[16:31], v[184:187], a[152:155], v[16:31]
    ds_read_b64_tr_b16 v[176:177], v10 offset:9216
    v_rcp_f32 v205, v205
    v_mul_f32 v206, v206, v204
    v_mul_f32 v207, v207, v205
    v_cvt_pk_bf16_f32 v223, v206, v207
    ds_write_b128 v12, v[220:223] offset:31744
    v_mfma_f32_32x32x16_bf16 v[32:47], v[184:187], a[156:159], v[32:47]
    ds_read_b64_tr_b16 v[178:179], v10 offset:9472
    s_mul_i32 s61, s21, 294912
    s_add_u32 m0, s66, 65536
    s_add_u32 s61, s61, s60
    buffer_load_dwordx4 v4, s[32:35], s61 offen lds
    v_mul_f32 v200, v80, v80
    v_mul_f32 v201, v81, v81
    v_fma_f32 v200, v200, s64, v14
    s_waitcnt lgkmcnt(3)
    v_mfma_f32_32x32x16_bf16 v[16:31], v[192:195], a[160:163], v[16:31]
    ds_read_b64_tr_b16 v[184:185], v10 offset:16384
    s_add_u32 s69, s80, 0
    buffer_load_dwordx4 v[180:183], v1, s[72:75], s69 offen offset:0
    v_fma_f32 v201, v201, s64, v14
    v_mul_f32 v200, v200, v80
    v_mul_f32 v201, v201, v81
    v_mfma_f32_32x32x16_bf16 v[32:47], v[192:195], a[164:167], v[32:47]
    ds_read_b64_tr_b16 v[186:187], v10 offset:16640
    s_add_u32 s69, s80, 0
    buffer_load_dwordx4 v[188:191], v1, s[72:75], s69 offen offset:1024
    v_exp_f32 v200, v200
    v_exp_f32 v201, v201
    v_mul_f32 v202, v80, v88
    s_waitcnt lgkmcnt(2)
    v_mfma_f32_32x32x16_bf16 v[16:31], v[176:179], a[168:171], v[16:31]
    ds_read_b64_tr_b16 v[192:193], v10 offset:17408
    s_add_u32 s69, s80, 0
    buffer_load_dwordx4 v[196:199], v1, s[72:75], s69 offen offset:2048
    v_mul_f32 v203, v81, v89
    v_add_f32 v200, 1.0, v200
    v_add_f32 v201, 1.0, v201
    v_mfma_f32_32x32x16_bf16 v[32:47], v[176:179], a[172:175], v[32:47]
    ds_read_b64_tr_b16 v[194:195], v10 offset:17664
    s_add_u32 s69, s80, 0
    buffer_load_dwordx4 v[232:235], v1, s[72:75], s69 offen offset:3072
    v_rcp_f32 v200, v200
    v_rcp_f32 v201, v201
    v_mul_f32 v202, v202, v200
    s_waitcnt lgkmcnt(2)
    v_mfma_f32_32x32x16_bf16 v[16:31], v[184:187], a[176:179], v[16:31]
    s_waitcnt vmcnt(8)
    s_barrier
    ds_read_b64_tr_b16 v[176:177], v10 offset:24576
    s_add_u32 s69, s80, 4096
    buffer_load_dwordx4 v[236:239], v1, s[72:75], s69 offen offset:0
    v_mul_f32 v203, v203, v201
    v_cvt_pk_bf16_f32 v216, v202, v203
    v_mul_f32 v204, v82, v82
    v_mfma_f32_32x32x16_bf16 v[32:47], v[184:187], a[180:183], v[32:47]
    ds_read_b64_tr_b16 v[178:179], v10 offset:24832
    s_add_u32 s84, s83, 0
    s_cmp_ge_u32 s84, 9
    s_cselect_b32 s62, 9, 0
    s_sub_u32 s84, s84, s62
    s_mul_i32 s84, s84, 128
    s_add_u32 s61, s67, s84
    s_add_u32 m0, s66, 0
    s_add_u32 s61, s61, 0
    buffer_load_dwordx4 v224, s[40:43], s61 offen lds
    v_mul_f32 v205, v83, v83
    v_fma_f32 v204, v204, s64, v14
    v_fma_f32 v205, v205, s64, v14
    s_waitcnt lgkmcnt(2)
    v_mfma_f32_32x32x16_bf16 v[16:31], v[192:195], a[184:187], v[16:31]
    ds_read_b64_tr_b16 v[184:185], v10 offset:25600
    s_add_u32 s69, s80, 4096
    buffer_load_dwordx4 v[240:243], v1, s[72:75], s69 offen offset:1024
    v_mul_f32 v204, v204, v82
    v_mul_f32 v205, v205, v83
    v_exp_f32 v204, v204
    v_mfma_f32_32x32x16_bf16 v[32:47], v[192:195], a[188:191], v[32:47]
    ds_read_b64_tr_b16 v[186:187], v10 offset:25856
    s_add_u32 s61, s67, s84
    s_add_u32 m0, s66, 4096
    s_add_u32 s61, s61, 36864
    buffer_load_dwordx4 v224, s[40:43], s61 offen lds
    v_exp_f32 v205, v205
    v_mul_f32 v206, v82, v90
    v_mul_f32 v207, v83, v91
    s_waitcnt lgkmcnt(2)
    v_mfma_f32_32x32x16_bf16 v[16:31], v[176:179], a[192:195], v[16:31]
    ds_read_b64_tr_b16 v[192:193], v10 offset:32768
    s_add_u32 s69, s80, 4096
    buffer_load_dwordx4 v[244:247], v1, s[72:75], s69 offen offset:2048
    v_add_f32 v204, 1.0, v204
    v_add_f32 v205, 1.0, v205
    v_rcp_f32 v204, v204
    v_mfma_f32_32x32x16_bf16 v[32:47], v[176:179], a[196:199], v[32:47]
    ds_read_b64_tr_b16 v[194:195], v10 offset:33024
    s_add_u32 s61, s67, s84
    s_add_u32 m0, s66, 8192
    s_add_u32 s61, s61, 73728
    buffer_load_dwordx4 v224, s[40:43], s61 offen lds
    v_rcp_f32 v205, v205
    v_mul_f32 v206, v206, v204
    v_mul_f32 v207, v207, v205
    s_waitcnt lgkmcnt(2)
    v_mfma_f32_32x32x16_bf16 v[16:31], v[184:187], a[200:203], v[16:31]
    ds_read_b64_tr_b16 v[176:177], v10 offset:33792
    v_cvt_pk_bf16_f32 v217, v206, v207
    v_mul_f32 v200, v84, v84
    v_mul_f32 v201, v85, v85
    v_fma_f32 v200, v200, s64, v14
    v_fma_f32 v201, v201, s64, v14
    v_mfma_f32_32x32x16_bf16 v[32:47], v[184:187], a[204:207], v[32:47]
    ds_read_b64_tr_b16 v[178:179], v10 offset:34048
    s_add_u32 s61, s67, s84
    s_add_u32 m0, s66, 12288
    s_add_u32 s61, s61, 110592
    buffer_load_dwordx4 v224, s[40:43], s61 offen lds
    v_mul_f32 v200, v200, v84
    v_mul_f32 v201, v201, v85
    v_exp_f32 v200, v200
    s_waitcnt lgkmcnt(2)
    v_mfma_f32_32x32x16_bf16 v[16:31], v[192:195], a[208:211], v[16:31]
    s_waitcnt vmcnt(13)
    s_barrier
    ds_read_b64_tr_b16 v[184:185], v10 offset:40960
    v_exp_f32 v201, v201
    v_mul_f32 v202, v84, v92
    v_mul_f32 v203, v85, v93
    v_add_f32 v200, 1.0, v200
    v_add_f32 v201, 1.0, v201
    v_mfma_f32_32x32x16_bf16 v[32:47], v[192:195], a[212:215], v[32:47]
    ds_read_b64_tr_b16 v[186:187], v10 offset:41216
    s_add_u32 s61, s67, s84
    s_add_u32 m0, s66, 16384
    s_add_u32 s61, s61, 147456
    buffer_load_dwordx4 v224, s[40:43], s61 offen lds
    v_rcp_f32 v200, v200
    v_rcp_f32 v201, v201
    v_mul_f32 v202, v202, v200
    s_waitcnt lgkmcnt(2)
    v_mfma_f32_32x32x16_bf16 v[16:31], v[176:179], a[216:219], v[16:31]
    ds_read_b64_tr_b16 v[192:193], v10 offset:41984
    v_mul_f32 v203, v203, v201
    v_cvt_pk_bf16_f32 v218, v202, v203
    v_mul_f32 v204, v86, v86
    v_mul_f32 v205, v87, v87
    v_fma_f32 v204, v204, s64, v14
    v_mfma_f32_32x32x16_bf16 v[32:47], v[176:179], a[220:223], v[32:47]
    ds_read_b64_tr_b16 v[194:195], v10 offset:42240
    s_add_u32 s61, s67, s84
    s_add_u32 m0, s66, 20480
    s_add_u32 s61, s61, 184320
    buffer_load_dwordx4 v224, s[40:43], s61 offen lds
    v_fma_f32 v205, v205, s64, v14
    v_mul_f32 v204, v204, v86
    v_mul_f32 v205, v205, v87
    s_waitcnt lgkmcnt(2)
    v_mfma_f32_32x32x16_bf16 v[16:31], v[184:187], a[224:227], v[16:31]
    ds_read_b64_tr_b16 v[176:177], v11 offset:0
    s_add_u32 s69, s80, 4096
    buffer_load_dwordx4 v[112:115], v1, s[72:75], s69 offen offset:3072
    v_exp_f32 v204, v204
    v_exp_f32 v205, v205
    v_mul_f32 v206, v86, v94
    v_mfma_f32_32x32x16_bf16 v[32:47], v[184:187], a[228:231], v[32:47]
    ds_read_b64_tr_b16 v[178:179], v11 offset:256
    s_add_u32 s61, s67, s84
    s_add_u32 m0, s66, 24576
    s_add_u32 s61, s61, 221184
    buffer_load_dwordx4 v224, s[40:43], s61 offen lds
    v_mul_f32 v207, v87, v95
    v_add_f32 v204, 1.0, v204
    v_add_f32 v205, 1.0, v205
    s_waitcnt lgkmcnt(2)
    v_mfma_f32_32x32x16_bf16 v[16:31], v[192:195], a[232:235], v[16:31]
    ds_read_b64_tr_b16 v[184:185], v11 offset:1024
    s_add_u32 s69, s80, 8192
    buffer_load_dwordx4 v[116:119], v1, s[72:75], s69 offen offset:0
    v_rcp_f32 v204, v204
    v_rcp_f32 v205, v205
    v_mul_f32 v206, v206, v204
    v_mfma_f32_32x32x16_bf16 v[32:47], v[192:195], a[236:239], v[32:47]
    ds_read_b64_tr_b16 v[186:187], v11 offset:1280
    s_add_u32 s61, s67, s84
    s_add_u32 m0, s66, 28672
    s_add_u32 s61, s61, 258048
    buffer_load_dwordx4 v224, s[40:43], s61 offen lds
    v_mul_f32 v207, v207, v205
    v_cvt_pk_bf16_f32 v219, v206, v207
    ds_write_b128 v12, v[216:219] offset:12288
    s_waitcnt lgkmcnt(3)
    v_mfma_f32_32x32x16_bf16 v[16:31], v[176:179], a[240:243], v[16:31]
    s_waitcnt vmcnt(17)
    s_barrier
    ds_read_b64_tr_b16 v[192:193], v11 offset:8192
    s_add_u32 s69, s80, 8192
    buffer_load_dwordx4 v[120:123], v1, s[72:75], s69 offen offset:1024
    v_mul_f32 v200, v96, v96
    v_mul_f32 v201, v97, v97
    v_fma_f32 v200, v200, s64, v14
    v_mfma_f32_32x32x16_bf16 v[32:47], v[176:179], a[244:247], v[32:47]
    ds_read_b64_tr_b16 v[194:195], v11 offset:8448
    s_add_u32 s61, s68, s84
    s_add_u32 m0, s66, 32768
    s_add_u32 s61, s61, 0
    buffer_load_dwordx4 v224, s[40:43], s61 offen lds
    v_fma_f32 v201, v201, s64, v14
    v_mul_f32 v200, v200, v96
    v_mul_f32 v201, v201, v97
    s_waitcnt lgkmcnt(3)
    v_mfma_f32_32x32x16_bf16 v[16:31], v[184:187], a[248:251], v[16:31]
    ds_read_b64_tr_b16 v[176:177], v11 offset:9216
    s_add_u32 s69, s80, 8192
    buffer_load_dwordx4 v[124:127], v1, s[72:75], s69 offen offset:2048
    v_exp_f32 v200, v200
    v_exp_f32 v201, v201
    v_mul_f32 v202, v96, v104
    v_mfma_f32_32x32x16_bf16 v[32:47], v[184:187], a[252:255], v[32:47]
    ds_read_b64_tr_b16 v[178:179], v11 offset:9472
    s_add_u32 s84, s83, 1
    s_cmp_ge_u32 s84, 9
    s_cselect_b32 s62, 9, 0
    s_sub_u32 s84, s84, s62
    s_mul_i32 s84, s84, 128
    s_add_u32 s61, s67, s84
    s_add_u32 m0, s66, 36864
    s_add_u32 s61, s61, 0
    buffer_load_dwordx4 v224, s[40:43], s61 offen lds
    v_mul_f32 v203, v97, v105
    v_add_f32 v200, 1.0, v200
    v_add_f32 v201, 1.0, v201
    s_waitcnt lgkmcnt(2)
    v_mfma_f32_32x32x16_bf16 v[16:31], v[192:195], v[144:147], v[16:31]
    ds_read_b64_tr_b16 v[184:185], v11 offset:16384
    s_add_u32 s69, s80, 8192
    buffer_load_dwordx4 v[128:131], v1, s[72:75], s69 offen offset:3072
    v_rcp_f32 v200, v200
    v_rcp_f32 v201, v201
    v_mul_f32 v202, v202, v200
    v_mfma_f32_32x32x16_bf16 v[32:47], v[192:195], v[148:151], v[32:47]
    ds_read_b64_tr_b16 v[186:187], v11 offset:16640
    s_add_u32 s61, s67, s84
    s_add_u32 m0, s66, 40960
    s_add_u32 s61, s61, 36864
    buffer_load_dwordx4 v224, s[40:43], s61 offen lds
    v_mul_f32 v203, v203, v201
    v_cvt_pk_bf16_f32 v220, v202, v203
    v_mul_f32 v204, v98, v98
    s_waitcnt lgkmcnt(2)
    v_mfma_f32_32x32x16_bf16 v[16:31], v[176:179], v[152:155], v[16:31]
    ds_read_b64_tr_b16 v[192:193], v11 offset:17408
    s_add_u32 s69, s80, 12288
    buffer_load_dwordx4 v[132:135], v1, s[72:75], s69 offen offset:0
    v_mul_f32 v205, v99, v99
    v_fma_f32 v204, v204, s64, v14
    v_fma_f32 v205, v205, s64, v14
    v_mfma_f32_32x32x16_bf16 v[32:47], v[176:179], v[156:159], v[32:47]
    ds_read_b64_tr_b16 v[194:195], v11 offset:17664
    s_add_u32 s61, s67, s84
    s_add_u32 m0, s66, 45056
    s_add_u32 s61, s61, 73728
    buffer_load_dwordx4 v224, s[40:43], s61 offen lds
    v_mul_f32 v204, v204, v98
    v_mul_f32 v205, v205, v99
    v_exp_f32 v204, v204
    s_waitcnt lgkmcnt(2)
    v_mfma_f32_32x32x16_bf16 v[16:31], v[184:187], v[160:163], v[16:31]
    s_add_u32 s69, s80, 12288
    buffer_load_dwordx4 v[136:139], v1, s[72:75], s69 offen offset:1024
    v_exp_f32 v205, v205
    v_mul_f32 v206, v98, v106
    v_mul_f32 v207, v99, v107
    v_mfma_f32_32x32x16_bf16 v[32:47], v[184:187], v[164:167], v[32:47]
    s_add_u32 s69, s80, 12288
    buffer_load_dwordx4 v[140:143], v1, s[72:75], s69 offen offset:2048
    v_add_f32 v204, 1.0, v204
    v_add_f32 v205, 1.0, v205
    v_rcp_f32 v204, v204
    s_waitcnt lgkmcnt(0)
    v_mfma_f32_32x32x16_bf16 v[16:31], v[192:195], v[168:171], v[16:31]
    v_rcp_f32 v205, v205
    v_mul_f32 v206, v206, v204
    v_mul_f32 v207, v207, v205
    v_cvt_pk_bf16_f32 v221, v206, v207
    v_mul_f32 v200, v100, v100
    v_mfma_f32_32x32x16_bf16 v[32:47], v[192:195], v[172:175], v[32:47]
    v_mul_f32 v201, v101, v101
    v_fma_f32 v200, v200, s64, v14
    v_fma_f32 v201, v201, s64, v14
    v_mul_f32 v200, v200, v100
    v_mul_f32 v201, v201, v101
    v_exp_f32 v200, v200
    v_exp_f32 v201, v201
    v_mul_f32 v202, v100, v108
    v_mul_f32 v203, v101, v109
    v_add_f32 v200, 1.0, v200
    v_add_f32 v201, 1.0, v201
    v_rcp_f32 v200, v200
    v_rcp_f32 v201, v201
    v_mul_f32 v202, v202, v200
    v_mul_f32 v203, v203, v201
    v_cvt_pk_bf16_f32 v222, v202, v203
    v_mul_f32 v204, v102, v102
    v_mul_f32 v205, v103, v103
    v_fma_f32 v204, v204, s64, v14
    v_fma_f32 v205, v205, s64, v14
    v_mul_f32 v204, v204, v102
    v_mul_f32 v205, v205, v103
    v_exp_f32 v204, v204
    v_exp_f32 v205, v205
    v_mul_f32 v206, v102, v110
    v_mul_f32 v207, v103, v111
    v_add_f32 v204, 1.0, v204
    v_add_f32 v205, 1.0, v205
    v_rcp_f32 v204, v204
    v_rcp_f32 v205, v205
    v_mul_f32 v206, v206, v204
    v_mul_f32 v207, v207, v205
    v_cvt_pk_bf16_f32 v223, v206, v207
    ds_write_b128 v12, v[220:223] offset:30720
    s_waitcnt lgkmcnt(0)
    s_barrier
    s_cmp_ge_u32 s52, 9
    s_cbranch_scc1 L_ffn_noa1
    s_waitcnt vmcnt(26)
    v_mfma_f32_32x32x16_bf16 v[80:95], a[0:3], v[180:183], 0
    v_mfma_f32_32x32x16_bf16 v[96:111], a[4:7], v[180:183], 0
    s_add_u32 s69, s80, 12288
    buffer_load_dwordx4 v[180:183], v1, s[72:75], s69 offen offset:3072
    s_waitcnt vmcnt(26)
    v_mfma_f32_32x32x16_bf16 v[80:95], a[8:11], v[188:191], v[80:95]
    s_add_u32 s61, s67, s84
    s_add_u32 m0, s66, 49152
    s_add_u32 s61, s61, 110592
    buffer_load_dwordx4 v224, s[40:43], s61 offen lds
    v_mfma_f32_32x32x16_bf16 v[96:111], a[12:15], v[188:191], v[96:111]
    s_add_u32 s69, s80, 16384
    buffer_load_dwordx4 v[188:191], v1, s[72:75], s69 offen offset:0
    s_waitcnt vmcnt(27)
    v_mfma_f32_32x32x16_bf16 v[80:95], a[16:19], v[196:199], v[80:95]
    v_mul_f32 v200, v16, v16
    v_mul_f32 v201, v17, v17
    v_fma_f32 v200, v200, s64, v14
    v_mfma_f32_32x32x16_bf16 v[96:111], a[20:23], v[196:199], v[96:111]
    s_add_u32 s69, s80, 16384
    buffer_load_dwordx4 v[196:199], v1, s[72:75], s69 offen offset:1024
    v_fma_f32 v201, v201, s64, v14
    v_mul_f32 v200, v200, v16
    v_mul_f32 v201, v201, v17
    s_waitcnt vmcnt(27)
    v_mfma_f32_32x32x16_bf16 v[80:95], a[24:27], v[232:235], v[80:95]
    s_add_u32 s61, s67, s84
    s_add_u32 m0, s66, 53248
    s_add_u32 s61, s61, 147456
    buffer_load_dwordx4 v224, s[40:43], s61 offen lds
    v_exp_f32 v200, v200
    v_exp_f32 v201, v201
    v_mul_f32 v202, v16, v24
    v_mfma_f32_32x32x16_bf16 v[96:111], a[28:31], v[232:235], v[96:111]
    s_add_u32 s69, s80, 16384
    buffer_load_dwordx4 v[232:235], v1, s[72:75], s69 offen offset:2048
    v_mul_f32 v203, v17, v25
    v_add_f32 v200, 1.0, v200
    v_add_f32 v201, 1.0, v201
    s_waitcnt vmcnt(28)
    v_mfma_f32_32x32x16_bf16 v[80:95], a[32:35], v[236:239], v[80:95]
    v_rcp_f32 v200, v200
    v_rcp_f32 v201, v201
    v_mul_f32 v202, v202, v200
    v_mfma_f32_32x32x16_bf16 v[96:111], a[36:39], v[236:239], v[96:111]
    s_add_u32 s69, s80, 16384
    buffer_load_dwordx4 v[236:239], v1, s[72:75], s69 offen offset:3072
    v_mul_f32 v203, v203, v201
    v_cvt_pk_bf16_f32 v216, v202, v203
    v_mul_f32 v204, v18, v18
    s_waitcnt vmcnt(27)
    v_mfma_f32_32x32x16_bf16 v[80:95], a[40:43], v[240:243], v[80:95]
    s_add_u32 s61, s67, s84
    s_add_u32 m0, s66, 57344
    s_add_u32 s61, s61, 184320
    buffer_load_dwordx4 v224, s[40:43], s61 offen lds
    v_mul_f32 v205, v19, v19
    v_fma_f32 v204, v204, s64, v14
    v_fma_f32 v205, v205, s64, v14
    v_mfma_f32_32x32x16_bf16 v[96:111], a[44:47], v[240:243], v[96:111]
    s_add_u32 s69, s80, 20480
    buffer_load_dwordx4 v[240:243], v1, s[72:75], s69 offen offset:0
    v_mul_f32 v204, v204, v18
    v_mul_f32 v205, v205, v19
    v_exp_f32 v204, v204
    s_waitcnt vmcnt(27)
    v_mfma_f32_32x32x16_bf16 v[80:95], a[48:51], v[244:247], v[80:95]
    v_exp_f32 v205, v205
    v_mul_f32 v206, v18, v26
    v_mul_f32 v207, v19, v27
    v_mfma_f32_32x32x16_bf16 v[96:111], a[52:55], v[244:247], v[96:111]
    s_add_u32 s69, s80, 20480
    buffer_load_dwordx4 v[244:247], v1, s[72:75], s69 offen offset:1024
    v_add_f32 v204, 1.0, v204
    v_add_f32 v205, 1.0, v205
    v_rcp_f32 v204, v204
    s_waitcnt vmcnt(23)
    v_mfma_f32_32x32x16_bf16 v[80:95], a[56:59], v[112:115], v[80:95]
    s_add_u32 s61, s67, s84
    s_add_u32 m0, s66, 61440
    s_add_u32 s61, s61, 221184
    buffer_load_dwordx4 v224, s[40:43], s61 offen lds
    v_rcp_f32 v205, v205
    v_mul_f32 v206, v206, v204
    v_mul_f32 v207, v207, v205
    v_mfma_f32_32x32x16_bf16 v[96:111], a[60:63], v[112:115], v[96:111]
    s_add_u32 s69, s80, 20480
    buffer_load_dwordx4 v[112:115], v1, s[72:75], s69 offen offset:2048
    v_cvt_pk_bf16_f32 v217, v206, v207
    v_mul_f32 v200, v20, v20
    v_mul_f32 v201, v21, v21
    s_waitcnt vmcnt(23)
    v_mfma_f32_32x32x16_bf16 v[80:95], a[64:67], v[116:119], v[80:95]
    v_fma_f32 v200, v200, s64, v14
    v_fma_f32 v201, v201, s64, v14
    v_mul_f32 v200, v200, v20
    v_mfma_f32_32x32x16_bf16 v[96:111], a[68:71], v[116:119], v[96:111]
    s_add_u32 s69, s80, 20480
    buffer_load_dwordx4 v[116:119], v1, s[72:75], s69 offen offset:3072
    v_mul_f32 v201, v201, v21
    v_exp_f32 v200, v200
    v_exp_f32 v201, v201
    s_waitcnt vmcnt(22)
    v_mfma_f32_32x32x16_bf16 v[80:95], a[72:75], v[120:123], v[80:95]
    s_add_u32 s61, s67, s84
    s_add_u32 m0, s66, 65536
    s_add_u32 s61, s61, 258048
    buffer_load_dwordx4 v224, s[40:43], s61 offen lds
    v_mul_f32 v202, v20, v28
    v_mul_f32 v203, v21, v29
    v_add_f32 v200, 1.0, v200
    v_mfma_f32_32x32x16_bf16 v[96:111], a[76:79], v[120:123], v[96:111]
    s_add_u32 s69, s80, 24576
    buffer_load_dwordx4 v[120:123], v1, s[72:75], s69 offen offset:0
    v_add_f32 v201, 1.0, v201
    v_rcp_f32 v200, v200
    v_rcp_f32 v201, v201
    s_waitcnt vmcnt(22)
    v_mfma_f32_32x32x16_bf16 v[80:95], a[80:83], v[124:127], v[80:95]
    v_mul_f32 v202, v202, v200
    v_mul_f32 v203, v203, v201
    v_cvt_pk_bf16_f32 v218, v202, v203
    v_mfma_f32_32x32x16_bf16 v[96:111], a[84:87], v[124:127], v[96:111]
    s_add_u32 s69, s80, 24576
    buffer_load_dwordx4 v[124:127], v1, s[72:75], s69 offen offset:1024
    v_mul_f32 v204, v22, v22
    v_mul_f32 v205, v23, v23
    v_fma_f32 v204, v204, s64, v14
    s_waitcnt vmcnt(21)
    v_mfma_f32_32x32x16_bf16 v[80:95], a[88:91], v[128:131], v[80:95]
    s_add_u32 s61, s68, s84
    s_add_u32 m0, s66, 69632
    s_add_u32 s61, s61, 0
    buffer_load_dwordx4 v224, s[40:43], s61 offen lds
    v_fma_f32 v205, v205, s64, v14
    v_mul_f32 v204, v204, v22
    v_mul_f32 v205, v205, v23
    v_mfma_f32_32x32x16_bf16 v[96:111], a[92:95], v[128:131], v[96:111]
    s_add_u32 s69, s80, 24576
    buffer_load_dwordx4 v[128:131], v1, s[72:75], s69 offen offset:2048
    v_exp_f32 v204, v204
    v_exp_f32 v205, v205
    v_mul_f32 v206, v22, v30
    s_waitcnt vmcnt(21)
    v_mfma_f32_32x32x16_bf16 v[80:95], a[96:99], v[132:135], v[80:95]
    v_mul_f32 v207, v23, v31
    v_add_f32 v204, 1.0, v204
    v_add_f32 v205, 1.0, v205
    v_mfma_f32_32x32x16_bf16 v[96:111], a[100:103], v[132:135], v[96:111]
    s_add_u32 s69, s80, 24576
    buffer_load_dwordx4 v[132:135], v1, s[72:75], s69 offen offset:3072
    v_rcp_f32 v204, v204
    v_rcp_f32 v205, v205
    v_mul_f32 v206, v206, v204
    s_waitcnt vmcnt(20)
    v_mfma_f32_32x32x16_bf16 v[80:95], a[104:107], v[136:139], v[80:95]
    v_mul_f32 v207, v207, v205
    v_cvt_pk_bf16_f32 v219, v206, v207
    ds_write_b128 v13, v[216:219] offset:0
    v_mfma_f32_32x32x16_bf16 v[96:111], a[108:111], v[136:139], v[96:111]
    s_add_u32 s69, s80, 28672
    buffer_load_dwordx4 v[136:139], v1, s[72:75], s69 offen offset:0
    v_mul_f32 v200, v32, v32
    v_mul_f32 v201, v33, v33
    v_fma_f32 v200, v200, s64, v14
    s_waitcnt vmcnt(20)
    v_mfma_f32_32x32x16_bf16 v[80:95], a[112:115], v[140:143], v[80:95]
    v_fma_f32 v201, v201, s64, v14
    v_mul_f32 v200, v200, v32
    v_mul_f32 v201, v201, v33
    v_mfma_f32_32x32x16_bf16 v[96:111], a[116:119], v[140:143], v[96:111]
    s_add_u32 s69, s80, 28672
    buffer_load_dwordx4 v[140:143], v1, s[72:75], s69 offen offset:1024
    v_exp_f32 v200, v200
    v_exp_f32 v201, v201
    v_mul_f32 v202, v32, v40
    s_waitcnt vmcnt(20)
    v_mfma_f32_32x32x16_bf16 v[80:95], a[120:123], v[180:183], v[80:95]
    v_mul_f32 v203, v33, v41
    v_add_f32 v200, 1.0, v200
    v_add_f32 v201, 1.0, v201
    v_mfma_f32_32x32x16_bf16 v[96:111], a[124:127], v[180:183], v[96:111]
    s_add_u32 s69, s80, 28672
    buffer_load_dwordx4 v[180:183], v1, s[72:75], s69 offen offset:2048
    v_rcp_f32 v200, v200
    v_rcp_f32 v201, v201
    v_mul_f32 v202, v202, v200
    s_waitcnt vmcnt(19)
    v_mfma_f32_32x32x16_bf16 v[80:95], a[128:131], v[188:191], v[80:95]
    v_mul_f32 v203, v203, v201
    v_cvt_pk_bf16_f32 v220, v202, v203
    v_mul_f32 v204, v34, v34
    v_mfma_f32_32x32x16_bf16 v[96:111], a[132:135], v[188:191], v[96:111]
    s_add_u32 s69, s80, 28672
    buffer_load_dwordx4 v[188:191], v1, s[72:75], s69 offen offset:3072
    v_mul_f32 v205, v35, v35
    v_fma_f32 v204, v204, s64, v14
    v_fma_f32 v205, v205, s64, v14
    s_waitcnt vmcnt(19)
    v_mfma_f32_32x32x16_bf16 v[80:95], a[136:139], v[196:199], v[80:95]
    v_mul_f32 v204, v204, v34
    v_mul_f32 v205, v205, v35
    v_exp_f32 v204, v204
    v_mfma_f32_32x32x16_bf16 v[96:111], a[140:143], v[196:199], v[96:111]
    s_add_u32 s69, s80, 32768
    buffer_load_dwordx4 v[196:199], v1, s[72:75], s69 offen offset:0
    v_exp_f32 v205, v205
    v_mul_f32 v206, v34, v42
    v_mul_f32 v207, v35, v43
    s_waitcnt vmcnt(18)
    v_mfma_f32_32x32x16_bf16 v[80:95], a[144:147], v[232:235], v[80:95]
    v_add_f32 v204, 1.0, v204
    v_add_f32 v205, 1.0, v205
    v_rcp_f32 v204, v204
    v_mfma_f32_32x32x16_bf16 v[96:111], a[148:151], v[232:235], v[96:111]
    s_add_u32 s69, s80, 32768
    buffer_load_dwordx4 v[232:235], v1, s[72:75], s69 offen offset:1024
    v_rcp_f32 v205, v205
    v_mul_f32 v206, v206, v204
    v_mul_f32 v207, v207, v205
    s_waitcnt vmcnt(18)
    v_mfma_f32_32x32x16_bf16 v[80:95], a[152:155], v[236:239], v[80:95]
    v_cvt_pk_bf16_f32 v221, v206, v207
    v_mul_f32 v200, v36, v36
    v_mul_f32 v201, v37, v37
    v_mfma_f32_32x32x16_bf16 v[96:111], a[156:159], v[236:239], v[96:111]
    s_add_u32 s69, s80, 32768
    buffer_load_dwordx4 v[236:239], v1, s[72:75], s69 offen offset:2048
    v_fma_f32 v200, v200, s64, v14
    v_fma_f32 v201, v201, s64, v14
    v_mul_f32 v200, v200, v36
    s_waitcnt vmcnt(17)
    v_mfma_f32_32x32x16_bf16 v[80:95], a[160:163], v[240:243], v[80:95]
    v_mul_f32 v201, v201, v37
    v_exp_f32 v200, v200
    v_exp_f32 v201, v201
    v_mfma_f32_32x32x16_bf16 v[96:111], a[164:167], v[240:243], v[96:111]
    s_add_u32 s69, s80, 32768
    buffer_load_dwordx4 v[240:243], v1, s[72:75], s69 offen offset:3072
    v_mul_f32 v202, v36, v44
    v_mul_f32 v203, v37, v45
    v_add_f32 v200, 1.0, v200
    s_waitcnt vmcnt(17)
    v_mfma_f32_32x32x16_bf16 v[80:95], a[168:171], v[244:247], v[80:95]
    v_add_f32 v201, 1.0, v201
    v_rcp_f32 v200, v200
    v_rcp_f32 v201, v201
    v_mfma_f32_32x32x16_bf16 v[96:111], a[172:175], v[244:247], v[96:111]
    v_mul_f32 v202, v202, v200
    v_mul_f32 v203, v203, v201
    v_cvt_pk_bf16_f32 v222, v202, v203
    s_waitcnt vmcnt(15)
    v_mfma_f32_32x32x16_bf16 v[80:95], a[176:179], v[112:115], v[80:95]
    v_mul_f32 v204, v38, v38
    v_mul_f32 v205, v39, v39
    v_fma_f32 v204, v204, s64, v14
    v_mfma_f32_32x32x16_bf16 v[96:111], a[180:183], v[112:115], v[96:111]
    v_fma_f32 v205, v205, s64, v14
    v_mul_f32 v204, v204, v38
    v_mul_f32 v205, v205, v39
    s_waitcnt vmcnt(14)
    v_mfma_f32_32x32x16_bf16 v[80:95], a[184:187], v[116:119], v[80:95]
    v_exp_f32 v204, v204
    v_exp_f32 v205, v205
    v_mul_f32 v206, v38, v46
    v_mfma_f32_32x32x16_bf16 v[96:111], a[188:191], v[116:119], v[96:111]
    v_mul_f32 v207, v39, v47
    v_add_f32 v204, 1.0, v204
    v_add_f32 v205, 1.0, v205
    s_waitcnt vmcnt(12)
    v_mfma_f32_32x32x16_bf16 v[80:95], a[192:195], v[120:123], v[80:95]
    v_rcp_f32 v204, v204
    v_rcp_f32 v205, v205
    v_mul_f32 v206, v206, v204
    v_mfma_f32_32x32x16_bf16 v[96:111], a[196:199], v[120:123], v[96:111]
    v_mul_f32 v207, v207, v205
    v_cvt_pk_bf16_f32 v223, v206, v207
    ds_write_b128 v13, v[220:223] offset:18432
    s_waitcnt vmcnt(11)
    v_mfma_f32_32x32x16_bf16 v[80:95], a[200:203], v[124:127], v[80:95]
    v_mfma_f32_32x32x16_bf16 v[96:111], a[204:207], v[124:127], v[96:111]
    s_waitcnt vmcnt(9)
    v_mfma_f32_32x32x16_bf16 v[80:95], a[208:211], v[128:131], v[80:95]
    v_mfma_f32_32x32x16_bf16 v[96:111], a[212:215], v[128:131], v[96:111]
    s_waitcnt vmcnt(8)
    v_mfma_f32_32x32x16_bf16 v[80:95], a[216:219], v[132:135], v[80:95]
    v_mfma_f32_32x32x16_bf16 v[96:111], a[220:223], v[132:135], v[96:111]
    s_waitcnt vmcnt(7)
    v_mfma_f32_32x32x16_bf16 v[80:95], a[224:227], v[136:139], v[80:95]
    v_mfma_f32_32x32x16_bf16 v[96:111], a[228:231], v[136:139], v[96:111]
    s_waitcnt vmcnt(6)
    v_mfma_f32_32x32x16_bf16 v[80:95], a[232:235], v[140:143], v[80:95]
    v_mfma_f32_32x32x16_bf16 v[96:111], a[236:239], v[140:143], v[96:111]
    s_waitcnt vmcnt(5)
    v_mfma_f32_32x32x16_bf16 v[80:95], a[240:243], v[180:183], v[80:95]
    v_mfma_f32_32x32x16_bf16 v[96:111], a[244:247], v[180:183], v[96:111]
    s_waitcnt vmcnt(4)
    v_mfma_f32_32x32x16_bf16 v[80:95], a[248:251], v[188:191], v[80:95]
    v_mfma_f32_32x32x16_bf16 v[96:111], a[252:255], v[188:191], v[96:111]
    s_waitcnt vmcnt(3)
    v_mfma_f32_32x32x16_bf16 v[80:95], v[144:147], v[196:199], v[80:95]
    v_mfma_f32_32x32x16_bf16 v[96:111], v[148:151], v[196:199], v[96:111]
    s_waitcnt vmcnt(2)
    v_mfma_f32_32x32x16_bf16 v[80:95], v[152:155], v[232:235], v[80:95]
    v_mfma_f32_32x32x16_bf16 v[96:111], v[156:159], v[232:235], v[96:111]
    s_waitcnt vmcnt(1)
    v_mfma_f32_32x32x16_bf16 v[80:95], v[160:163], v[236:239], v[80:95]
    v_mfma_f32_32x32x16_bf16 v[96:111], v[164:167], v[236:239], v[96:111]
    s_waitcnt vmcnt(0)
    v_mfma_f32_32x32x16_bf16 v[80:95], v[168:171], v[240:243], v[80:95]
    v_mfma_f32_32x32x16_bf16 v[96:111], v[172:175], v[240:243], v[96:111]
    s_waitcnt lgkmcnt(0)
    s_barrier
    ds_read_b128 a[0:3], v229 offset:0
    ds_read_b128 a[72:75], v229 offset:18432
    ds_read_b128 a[4:7], v229 offset:1024
    ds_read_b128 a[76:79], v229 offset:19456
    ds_read_b128 a[8:11], v229 offset:2048
    ds_read_b128 a[80:83], v229 offset:20480
    ds_read_b128 a[12:15], v229 offset:3072
    ds_read_b128 a[84:87], v229 offset:21504
    ds_read_b64_tr_b16 v[176:177], v225 offset:0
    ds_read_b64_tr_b16 v[178:179], v225 offset:1024
    ds_read_b64_tr_b16 v[180:181], v225 offset:2048
    ds_read_b64_tr_b16 v[182:183], v225 offset:3072
    ds_read_b64_tr_b16 v[184:185], v225 offset:4096
    ds_read_b64_tr_b16 v[186:187], v225 offset:5120
    s_waitcnt lgkmcnt(4)
    v_mfma_f32_32x32x16_bf16 v[16:31], v[176:179], a[0:3], 0
    ds_read_b128 a[16:19], v229 offset:4096
    ds_read_b128 a[88:91], v229 offset:22528
    ds_read_b64_tr_b16 v[188:189], v225 offset:6144
    v_mfma_f32_32x32x16_bf16 v[32:47], v[176:179], a[72:75], 0
    ds_read_b128 a[20:23], v229 offset:5120
    ds_read_b128 a[92:95], v229 offset:23552
    ds_read_b64_tr_b16 v[190:191], v225 offset:7168
    s_waitcnt lgkmcnt(8)
    v_mfma_f32_32x32x16_bf16 v[16:31], v[180:183], a[4:7], v[16:31]
    ds_read_b128 a[24:27], v229 offset:6144
    ds_read_b128 a[96:99], v229 offset:24576
    ds_read_b64_tr_b16 v[176:177], v225 offset:8192
    v_mfma_f32_32x32x16_bf16 v[32:47], v[180:183], a[76:79], v[32:47]
    ds_read_b128 a[28:31], v229 offset:7168
    ds_read_b128 a[100:103], v229 offset:25600
    ds_read_b64_tr_b16 v[178:179], v225 offset:9216
    s_waitcnt lgkmcnt(12)
    v_mfma_f32_32x32x16_bf16 v[16:31], v[184:187], a[8:11], v[16:31]
    ds_read_b128 a[32:35], v229 offset:8192
    ds_read_b128 a[104:107], v229 offset:26624
    ds_read_b64_tr_b16 v[180:181], v225 offset:10240
    v_cvt_pk_bf16_f32 v144, v80, v81
    v_cvt_pk_bf16_f32 v145, v82, v83
    v_mfma_f32_32x32x16_bf16 v[32:47], v[184:187], a[80:83], v[32:47]
    ds_read_b128 a[36:39], v229 offset:9216
    ds_read_b128 a[108:111], v229 offset:27648
    ds_read_b64_tr_b16 v[182:183], v225 offset:11264
    v_cvt_pk_bf16_f32 v146, v84, v85
    v_cvt_pk_bf16_f32 v147, v86, v87
    s_waitcnt lgkmcnt(12)
    v_mfma_f32_32x32x16_bf16 v[16:31], v[188:191], a[12:15], v[16:31]
    ds_read_b128 a[40:43], v229 offset:10240
    ds_read_b128 a[112:115], v229 offset:28672
    ds_read_b64_tr_b16 v[184:185], v225 offset:12288
    v_cvt_pk_bf16_f32 v148, v88, v89
    v_cvt_pk_bf16_f32 v149, v90, v91
    v_mfma_f32_32x32x16_bf16 v[32:47], v[188:191], a[84:87], v[32:47]
    ds_read_b128 a[44:47], v229 offset:11264
    ds_read_b128 a[116:119], v229 offset:29696
    ds_read_b64_tr_b16 v[186:187], v225 offset:13312
    v_cvt_pk_bf16_f32 v150, v92, v93
    v_cvt_pk_bf16_f32 v151, v94, v95
    s_waitcnt lgkmcnt(12)
    v_mfma_f32_32x32x16_bf16 v[16:31], v[176:179], a[16:19], v[16:31]
    ds_read_b128 a[48:51], v229 offset:12288
    ds_read_b128 a[120:123], v229 offset:30720
    ds_read_b64_tr_b16 v[188:189], v225 offset:14336
    s_nop 1
    v_permlane32_swap_b32 v144, v146
    v_permlane32_swap_b32 v145, v147
    v_permlane32_swap_b32 v148, v150
    v_permlane32_swap_b32 v149, v151
    v_mfma_f32_32x32x16_bf16 v[32:47], v[176:179], a[88:91], v[32:47]
    ds_read_b128 a[52:55], v229 offset:13312
    ds_read_b128 a[124:127], v229 offset:31744
    ds_read_b64_tr_b16 v[190:191], v225 offset:15360
    ds_write_b128 v230, v[144:147] offset:0
    s_waitcnt lgkmcnt(13)
    v_mfma_f32_32x32x16_bf16 v[16:31], v[180:183], a[20:23], v[16:31]
    ds_read_b128 a[56:59], v229 offset:14336
    ds_read_b128 a[128:131], v229 offset:32768
    ds_read_b64_tr_b16 v[176:177], v225 offset:16384
    ds_write_b128 v230, v[148:151] offset:32
    v_cvt_pk_bf16_f32 v152, v96, v97
    v_mfma_f32_32x32x16_bf16 v[32:47], v[180:183], a[92:95], v[32:47]
    ds_read_b128 a[60:63], v229 offset:15360
    ds_read_b128 a[132:135], v229 offset:33792
    ds_read_b64_tr_b16 v[178:179], v225 offset:17408
    v_cvt_pk_bf16_f32 v153, v98, v99
    v_cvt_pk_bf16_f32 v154, v100, v101
    s_waitcnt lgkmcnt(14)
    v_mfma_f32_32x32x16_bf16 v[16:31], v[184:187], a[24:27], v[16:31]
    ds_read_b128 a[64:67], v229 offset:16384
    ds_read_b128 a[136:139], v229 offset:34816
    ds_read_b64_tr_b16 v[180:181], v225 offset:18432
    v_cvt_pk_bf16_f32 v155, v102, v103
    v_cvt_pk_bf16_f32 v156, v104, v105
    v_mfma_f32_32x32x16_bf16 v[32:47], v[184:187], a[96:99], v[32:47]
    ds_read_b128 a[68:71], v229 offset:17408
    ds_read_b128 a[140:143], v229 offset:35840
    ds_read_b64_tr_b16 v[182:183], v225 offset:19456
    v_cvt_pk_bf16_f32 v157, v106, v107
    v_cvt_pk_bf16_f32 v158, v108, v109
    s_waitcnt lgkmcnt(14)
    v_mfma_f32_32x32x16_bf16 v[16:31], v[188:191], a[28:31], v[16:31]
    ds_read_b64_tr_b16 v[184:185], v225 offset:20480
    v_cvt_pk_bf16_f32 v159, v110, v111
    v_mfma_f32_32x32x16_bf16 v[32:47], v[188:191], a[100:103], v[32:47]
    ds_read_b64_tr_b16 v[186:187], v225 offset:21504
    s_nop 1
    v_permlane32_swap_b32 v152, v154
    v_permlane32_swap_b32 v153, v155
    v_permlane32_swap_b32 v156, v158
    v_permlane32_swap_b32 v157, v159
    s_waitcnt lgkmcnt(8)
    v_mfma_f32_32x32x16_bf16 v[16:31], v[176:179], a[32:35], v[16:31]
    s_waitcnt lgkmcnt(3)
    s_barrier
    ds_read_b64_tr_b16 v[188:189], v225 offset:22528
    s_add_u32 s84, s83, 2
    s_cmp_ge_u32 s84, 9
    s_cselect_b32 s62, 9, 0
    s_sub_u32 s84, s84, s62
    s_mul_i32 s84, s84, 128
    s_add_u32 s61, s67, s84
    s_add_u32 m0, s66, 73728
    s_add_u32 s61, s61, 0
    buffer_load_dwordx4 v224, s[40:43], s61 offen lds
    v_mfma_f32_32x32x16_bf16 v[32:47], v[176:179], a[104:107], v[32:47]
    ds_read_b64_tr_b16 v[190:191], v225 offset:23552
    ds_write_b128 v230, v[152:155] offset:64
    s_waitcnt lgkmcnt(5)
    v_mfma_f32_32x32x16_bf16 v[16:31], v[180:183], a[36:39], v[16:31]
    ds_read_b64_tr_b16 v[176:177], v225 offset:24576
    s_add_u32 s61, s67, s84
    s_add_u32 m0, s66, 77824
    s_add_u32 s61, s61, 36864
    buffer_load_dwordx4 v224, s[40:43], s61 offen lds
    v_mfma_f32_32x32x16_bf16 v[32:47], v[180:183], a[108:111], v[32:47]
    ds_read_b64_tr_b16 v[178:179], v225 offset:25600
    ds_write_b128 v230, v[156:159] offset:96
    s_waitcnt lgkmcnt(6)
    v_mfma_f32_32x32x16_bf16 v[16:31], v[184:187], a[40:43], v[16:31]
    ds_read_b64_tr_b16 v[180:181], v225 offset:26624
    s_add_u32 s61, s67, s84
    s_add_u32 m0, s66, 81920
    s_add_u32 s61, s61, 73728
    buffer_load_dwordx4 v224, s[40:43], s61 offen lds
    v_mfma_f32_32x32x16_bf16 v[32:47], v[184:187], a[112:115], v[32:47]
    ds_read_b64_tr_b16 v[182:183], v225 offset:27648
    s_waitcnt lgkmcnt(2)
    v_mfma_f32_32x32x16_bf16 v[16:31], v[188:191], a[44:47], v[16:31]
    ds_read_b64_tr_b16 v[184:185], v225 offset:28672
    s_add_u32 s61, s67, s84
    s_add_u32 m0, s66, 86016
    s_add_u32 s61, s61, 110592
    buffer_load_dwordx4 v224, s[40:43], s61 offen lds
    v_mfma_f32_32x32x16_bf16 v[32:47], v[188:191], a[116:119], v[32:47]
    ds_read_b64_tr_b16 v[186:187], v225 offset:29696
    ds_read_b128 v[112:115], v231 offset:0
    v_mfma_f32_32x32x16_bf16 v[16:31], v[176:179], a[48:51], v[16:31]
    ds_read_b64_tr_b16 v[188:189], v225 offset:30720
    s_add_u32 s61, s67, s84
    s_add_u32 m0, s66, 90112
    s_add_u32 s61, s61, 147456
    buffer_load_dwordx4 v224, s[40:43], s61 offen lds
    v_mfma_f32_32x32x16_bf16 v[32:47], v[176:179], a[120:123], v[32:47]
    ds_read_b64_tr_b16 v[190:191], v225 offset:31744
    ds_read_b128 v[116:119], v231 offset:1024
    s_waitcnt lgkmcnt(6)
    v_mfma_f32_32x32x16_bf16 v[16:31], v[180:183], a[52:55], v[16:31]
    ds_read_b64_tr_b16 v[176:177], v225 offset:32768
    s_add_u32 s61, s67, s84
    s_add_u32 m0, s66, 94208
    s_add_u32 s61, s61, 184320
    buffer_load_dwordx4 v224, s[40:43], s61 offen lds
    v_mfma_f32_32x32x16_bf16 v[32:47], v[180:183], a[124:127], v[32:47]
    ds_read_b64_tr_b16 v[178:179], v225 offset:33792
    ds_read_b128 v[120:123], v231 offset:2048
    s_waitcnt lgkmcnt(7)
    v_mfma_f32_32x32x16_bf16 v[16:31], v[184:187], a[56:59], v[16:31]
    ds_read_b64_tr_b16 v[180:181], v225 offset:34816
    s_add_u32 s61, s67, s84
    s_add_u32 m0, s66, 98304
    s_add_u32 s61, s61, 221184
    buffer_load_dwordx4 v224, s[40:43], s61 offen lds
    v_mfma_f32_32x32x16_bf16 v[32:47], v[184:187], a[128:131], v[32:47]
    ds_read_b64_tr_b16 v[182:183], v225 offset:35840
    ds_read_b128 v[124:127], v231 offset:3072
    s_waitcnt lgkmcnt(7)
    v_mfma_f32_32x32x16_bf16 v[16:31], v[188:191], a[60:63], v[16:31]
    s_waitcnt vmcnt(7)
    s_barrier
    ds_read_b64_tr_b16 v[184:185], v226 offset:0
    v_mfma_f32_32x32x16_bf16 v[32:47], v[188:191], a[132:135], v[32:47]
    ds_read_b64_tr_b16 v[186:187], v226 offset:1024
    s_add_u32 s61, s67, s84
    s_add_u32 m0, s66, 102400
    s_add_u32 s61, s61, 258048
    buffer_load_dwordx4 v224, s[40:43], s61 offen lds
    s_waitcnt lgkmcnt(6)
    v_mfma_f32_32x32x16_bf16 v[16:31], v[176:179], a[64:67], v[16:31]
    ds_read_b64_tr_b16 v[188:189], v226 offset:2048
    v_mfma_f32_32x32x16_bf16 v[32:47], v[176:179], a[136:139], v[32:47]
    ds_read_b64_tr_b16 v[190:191], v226 offset:3072
    s_add_u32 s61, s68, s84
    s_add_u32 m0, s66, 106496
    s_add_u32 s61, s61, 0
    buffer_load_dwordx4 v224, s[40:43], s61 offen lds
    s_waitcnt lgkmcnt(5)
    v_mfma_f32_32x32x16_bf16 v[16:31], v[180:183], a[68:71], v[16:31]
    ds_read_b64_tr_b16 v[176:177], v226 offset:4096
    v_mfma_f32_32x32x16_bf16 v[32:47], v[180:183], a[140:143], v[32:47]
    ds_read_b64_tr_b16 v[178:179], v226 offset:5120
    s_add_u32 s84, s83, 3
    s_cmp_ge_u32 s84, 9
    s_cselect_b32 s62, 9, 0
    s_sub_u32 s84, s84, s62
    s_mul_i32 s84, s84, 128
    s_add_u32 s61, s67, s84
    s_add_u32 m0, s66, 110592
    s_add_u32 s61, s61, 0
    buffer_load_dwordx4 v224, s[40:43], s61 offen lds
    s_add_u32 s69, s81, 0
    buffer_store_dwordx4 v[112:115], v254, s[76:79], s69 offen sc1
    s_add_u32 s69, s81, 65536
    buffer_store_dwordx4 v[116:119], v254, s[76:79], s69 offen sc1
    s_add_u32 s69, s81, 131072
    buffer_store_dwordx4 v[120:123], v254, s[76:79], s69 offen sc1
    s_waitcnt lgkmcnt(6)
    s_add_u32 s69, s81, 196608
    buffer_store_dwordx4 v[124:127], v254, s[76:79], s69 offen sc1
    s_waitcnt lgkmcnt(4)
    v_mfma_f32_32x32x16_bf16 v[48:63], v[184:187], a[0:3], 0
    ds_read_b64_tr_b16 v[180:181], v226 offset:6144
    s_add_u32 s61, s67, s84
    s_add_u32 m0, s66, 114688
    s_add_u32 s61, s61, 36864
    buffer_load_dwordx4 v224, s[40:43], s61 offen lds
    v_mfma_f32_32x32x16_bf16 v[64:79], v[184:187], a[72:75], 0
    ds_read_b64_tr_b16 v[182:183], v226 offset:7168
    s_waitcnt lgkmcnt(4)
    v_mfma_f32_32x32x16_bf16 v[48:63], v[188:191], a[4:7], v[48:63]
    ds_read_b64_tr_b16 v[184:185], v226 offset:8192
    s_add_u32 s61, s67, s84
    s_add_u32 m0, s66, 118784
    s_add_u32 s61, s61, 73728
    buffer_load_dwordx4 v224, s[40:43], s61 offen lds
    v_mfma_f32_32x32x16_bf16 v[64:79], v[188:191], a[76:79], v[64:79]
    ds_read_b64_tr_b16 v[186:187], v226 offset:9216
    s_waitcnt lgkmcnt(4)
    v_mfma_f32_32x32x16_bf16 v[48:63], v[176:179], a[8:11], v[48:63]
    ds_read_b64_tr_b16 v[188:189], v226 offset:10240
    s_add_u32 s61, s67, s84
    s_add_u32 m0, s66, 122880
    s_add_u32 s61, s61, 110592
    buffer_load_dwordx4 v224, s[40:43], s61 offen lds
    v_mfma_f32_32x32x16_bf16 v[64:79], v[176:179], a[80:83], v[64:79]
    ds_read_b64_tr_b16 v[190:191], v226 offset:11264
    v_cvt_pk_bf16_f32 v200, v16, v17
    v_cvt_pk_bf16_f32 v201, v18, v19
    s_waitcnt lgkmcnt(4)
    v_mfma_f32_32x32x16_bf16 v[48:63], v[180:183], a[12:15], v[48:63]
    ds_read_b64_tr_b16 v[176:177], v226 offset:12288
    s_add_u32 s61, s67, s84
    s_add_u32 m0, s66, 126976
    s_add_u32 s61, s61, 147456
    buffer_load_dwordx4 v224, s[40:43], s61 offen lds
    v_mfma_f32_32x32x16_bf16 v[64:79], v[180:183], a[84:87], v[64:79]
    ds_read_b64_tr_b16 v[178:179], v226 offset:13312
    v_cvt_pk_bf16_f32 v202, v20, v21
    v_cvt_pk_bf16_f32 v203, v22, v23
    s_waitcnt lgkmcnt(4)
    v_mfma_f32_32x32x16_bf16 v[48:63], v[184:187], a[16:19], v[48:63]
    ds_read_b64_tr_b16 v[180:181], v226 offset:14336
    s_add_u32 s61, s67, s84
    s_add_u32 m0, s66, 131072
    s_add_u32 s61, s61, 184320
    buffer_load_dwordx4 v224, s[40:43], s61 offen lds
    v_mfma_f32_32x32x16_bf16 v[64:79], v[184:187], a[88:91], v[64:79]
    ds_read_b64_tr_b16 v[182:183], v226 offset:15360
    v_cvt_pk_bf16_f32 v204, v24, v25
    v_cvt_pk_bf16_f32 v205, v26, v27
    s_waitcnt lgkmcnt(4)
    v_mfma_f32_32x32x16_bf16 v[48:63], v[188:191], a[20:23], v[48:63]
    ds_read_b64_tr_b16 v[184:185], v226 offset:16384
    s_add_u32 s61, s67, s84
    s_add_u32 m0, s66, 135168
    s_add_u32 s61, s61, 221184
    buffer_load_dwordx4 v224, s[40:43], s61 offen lds
    v_mfma_f32_32x32x16_bf16 v[64:79], v[188:191], a[92:95], v[64:79]
    ds_read_b64_tr_b16 v[186:187], v226 offset:17408
    v_cvt_pk_bf16_f32 v206, v28, v29
    v_cvt_pk_bf16_f32 v207, v30, v31
    s_waitcnt lgkmcnt(4)
    v_mfma_f32_32x32x16_bf16 v[48:63], v[176:179], a[24:27], v[48:63]
    ds_read_b64_tr_b16 v[188:189], v226 offset:18432
    s_add_u32 s61, s67, s84
    s_add_u32 m0, s66, 139264
    s_add_u32 s61, s61, 258048
    buffer_load_dwordx4 v224, s[40:43], s61 offen lds
    v_mfma_f32_32x32x16_bf16 v[64:79], v[176:179], a[96:99], v[64:79]
    ds_read_b64_tr_b16 v[190:191], v226 offset:19456
    s_waitcnt lgkmcnt(4)
    v_mfma_f32_32x32x16_bf16 v[48:63], v[180:183], a[28:31], v[48:63]
    ds_read_b64_tr_b16 v[176:177], v226 offset:20480
    s_add_u32 s61, s68, s84
    s_add_u32 m0, s66, 143360
    s_add_u32 s61, s61, 0
    buffer_load_dwordx4 v224, s[40:43], s61 offen lds
    v_mfma_f32_32x32x16_bf16 v[64:79], v[180:183], a[100:103], v[64:79]
    ds_read_b64_tr_b16 v[178:179], v226 offset:21504
    s_waitcnt lgkmcnt(4)
    v_mfma_f32_32x32x16_bf16 v[48:63], v[184:187], a[32:35], v[48:63]
    ds_read_b64_tr_b16 v[180:181], v226 offset:22528
    s_add_u32 s85, s83, 0
    s_cmp_ge_u32 s85, 9
    s_cselect_b32 s87, 9, 0
    s_sub_u32 s85, s85, s87
    s_mul_i32 s85, s85, 65536
    s_add_u32 s69, s65, s85
    s_add_u32 s69, s69, 0
    buffer_store_dwordx4 v[200:203], v1, s[44:47], s69 offen sc1
    v_mfma_f32_32x32x16_bf16 v[64:79], v[184:187], a[104:107], v[64:79]
    ds_read_b64_tr_b16 v[182:183], v226 offset:23552
    s_waitcnt lgkmcnt(4)
    v_mfma_f32_32x32x16_bf16 v[48:63], v[188:191], a[36:39], v[48:63]
    ds_read_b64_tr_b16 v[184:185], v226 offset:24576
    s_add_u32 s69, s65, s85
    s_add_u32 s69, s69, 16384
    buffer_store_dwordx4 v[204:207], v1, s[44:47], s69 offen sc1
    v_mfma_f32_32x32x16_bf16 v[64:79], v[188:191], a[108:111], v[64:79]
    ds_read_b64_tr_b16 v[186:187], v226 offset:25600
    v_cvt_pk_bf16_f32 v208, v32, v33
    v_cvt_pk_bf16_f32 v209, v34, v35
    s_waitcnt lgkmcnt(4)
    v_mfma_f32_32x32x16_bf16 v[48:63], v[176:179], a[40:43], v[48:63]
    ds_read_b64_tr_b16 v[188:189], v226 offset:26624
    v_cvt_pk_bf16_f32 v210, v36, v37
    v_cvt_pk_bf16_f32 v211, v38, v39
    v_mfma_f32_32x32x16_bf16 v[64:79], v[176:179], a[112:115], v[64:79]
    ds_read_b64_tr_b16 v[190:191], v226 offset:27648
    v_cvt_pk_bf16_f32 v212, v40, v41
    v_cvt_pk_bf16_f32 v213, v42, v43
    s_waitcnt lgkmcnt(4)
    v_mfma_f32_32x32x16_bf16 v[48:63], v[180:183], a[44:47], v[48:63]
    ds_read_b64_tr_b16 v[176:177], v226 offset:28672
    v_cvt_pk_bf16_f32 v214, v44, v45
    v_cvt_pk_bf16_f32 v215, v46, v47
    v_mfma_f32_32x32x16_bf16 v[64:79], v[180:183], a[116:119], v[64:79]
    ds_read_b64_tr_b16 v[178:179], v226 offset:29696
    s_add_u32 s69, s65, s85
    s_add_u32 s69, s69, 589824
    buffer_store_dwordx4 v[208:211], v1, s[44:47], s69 offen sc1
    s_waitcnt lgkmcnt(4)
    v_mfma_f32_32x32x16_bf16 v[48:63], v[184:187], a[48:51], v[48:63]
    ds_read_b64_tr_b16 v[180:181], v226 offset:30720
    v_mfma_f32_32x32x16_bf16 v[64:79], v[184:187], a[120:123], v[64:79]
    ds_read_b64_tr_b16 v[182:183], v226 offset:31744
    s_add_u32 s69, s65, s85
    s_add_u32 s69, s69, 606208
    buffer_store_dwordx4 v[212:215], v1, s[44:47], s69 offen sc1
    s_waitcnt lgkmcnt(4)
    v_mfma_f32_32x32x16_bf16 v[48:63], v[188:191], a[52:55], v[48:63]
    ds_read_b64_tr_b16 v[184:185], v226 offset:32768
    v_mfma_f32_32x32x16_bf16 v[64:79], v[188:191], a[124:127], v[64:79]
    ds_read_b64_tr_b16 v[186:187], v226 offset:33792
    s_waitcnt lgkmcnt(4)
    v_mfma_f32_32x32x16_bf16 v[48:63], v[176:179], a[56:59], v[48:63]
    ds_read_b64_tr_b16 v[188:189], v226 offset:34816
    v_mfma_f32_32x32x16_bf16 v[64:79], v[176:179], a[128:131], v[64:79]
    ds_read_b64_tr_b16 v[190:191], v226 offset:35840
    s_waitcnt lgkmcnt(4)
    v_mfma_f32_32x32x16_bf16 v[48:63], v[180:183], a[60:63], v[48:63]
    s_waitcnt vmcnt(12)
    s_barrier
    v_lshlrev_b32 v249, 20, v248
    v_add_u32 v249, s86, v249
    v_mov_b32 v250, 1
    buffer_store_dword v250, v249, s[96:99], 0 offen sc1
    ds_read_b64_tr_b16 v[176:177], v227 offset:0
    v_mfma_f32_32x32x16_bf16 v[64:79], v[180:183], a[132:135], v[64:79]
    ds_read_b64_tr_b16 v[178:179], v227 offset:1024
    s_add_u32 s84, s83, 4
    s_cmp_ge_u32 s84, 9
    s_cselect_b32 s62, 9, 0
    s_sub_u32 s84, s84, s62
    s_mul_i32 s84, s84, 128
    s_add_u32 s61, s67, s84
    s_add_u32 m0, s66, 0
    s_add_u32 s61, s61, 0
    buffer_load_dwordx4 v224, s[40:43], s61 offen lds
    s_waitcnt lgkmcnt(4)
    v_mfma_f32_32x32x16_bf16 v[48:63], v[184:187], a[64:67], v[48:63]
    ds_read_b64_tr_b16 v[180:181], v227 offset:2048
    v_mfma_f32_32x32x16_bf16 v[64:79], v[184:187], a[136:139], v[64:79]
    ds_read_b64_tr_b16 v[182:183], v227 offset:3072
    s_add_u32 s61, s67, s84
    s_add_u32 m0, s66, 4096
    s_add_u32 s61, s61, 36864
    buffer_load_dwordx4 v224, s[40:43], s61 offen lds
    s_waitcnt lgkmcnt(4)
    v_mfma_f32_32x32x16_bf16 v[48:63], v[188:191], a[68:71], v[48:63]
    ds_read_b64_tr_b16 v[184:185], v227 offset:4096
    v_mfma_f32_32x32x16_bf16 v[64:79], v[188:191], a[140:143], v[64:79]
    ds_read_b64_tr_b16 v[186:187], v227 offset:5120
    s_add_u32 s61, s67, s84
    s_add_u32 m0, s66, 8192
    s_add_u32 s61, s61, 73728
    buffer_load_dwordx4 v224, s[40:43], s61 offen lds
    s_waitcnt lgkmcnt(4)
    v_mfma_f32_32x32x16_bf16 v[16:31], v[176:179], a[0:3], 0
    ds_read_b64_tr_b16 v[188:189], v227 offset:6144
    s_add_u32 s61, s67, s84
    s_add_u32 m0, s66, 12288
    s_add_u32 s61, s61, 110592
    buffer_load_dwordx4 v224, s[40:43], s61 offen lds
    v_mfma_f32_32x32x16_bf16 v[32:47], v[176:179], a[72:75], 0
    ds_read_b64_tr_b16 v[190:191], v227 offset:7168
    s_waitcnt lgkmcnt(4)
    v_mfma_f32_32x32x16_bf16 v[16:31], v[180:183], a[4:7], v[16:31]
    ds_read_b64_tr_b16 v[176:177], v227 offset:8192
    s_add_u32 s61, s67, s84
    s_add_u32 m0, s66, 16384
    s_add_u32 s61, s61, 147456
    buffer_load_dwordx4 v224, s[40:43], s61 offen lds
    v_mfma_f32_32x32x16_bf16 v[32:47], v[180:183], a[76:79], v[32:47]
    ds_read_b64_tr_b16 v[178:179], v227 offset:9216
    s_waitcnt lgkmcnt(4)
    v_mfma_f32_32x32x16_bf16 v[16:31], v[184:187], a[8:11], v[16:31]
    ds_read_b64_tr_b16 v[180:181], v227 offset:10240
    s_add_u32 s61, s67, s84
    s_add_u32 m0, s66, 20480
    s_add_u32 s61, s61, 184320
    buffer_load_dwordx4 v224, s[40:43], s61 offen lds
    v_mfma_f32_32x32x16_bf16 v[32:47], v[184:187], a[80:83], v[32:47]
    ds_read_b64_tr_b16 v[182:183], v227 offset:11264
    v_cvt_pk_bf16_f32 v200, v48, v49
    v_cvt_pk_bf16_f32 v201, v50, v51
    s_waitcnt lgkmcnt(4)
    v_mfma_f32_32x32x16_bf16 v[16:31], v[188:191], a[12:15], v[16:31]
    ds_read_b64_tr_b16 v[184:185], v227 offset:12288
    s_add_u32 s61, s67, s84
    s_add_u32 m0, s66, 24576
    s_add_u32 s61, s61, 221184
    buffer_load_dwordx4 v224, s[40:43], s61 offen lds
    v_mfma_f32_32x32x16_bf16 v[32:47], v[188:191], a[84:87], v[32:47]
    ds_read_b64_tr_b16 v[186:187], v227 offset:13312
    v_cvt_pk_bf16_f32 v202, v52, v53
    v_cvt_pk_bf16_f32 v203, v54, v55
    s_waitcnt lgkmcnt(4)
    v_mfma_f32_32x32x16_bf16 v[16:31], v[176:179], a[16:19], v[16:31]
    ds_read_b64_tr_b16 v[188:189], v227 offset:14336
    s_add_u32 s61, s67, s84
    s_add_u32 m0, s66, 28672
    s_add_u32 s61, s61, 258048
    buffer_load_dwordx4 v224, s[40:43], s61 offen lds
    v_mfma_f32_32x32x16_bf16 v[32:47], v[176:179], a[88:91], v[32:47]
    ds_read_b64_tr_b16 v[190:191], v227 offset:15360
    v_cvt_pk_bf16_f32 v204, v56, v57
    v_cvt_pk_bf16_f32 v205, v58, v59
    s_waitcnt lgkmcnt(4)
    v_mfma_f32_32x32x16_bf16 v[16:31], v[180:183], a[20:23], v[16:31]
    ds_read_b64_tr_b16 v[176:177], v227 offset:16384
    s_add_u32 s61, s68, s84
    s_add_u32 m0, s66, 32768
    s_add_u32 s61, s61, 0
    buffer_load_dwordx4 v224, s[40:43], s61 offen lds
    v_mfma_f32_32x32x16_bf16 v[32:47], v[180:183], a[92:95], v[32:47]
    ds_read_b64_tr_b16 v[178:179], v227 offset:17408
    v_cvt_pk_bf16_f32 v206, v60, v61
    v_cvt_pk_bf16_f32 v207, v62, v63
    s_waitcnt lgkmcnt(4)
    v_mfma_f32_32x32x16_bf16 v[16:31], v[184:187], a[24:27], v[16:31]
    ds_read_b64_tr_b16 v[180:181], v227 offset:18432
    s_add_u32 s85, s83, 1
    s_cmp_ge_u32 s85, 9
    s_cselect_b32 s87, 9, 0
    s_sub_u32 s85, s85, s87
    s_mul_i32 s85, s85, 65536
    s_add_u32 s69, s65, s85
    s_add_u32 s69, s69, 0
    buffer_store_dwordx4 v[200:203], v1, s[44:47], s69 offen sc1
    v_mfma_f32_32x32x16_bf16 v[32:47], v[184:187], a[96:99], v[32:47]
    ds_read_b64_tr_b16 v[182:183], v227 offset:19456
    s_waitcnt lgkmcnt(4)
    v_mfma_f32_32x32x16_bf16 v[16:31], v[188:191], a[28:31], v[16:31]
    ds_read_b64_tr_b16 v[184:185], v227 offset:20480
    s_add_u32 s69, s65, s85
    s_add_u32 s69, s69, 16384
    buffer_store_dwordx4 v[204:207], v1, s[44:47], s69 offen sc1
    v_mfma_f32_32x32x16_bf16 v[32:47], v[188:191], a[100:103], v[32:47]
    ds_read_b64_tr_b16 v[186:187], v227 offset:21504
    v_cvt_pk_bf16_f32 v208, v64, v65
    v_cvt_pk_bf16_f32 v209, v66, v67
    s_waitcnt lgkmcnt(4)
    v_mfma_f32_32x32x16_bf16 v[16:31], v[176:179], a[32:35], v[16:31]
    ds_read_b64_tr_b16 v[188:189], v227 offset:22528
    v_cvt_pk_bf16_f32 v210, v68, v69
    v_cvt_pk_bf16_f32 v211, v70, v71
    v_mfma_f32_32x32x16_bf16 v[32:47], v[176:179], a[104:107], v[32:47]
    ds_read_b64_tr_b16 v[190:191], v227 offset:23552
    v_cvt_pk_bf16_f32 v212, v72, v73
    v_cvt_pk_bf16_f32 v213, v74, v75
    s_waitcnt lgkmcnt(4)
    v_mfma_f32_32x32x16_bf16 v[16:31], v[180:183], a[36:39], v[16:31]
    ds_read_b64_tr_b16 v[176:177], v227 offset:24576
    v_cvt_pk_bf16_f32 v214, v76, v77
    v_cvt_pk_bf16_f32 v215, v78, v79
    v_mfma_f32_32x32x16_bf16 v[32:47], v[180:183], a[108:111], v[32:47]
    ds_read_b64_tr_b16 v[178:179], v227 offset:25600
    s_add_u32 s69, s65, s85
    s_add_u32 s69, s69, 589824
    buffer_store_dwordx4 v[208:211], v1, s[44:47], s69 offen sc1
    s_waitcnt lgkmcnt(4)
    v_mfma_f32_32x32x16_bf16 v[16:31], v[184:187], a[40:43], v[16:31]
    ds_read_b64_tr_b16 v[180:181], v227 offset:26624
    v_mfma_f32_32x32x16_bf16 v[32:47], v[184:187], a[112:115], v[32:47]
    ds_read_b64_tr_b16 v[182:183], v227 offset:27648
    s_add_u32 s69, s65, s85
    s_add_u32 s69, s69, 606208
    buffer_store_dwordx4 v[212:215], v1, s[44:47], s69 offen sc1
    s_waitcnt lgkmcnt(4)
    v_mfma_f32_32x32x16_bf16 v[16:31], v[188:191], a[44:47], v[16:31]
    ds_read_b64_tr_b16 v[184:185], v227 offset:28672
    v_mfma_f32_32x32x16_bf16 v[32:47], v[188:191], a[116:119], v[32:47]
    ds_read_b64_tr_b16 v[186:187], v227 offset:29696
    s_waitcnt lgkmcnt(4)
    v_mfma_f32_32x32x16_bf16 v[16:31], v[176:179], a[48:51], v[16:31]
    ds_read_b64_tr_b16 v[188:189], v227 offset:30720
    v_mfma_f32_32x32x16_bf16 v[32:47], v[176:179], a[120:123], v[32:47]
    ds_read_b64_tr_b16 v[190:191], v227 offset:31744
    s_waitcnt lgkmcnt(4)
    v_mfma_f32_32x32x16_bf16 v[16:31], v[180:183], a[52:55], v[16:31]
    ds_read_b64_tr_b16 v[176:177], v227 offset:32768
    v_mfma_f32_32x32x16_bf16 v[32:47], v[180:183], a[124:127], v[32:47]
    ds_read_b64_tr_b16 v[178:179], v227 offset:33792
    s_waitcnt lgkmcnt(4)
    v_mfma_f32_32x32x16_bf16 v[16:31], v[184:187], a[56:59], v[16:31]
    ds_read_b64_tr_b16 v[180:181], v227 offset:34816
    v_mfma_f32_32x32x16_bf16 v[32:47], v[184:187], a[128:131], v[32:47]
    ds_read_b64_tr_b16 v[182:183], v227 offset:35840
    s_waitcnt lgkmcnt(4)
    v_mfma_f32_32x32x16_bf16 v[16:31], v[188:191], a[60:63], v[16:31]
    s_waitcnt vmcnt(18)
    s_barrier
    ds_read_b64_tr_b16 v[184:185], v228 offset:0
    v_mfma_f32_32x32x16_bf16 v[32:47], v[188:191], a[132:135], v[32:47]
    ds_read_b64_tr_b16 v[186:187], v228 offset:1024
    s_add_u32 s84, s83, 5
    s_cmp_ge_u32 s84, 9
    s_cselect_b32 s62, 9, 0
    s_sub_u32 s84, s84, s62
    s_mul_i32 s84, s84, 128
    s_add_u32 s61, s67, s84
    s_add_u32 m0, s66, 36864
    s_add_u32 s61, s61, 0
    buffer_load_dwordx4 v224, s[40:43], s61 offen lds
    s_waitcnt lgkmcnt(4)
    v_mfma_f32_32x32x16_bf16 v[16:31], v[176:179], a[64:67], v[16:31]
    ds_read_b64_tr_b16 v[188:189], v228 offset:2048
    v_mfma_f32_32x32x16_bf16 v[32:47], v[176:179], a[136:139], v[32:47]
    ds_read_b64_tr_b16 v[190:191], v228 offset:3072
    s_add_u32 s61, s67, s84
    s_add_u32 m0, s66, 40960
    s_add_u32 s61, s61, 36864
    buffer_load_dwordx4 v224, s[40:43], s61 offen lds
    s_waitcnt lgkmcnt(4)
    v_mfma_f32_32x32x16_bf16 v[16:31], v[180:183], a[68:71], v[16:31]
    ds_read_b64_tr_b16 v[176:177], v228 offset:4096
    v_mfma_f32_32x32x16_bf16 v[32:47], v[180:183], a[140:143], v[32:47]
    ds_read_b64_tr_b16 v[178:179], v228 offset:5120
    s_add_u32 s61, s67, s84
    s_add_u32 m0, s66, 45056
    s_add_u32 s61, s61, 73728
    buffer_load_dwordx4 v224, s[40:43], s61 offen lds
    s_waitcnt lgkmcnt(4)
    v_mfma_f32_32x32x16_bf16 v[48:63], v[184:187], a[0:3], 0
    ds_read_b64_tr_b16 v[180:181], v228 offset:6144
    s_add_u32 s61, s67, s84
    s_add_u32 m0, s66, 49152
    s_add_u32 s61, s61, 110592
    buffer_load_dwordx4 v224, s[40:43], s61 offen lds
    v_mfma_f32_32x32x16_bf16 v[64:79], v[184:187], a[72:75], 0
    ds_read_b64_tr_b16 v[182:183], v228 offset:7168
    s_waitcnt lgkmcnt(4)
    v_mfma_f32_32x32x16_bf16 v[48:63], v[188:191], a[4:7], v[48:63]
    ds_read_b64_tr_b16 v[184:185], v228 offset:8192
    s_add_u32 s61, s67, s84
    s_add_u32 m0, s66, 53248
    s_add_u32 s61, s61, 147456
    buffer_load_dwordx4 v224, s[40:43], s61 offen lds
    v_mfma_f32_32x32x16_bf16 v[64:79], v[188:191], a[76:79], v[64:79]
    ds_read_b64_tr_b16 v[186:187], v228 offset:9216
    s_waitcnt lgkmcnt(4)
    v_mfma_f32_32x32x16_bf16 v[48:63], v[176:179], a[8:11], v[48:63]
    ds_read_b64_tr_b16 v[188:189], v228 offset:10240
    s_add_u32 s61, s67, s84
    s_add_u32 m0, s66, 57344
    s_add_u32 s61, s61, 184320
    buffer_load_dwordx4 v224, s[40:43], s61 offen lds
    v_mfma_f32_32x32x16_bf16 v[64:79], v[176:179], a[80:83], v[64:79]
    ds_read_b64_tr_b16 v[190:191], v228 offset:11264
    v_cvt_pk_bf16_f32 v200, v16, v17
    v_cvt_pk_bf16_f32 v201, v18, v19
    s_waitcnt lgkmcnt(4)
    v_mfma_f32_32x32x16_bf16 v[48:63], v[180:183], a[12:15], v[48:63]
    ds_read_b64_tr_b16 v[176:177], v228 offset:12288
    s_add_u32 s61, s67, s84
    s_add_u32 m0, s66, 61440
    s_add_u32 s61, s61, 221184
    buffer_load_dwordx4 v224, s[40:43], s61 offen lds
    v_mfma_f32_32x32x16_bf16 v[64:79], v[180:183], a[84:87], v[64:79]
    ds_read_b64_tr_b16 v[178:179], v228 offset:13312
    v_cvt_pk_bf16_f32 v202, v20, v21
    v_cvt_pk_bf16_f32 v203, v22, v23
    s_waitcnt lgkmcnt(4)
    v_mfma_f32_32x32x16_bf16 v[48:63], v[184:187], a[16:19], v[48:63]
    ds_read_b64_tr_b16 v[180:181], v228 offset:14336
    s_add_u32 s61, s67, s84
    s_add_u32 m0, s66, 65536
    s_add_u32 s61, s61, 258048
    buffer_load_dwordx4 v224, s[40:43], s61 offen lds
    v_mfma_f32_32x32x16_bf16 v[64:79], v[184:187], a[88:91], v[64:79]
    ds_read_b64_tr_b16 v[182:183], v228 offset:15360
    v_cvt_pk_bf16_f32 v204, v24, v25
    v_cvt_pk_bf16_f32 v205, v26, v27
    s_waitcnt lgkmcnt(4)
    v_mfma_f32_32x32x16_bf16 v[48:63], v[188:191], a[20:23], v[48:63]
    ds_read_b64_tr_b16 v[184:185], v228 offset:16384
    s_add_u32 s61, s68, s84
    s_add_u32 m0, s66, 69632
    s_add_u32 s61, s61, 0
    buffer_load_dwordx4 v224, s[40:43], s61 offen lds
    v_mfma_f32_32x32x16_bf16 v[64:79], v[188:191], a[92:95], v[64:79]
    ds_read_b64_tr_b16 v[186:187], v228 offset:17408
    v_cvt_pk_bf16_f32 v206, v28, v29
    v_cvt_pk_bf16_f32 v207, v30, v31
    s_waitcnt lgkmcnt(4)
    v_mfma_f32_32x32x16_bf16 v[48:63], v[176:179], a[24:27], v[48:63]
    ds_read_b64_tr_b16 v[188:189], v228 offset:18432
    s_add_u32 s85, s83, 2
    s_cmp_ge_u32 s85, 9
    s_cselect_b32 s87, 9, 0
    s_sub_u32 s85, s85, s87
    s_mul_i32 s85, s85, 65536
    s_add_u32 s69, s65, s85
    s_add_u32 s69, s69, 0
    buffer_store_dwordx4 v[200:203], v1, s[44:47], s69 offen sc1
    v_mfma_f32_32x32x16_bf16 v[64:79], v[176:179], a[96:99], v[64:79]
    ds_read_b64_tr_b16 v[190:191], v228 offset:19456
    s_waitcnt lgkmcnt(4)
    v_mfma_f32_32x32x16_bf16 v[48:63], v[180:183], a[28:31], v[48:63]
    ds_read_b64_tr_b16 v[176:177], v228 offset:20480
    s_add_u32 s69, s65, s85
    s_add_u32 s69, s69, 16384
    buffer_store_dwordx4 v[204:207], v1, s[44:47], s69 offen sc1
    v_mfma_f32_32x32x16_bf16 v[64:79], v[180:183], a[100:103], v[64:79]
    ds_read_b64_tr_b16 v[178:179], v228 offset:21504
    v_cvt_pk_bf16_f32 v208, v32, v33
    v_cvt_pk_bf16_f32 v209, v34, v35
    s_waitcnt lgkmcnt(4)
    v_mfma_f32_32x32x16_bf16 v[48:63], v[184:187], a[32:35], v[48:63]
    ds_read_b64_tr_b16 v[180:181], v228 offset:22528
    v_cvt_pk_bf16_f32 v210, v36, v37
    v_cvt_pk_bf16_f32 v211, v38, v39
    v_mfma_f32_32x32x16_bf16 v[64:79], v[184:187], a[104:107], v[64:79]
    ds_read_b64_tr_b16 v[182:183], v228 offset:23552
    v_cvt_pk_bf16_f32 v212, v40, v41
    v_cvt_pk_bf16_f32 v213, v42, v43
    s_waitcnt lgkmcnt(4)
    v_mfma_f32_32x32x16_bf16 v[48:63], v[188:191], a[36:39], v[48:63]
    ds_read_b64_tr_b16 v[184:185], v228 offset:24576
    v_cvt_pk_bf16_f32 v214, v44, v45
    v_cvt_pk_bf16_f32 v215, v46, v47
    v_mfma_f32_32x32x16_bf16 v[64:79], v[188:191], a[108:111], v[64:79]
    ds_read_b64_tr_b16 v[186:187], v228 offset:25600
    s_add_u32 s69, s65, s85
    s_add_u32 s69, s69, 589824
    buffer_store_dwordx4 v[208:211], v1, s[44:47], s69 offen sc1
    s_waitcnt lgkmcnt(4)
    v_mfma_f32_32x32x16_bf16 v[48:63], v[176:179], a[40:43], v[48:63]
    ds_read_b64_tr_b16 v[188:189], v228 offset:26624
    v_mfma_f32_32x32x16_bf16 v[64:79], v[176:179], a[112:115], v[64:79]
    ds_read_b64_tr_b16 v[190:191], v228 offset:27648
    s_add_u32 s69, s65, s85
    s_add_u32 s69, s69, 606208
    buffer_store_dwordx4 v[212:215], v1, s[44:47], s69 offen sc1
    s_waitcnt lgkmcnt(4)
    v_mfma_f32_32x32x16_bf16 v[48:63], v[180:183], a[44:47], v[48:63]
    ds_read_b64_tr_b16 v[176:177], v228 offset:28672
    v_mfma_f32_32x32x16_bf16 v[64:79], v[180:183], a[116:119], v[64:79]
    ds_read_b64_tr_b16 v[178:179], v228 offset:29696
    s_waitcnt lgkmcnt(4)
    v_mfma_f32_32x32x16_bf16 v[48:63], v[184:187], a[48:51], v[48:63]
    ds_read_b64_tr_b16 v[180:181], v228 offset:30720
    v_mfma_f32_32x32x16_bf16 v[64:79], v[184:187], a[120:123], v[64:79]
    ds_read_b64_tr_b16 v[182:183], v228 offset:31744
    s_waitcnt lgkmcnt(4)
    v_mfma_f32_32x32x16_bf16 v[48:63], v[188:191], a[52:55], v[48:63]
    ds_read_b64_tr_b16 v[184:185], v228 offset:32768
    v_mfma_f32_32x32x16_bf16 v[64:79], v[188:191], a[124:127], v[64:79]
    ds_read_b64_tr_b16 v[186:187], v228 offset:33792
    s_waitcnt lgkmcnt(4)
    v_mfma_f32_32x32x16_bf16 v[48:63], v[176:179], a[56:59], v[48:63]
    ds_read_b64_tr_b16 v[188:189], v228 offset:34816
    v_mfma_f32_32x32x16_bf16 v[64:79], v[176:179], a[128:131], v[64:79]
    ds_read_b64_tr_b16 v[190:191], v228 offset:35840
    s_waitcnt lgkmcnt(4)
    v_mfma_f32_32x32x16_bf16 v[48:63], v[180:183], a[60:63], v[48:63]
    s_waitcnt vmcnt(17)
    s_barrier
    ds_read_b64_tr_b16 v[176:177], v225 offset:0
    v_mfma_f32_32x32x16_bf16 v[64:79], v[180:183], a[132:135], v[64:79]
    ds_read_b64_tr_b16 v[178:179], v225 offset:1024
    s_add_u32 s84, s83, 6
    s_cmp_ge_u32 s84, 9
    s_cselect_b32 s62, 9, 0
    s_sub_u32 s84, s84, s62
    s_mul_i32 s84, s84, 128
    s_add_u32 s61, s67, s84
    s_add_u32 m0, s66, 73728
    s_add_u32 s61, s61, 0
    buffer_load_dwordx4 v224, s[40:43], s61 offen lds
    s_waitcnt lgkmcnt(4)
    v_mfma_f32_32x32x16_bf16 v[48:63], v[184:187], a[64:67], v[48:63]
    ds_read_b64_tr_b16 v[180:181], v225 offset:2048
    v_mfma_f32_32x32x16_bf16 v[64:79], v[184:187], a[136:139], v[64:79]
    ds_read_b64_tr_b16 v[182:183], v225 offset:3072
    s_add_u32 s61, s67, s84
    s_add_u32 m0, s66, 77824
    s_add_u32 s61, s61, 36864
    buffer_load_dwordx4 v224, s[40:43], s61 offen lds
    s_waitcnt lgkmcnt(4)
    v_mfma_f32_32x32x16_bf16 v[48:63], v[188:191], a[68:71], v[48:63]
    ds_read_b64_tr_b16 v[184:185], v225 offset:4096
    v_mfma_f32_32x32x16_bf16 v[64:79], v[188:191], a[140:143], v[64:79]
    ds_read_b64_tr_b16 v[186:187], v225 offset:5120
    s_add_u32 s61, s67, s84
    s_add_u32 m0, s66, 81920
    s_add_u32 s61, s61, 73728
    buffer_load_dwordx4 v224, s[40:43], s61 offen lds
    s_waitcnt lgkmcnt(4)
    v_mfma_f32_32x32x16_bf16 v[16:31], v[176:179], a[0:3], 0
    ds_read_b64_tr_b16 v[188:189], v225 offset:6144
    s_add_u32 s61, s67, s84
    s_add_u32 m0, s66, 86016
    s_add_u32 s61, s61, 110592
    buffer_load_dwordx4 v224, s[40:43], s61 offen lds
    v_mfma_f32_32x32x16_bf16 v[32:47], v[176:179], a[72:75], 0
    ds_read_b64_tr_b16 v[190:191], v225 offset:7168
    s_waitcnt lgkmcnt(4)
    v_mfma_f32_32x32x16_bf16 v[16:31], v[180:183], a[4:7], v[16:31]
    ds_read_b64_tr_b16 v[176:177], v225 offset:8192
    s_add_u32 s61, s67, s84
    s_add_u32 m0, s66, 90112
    s_add_u32 s61, s61, 147456
    buffer_load_dwordx4 v224, s[40:43], s61 offen lds
    v_mfma_f32_32x32x16_bf16 v[32:47], v[180:183], a[76:79], v[32:47]
    ds_read_b64_tr_b16 v[178:179], v225 offset:9216
    s_waitcnt lgkmcnt(4)
    v_mfma_f32_32x32x16_bf16 v[16:31], v[184:187], a[8:11], v[16:31]
    ds_read_b64_tr_b16 v[180:181], v225 offset:10240
    s_add_u32 s61, s67, s84
    s_add_u32 m0, s66, 94208
    s_add_u32 s61, s61, 184320
    buffer_load_dwordx4 v224, s[40:43], s61 offen lds
    v_mfma_f32_32x32x16_bf16 v[32:47], v[184:187], a[80:83], v[32:47]
    ds_read_b64_tr_b16 v[182:183], v225 offset:11264
    v_cvt_pk_bf16_f32 v200, v48, v49
    v_cvt_pk_bf16_f32 v201, v50, v51
    s_waitcnt lgkmcnt(4)
    v_mfma_f32_32x32x16_bf16 v[16:31], v[188:191], a[12:15], v[16:31]
    ds_read_b64_tr_b16 v[184:185], v225 offset:12288
    s_add_u32 s61, s67, s84
    s_add_u32 m0, s66, 98304
    s_add_u32 s61, s61, 221184
    buffer_load_dwordx4 v224, s[40:43], s61 offen lds
    v_mfma_f32_32x32x16_bf16 v[32:47], v[188:191], a[84:87], v[32:47]
    ds_read_b64_tr_b16 v[186:187], v225 offset:13312
    v_cvt_pk_bf16_f32 v202, v52, v53
    v_cvt_pk_bf16_f32 v203, v54, v55
    s_waitcnt lgkmcnt(4)
    v_mfma_f32_32x32x16_bf16 v[16:31], v[176:179], a[16:19], v[16:31]
    ds_read_b64_tr_b16 v[188:189], v225 offset:14336
    s_add_u32 s61, s67, s84
    s_add_u32 m0, s66, 102400
    s_add_u32 s61, s61, 258048
    buffer_load_dwordx4 v224, s[40:43], s61 offen lds
    v_mfma_f32_32x32x16_bf16 v[32:47], v[176:179], a[88:91], v[32:47]
    ds_read_b64_tr_b16 v[190:191], v225 offset:15360
    v_cvt_pk_bf16_f32 v204, v56, v57
    v_cvt_pk_bf16_f32 v205, v58, v59
    s_waitcnt lgkmcnt(4)
    v_mfma_f32_32x32x16_bf16 v[16:31], v[180:183], a[20:23], v[16:31]
    ds_read_b64_tr_b16 v[176:177], v225 offset:16384
    s_add_u32 s61, s68, s84
    s_add_u32 m0, s66, 106496
    s_add_u32 s61, s61, 0
    buffer_load_dwordx4 v224, s[40:43], s61 offen lds
    v_mfma_f32_32x32x16_bf16 v[32:47], v[180:183], a[92:95], v[32:47]
    ds_read_b64_tr_b16 v[178:179], v225 offset:17408
    v_cvt_pk_bf16_f32 v206, v60, v61
    v_cvt_pk_bf16_f32 v207, v62, v63
    s_waitcnt lgkmcnt(4)
    v_mfma_f32_32x32x16_bf16 v[16:31], v[184:187], a[24:27], v[16:31]
    ds_read_b64_tr_b16 v[180:181], v225 offset:18432
    s_add_u32 s85, s83, 3
    s_cmp_ge_u32 s85, 9
    s_cselect_b32 s87, 9, 0
    s_sub_u32 s85, s85, s87
    s_mul_i32 s85, s85, 65536
    s_add_u32 s69, s65, s85
    s_add_u32 s69, s69, 0
    buffer_store_dwordx4 v[200:203], v1, s[44:47], s69 offen sc1
    v_mfma_f32_32x32x16_bf16 v[32:47], v[184:187], a[96:99], v[32:47]
    ds_read_b64_tr_b16 v[182:183], v225 offset:19456
    s_waitcnt lgkmcnt(4)
    v_mfma_f32_32x32x16_bf16 v[16:31], v[188:191], a[28:31], v[16:31]
    ds_read_b64_tr_b16 v[184:185], v225 offset:20480
    s_add_u32 s69, s65, s85
    s_add_u32 s69, s69, 16384
    buffer_store_dwordx4 v[204:207], v1, s[44:47], s69 offen sc1
    v_mfma_f32_32x32x16_bf16 v[32:47], v[188:191], a[100:103], v[32:47]
    ds_read_b64_tr_b16 v[186:187], v225 offset:21504
    v_cvt_pk_bf16_f32 v208, v64, v65
    v_cvt_pk_bf16_f32 v209, v66, v67
    s_waitcnt lgkmcnt(4)
    v_mfma_f32_32x32x16_bf16 v[16:31], v[176:179], a[32:35], v[16:31]
    ds_read_b64_tr_b16 v[188:189], v225 offset:22528
    v_cvt_pk_bf16_f32 v210, v68, v69
    v_cvt_pk_bf16_f32 v211, v70, v71
    v_mfma_f32_32x32x16_bf16 v[32:47], v[176:179], a[104:107], v[32:47]
    ds_read_b64_tr_b16 v[190:191], v225 offset:23552
    v_cvt_pk_bf16_f32 v212, v72, v73
    v_cvt_pk_bf16_f32 v213, v74, v75
    s_waitcnt lgkmcnt(4)
    v_mfma_f32_32x32x16_bf16 v[16:31], v[180:183], a[36:39], v[16:31]
    ds_read_b64_tr_b16 v[176:177], v225 offset:24576
    v_cvt_pk_bf16_f32 v214, v76, v77
    v_cvt_pk_bf16_f32 v215, v78, v79
    v_mfma_f32_32x32x16_bf16 v[32:47], v[180:183], a[108:111], v[32:47]
    ds_read_b64_tr_b16 v[178:179], v225 offset:25600
    s_add_u32 s69, s65, s85
    s_add_u32 s69, s69, 589824
    buffer_store_dwordx4 v[208:211], v1, s[44:47], s69 offen sc1
    s_waitcnt lgkmcnt(4)
    v_mfma_f32_32x32x16_bf16 v[16:31], v[184:187], a[40:43], v[16:31]
    ds_read_b64_tr_b16 v[180:181], v225 offset:26624
    v_mfma_f32_32x32x16_bf16 v[32:47], v[184:187], a[112:115], v[32:47]
    ds_read_b64_tr_b16 v[182:183], v225 offset:27648
    s_add_u32 s69, s65, s85
    s_add_u32 s69, s69, 606208
    buffer_store_dwordx4 v[212:215], v1, s[44:47], s69 offen sc1
    s_waitcnt lgkmcnt(4)
    v_mfma_f32_32x32x16_bf16 v[16:31], v[188:191], a[44:47], v[16:31]
    ds_read_b64_tr_b16 v[184:185], v225 offset:28672
    v_mfma_f32_32x32x16_bf16 v[32:47], v[188:191], a[116:119], v[32:47]
    ds_read_b64_tr_b16 v[186:187], v225 offset:29696
    s_waitcnt lgkmcnt(4)
    v_mfma_f32_32x32x16_bf16 v[16:31], v[176:179], a[48:51], v[16:31]
    ds_read_b64_tr_b16 v[188:189], v225 offset:30720
    v_mfma_f32_32x32x16_bf16 v[32:47], v[176:179], a[120:123], v[32:47]
    ds_read_b64_tr_b16 v[190:191], v225 offset:31744
    s_waitcnt lgkmcnt(4)
    v_mfma_f32_32x32x16_bf16 v[16:31], v[180:183], a[52:55], v[16:31]
    ds_read_b64_tr_b16 v[176:177], v225 offset:32768
    v_mfma_f32_32x32x16_bf16 v[32:47], v[180:183], a[124:127], v[32:47]
    ds_read_b64_tr_b16 v[178:179], v225 offset:33792
    s_waitcnt lgkmcnt(4)
    v_mfma_f32_32x32x16_bf16 v[16:31], v[184:187], a[56:59], v[16:31]
    ds_read_b64_tr_b16 v[180:181], v225 offset:34816
    v_mfma_f32_32x32x16_bf16 v[32:47], v[184:187], a[128:131], v[32:47]
    ds_read_b64_tr_b16 v[182:183], v225 offset:35840
    s_waitcnt lgkmcnt(4)
    v_mfma_f32_32x32x16_bf16 v[16:31], v[188:191], a[60:63], v[16:31]
    s_waitcnt vmcnt(17)
    s_barrier
    ds_read_b64_tr_b16 v[184:185], v226 offset:0
    v_mfma_f32_32x32x16_bf16 v[32:47], v[188:191], a[132:135], v[32:47]
    ds_read_b64_tr_b16 v[186:187], v226 offset:1024
    s_add_u32 s84, s83, 7
    s_cmp_ge_u32 s84, 9
    s_cselect_b32 s62, 9, 0
    s_sub_u32 s84, s84, s62
    s_mul_i32 s84, s84, 128
    s_add_u32 s61, s67, s84
    s_add_u32 m0, s66, 110592
    s_add_u32 s61, s61, 0
    buffer_load_dwordx4 v224, s[40:43], s61 offen lds
    s_waitcnt lgkmcnt(4)
    v_mfma_f32_32x32x16_bf16 v[16:31], v[176:179], a[64:67], v[16:31]
    ds_read_b64_tr_b16 v[188:189], v226 offset:2048
    v_mfma_f32_32x32x16_bf16 v[32:47], v[176:179], a[136:139], v[32:47]
    ds_read_b64_tr_b16 v[190:191], v226 offset:3072
    s_add_u32 s61, s67, s84
    s_add_u32 m0, s66, 114688
    s_add_u32 s61, s61, 36864
    buffer_load_dwordx4 v224, s[40:43], s61 offen lds
    s_waitcnt lgkmcnt(4)
    v_mfma_f32_32x32x16_bf16 v[16:31], v[180:183], a[68:71], v[16:31]
    ds_read_b64_tr_b16 v[176:177], v226 offset:4096
    v_mfma_f32_32x32x16_bf16 v[32:47], v[180:183], a[140:143], v[32:47]
    ds_read_b64_tr_b16 v[178:179], v226 offset:5120
    s_add_u32 s61, s67, s84
    s_add_u32 m0, s66, 118784
    s_add_u32 s61, s61, 73728
    buffer_load_dwordx4 v224, s[40:43], s61 offen lds
    s_getpc_b64 s[72:73]
L_k2_pc_0:
    s_add_u32 s72, s72, fin_kernel-L_k2_pc_0
    s_addc_u32 s73, s73, 0
    v_lshlrev_b32 v249, 6, v0
    v_min_u32 v249, L_code_end-fin_kernel-64, v249
    global_load_dword v250, v249, s[72:73]
    s_waitcnt lgkmcnt(4)
    v_mfma_f32_32x32x16_bf16 v[48:63], v[184:187], a[0:3], 0
    ds_read_b64_tr_b16 v[180:181], v226 offset:6144
    s_add_u32 s61, s67, s84
    s_add_u32 m0, s66, 122880
    s_add_u32 s61, s61, 110592
    buffer_load_dwordx4 v224, s[40:43], s61 offen lds
    v_mfma_f32_32x32x16_bf16 v[64:79], v[184:187], a[72:75], 0
    ds_read_b64_tr_b16 v[182:183], v226 offset:7168
    s_waitcnt lgkmcnt(4)
    v_mfma_f32_32x32x16_bf16 v[48:63], v[188:191], a[4:7], v[48:63]
    ds_read_b64_tr_b16 v[184:185], v226 offset:8192
    s_add_u32 s61, s67, s84
    s_add_u32 m0, s66, 126976
    s_add_u32 s61, s61, 147456
    buffer_load_dwordx4 v224, s[40:43], s61 offen lds
    v_mfma_f32_32x32x16_bf16 v[64:79], v[188:191], a[76:79], v[64:79]
    ds_read_b64_tr_b16 v[186:187], v226 offset:9216
    s_waitcnt lgkmcnt(4)
    v_mfma_f32_32x32x16_bf16 v[48:63], v[176:179], a[8:11], v[48:63]
    ds_read_b64_tr_b16 v[188:189], v226 offset:10240
    s_add_u32 s61, s67, s84
    s_add_u32 m0, s66, 131072
    s_add_u32 s61, s61, 184320
    buffer_load_dwordx4 v224, s[40:43], s61 offen lds
    v_mfma_f32_32x32x16_bf16 v[64:79], v[176:179], a[80:83], v[64:79]
    ds_read_b64_tr_b16 v[190:191], v226 offset:11264
    v_cvt_pk_bf16_f32 v200, v16, v17
    v_cvt_pk_bf16_f32 v201, v18, v19
    s_waitcnt lgkmcnt(4)
    v_mfma_f32_32x32x16_bf16 v[48:63], v[180:183], a[12:15], v[48:63]
    ds_read_b64_tr_b16 v[176:177], v226 offset:12288
    s_add_u32 s61, s67, s84
    s_add_u32 m0, s66, 135168
    s_add_u32 s61, s61, 221184
    buffer_load_dwordx4 v224, s[40:43], s61 offen lds
    v_mfma_f32_32x32x16_bf16 v[64:79], v[180:183], a[84:87], v[64:79]
    ds_read_b64_tr_b16 v[178:179], v226 offset:13312
    v_cvt_pk_bf16_f32 v202, v20, v21
    v_cvt_pk_bf16_f32 v203, v22, v23
    s_waitcnt lgkmcnt(4)
    v_mfma_f32_32x32x16_bf16 v[48:63], v[184:187], a[16:19], v[48:63]
    ds_read_b64_tr_b16 v[180:181], v226 offset:14336
    s_add_u32 s61, s67, s84
    s_add_u32 m0, s66, 139264
    s_add_u32 s61, s61, 258048
    buffer_load_dwordx4 v224, s[40:43], s61 offen lds
    v_mfma_f32_32x32x16_bf16 v[64:79], v[184:187], a[88:91], v[64:79]
    ds_read_b64_tr_b16 v[182:183], v226 offset:15360
    v_cvt_pk_bf16_f32 v204, v24, v25
    v_cvt_pk_bf16_f32 v205, v26, v27
    s_waitcnt lgkmcnt(4)
    v_mfma_f32_32x32x16_bf16 v[48:63], v[188:191], a[20:23], v[48:63]
    ds_read_b64_tr_b16 v[184:185], v226 offset:16384
    s_add_u32 s61, s68, s84
    s_add_u32 m0, s66, 143360
    s_add_u32 s61, s61, 0
    buffer_load_dwordx4 v224, s[40:43], s61 offen lds
    v_mfma_f32_32x32x16_bf16 v[64:79], v[188:191], a[92:95], v[64:79]
    ds_read_b64_tr_b16 v[186:187], v226 offset:17408
    v_cvt_pk_bf16_f32 v206, v28, v29
    v_cvt_pk_bf16_f32 v207, v30, v31
    s_waitcnt lgkmcnt(4)
    v_mfma_f32_32x32x16_bf16 v[48:63], v[176:179], a[24:27], v[48:63]
    ds_read_b64_tr_b16 v[188:189], v226 offset:18432
    s_add_u32 s85, s83, 4
    s_cmp_ge_u32 s85, 9
    s_cselect_b32 s87, 9, 0
    s_sub_u32 s85, s85, s87
    s_mul_i32 s85, s85, 65536
    s_add_u32 s69, s65, s85
    s_add_u32 s69, s69, 0
    buffer_store_dwordx4 v[200:203], v1, s[44:47], s69 offen sc1
    v_mfma_f32_32x32x16_bf16 v[64:79], v[176:179], a[96:99], v[64:79]
    ds_read_b64_tr_b16 v[190:191], v226 offset:19456
    s_waitcnt lgkmcnt(4)
    v_mfma_f32_32x32x16_bf16 v[48:63], v[180:183], a[28:31], v[48:63]
    ds_read_b64_tr_b16 v[176:177], v226 offset:20480
    s_add_u32 s69, s65, s85
    s_add_u32 s69, s69, 16384
    buffer_store_dwordx4 v[204:207], v1, s[44:47], s69 offen sc1
    v_mfma_f32_32x32x16_bf16 v[64:79], v[180:183], a[100:103], v[64:79]
    ds_read_b64_tr_b16 v[178:179], v226 offset:21504
    v_cvt_pk_bf16_f32 v208, v32, v33
    v_cvt_pk_bf16_f32 v209, v34, v35
    s_waitcnt lgkmcnt(4)
    v_mfma_f32_32x32x16_bf16 v[48:63], v[184:187], a[32:35], v[48:63]
    ds_read_b64_tr_b16 v[180:181], v226 offset:22528
    v_cvt_pk_bf16_f32 v210, v36, v37
    v_cvt_pk_bf16_f32 v211, v38, v39
    v_mfma_f32_32x32x16_bf16 v[64:79], v[184:187], a[104:107], v[64:79]
    ds_read_b64_tr_b16 v[182:183], v226 offset:23552
    v_cvt_pk_bf16_f32 v212, v40, v41
    v_cvt_pk_bf16_f32 v213, v42, v43
    s_waitcnt lgkmcnt(4)
    v_mfma_f32_32x32x16_bf16 v[48:63], v[188:191], a[36:39], v[48:63]
    ds_read_b64_tr_b16 v[184:185], v226 offset:24576
    v_cvt_pk_bf16_f32 v214, v44, v45
    v_cvt_pk_bf16_f32 v215, v46, v47
    v_mfma_f32_32x32x16_bf16 v[64:79], v[188:191], a[108:111], v[64:79]
    ds_read_b64_tr_b16 v[186:187], v226 offset:25600
    s_add_u32 s69, s65, s85
    s_add_u32 s69, s69, 589824
    buffer_store_dwordx4 v[208:211], v1, s[44:47], s69 offen sc1
    s_waitcnt lgkmcnt(4)
    v_mfma_f32_32x32x16_bf16 v[48:63], v[176:179], a[40:43], v[48:63]
    ds_read_b64_tr_b16 v[188:189], v226 offset:26624
    v_mfma_f32_32x32x16_bf16 v[64:79], v[176:179], a[112:115], v[64:79]
    ds_read_b64_tr_b16 v[190:191], v226 offset:27648
    s_add_u32 s69, s65, s85
    s_add_u32 s69, s69, 606208
    buffer_store_dwordx4 v[212:215], v1, s[44:47], s69 offen sc1
    s_waitcnt lgkmcnt(4)
    v_mfma_f32_32x32x16_bf16 v[48:63], v[180:183], a[44:47], v[48:63]
    ds_read_b64_tr_b16 v[176:177], v226 offset:28672
    v_mfma_f32_32x32x16_bf16 v[64:79], v[180:183], a[116:119], v[64:79]
    ds_read_b64_tr_b16 v[178:179], v226 offset:29696
    s_waitcnt lgkmcnt(4)
    v_mfma_f32_32x32x16_bf16 v[48:63], v[184:187], a[48:51], v[48:63]
    ds_read_b64_tr_b16 v[180:181], v226 offset:30720
    v_mfma_f32_32x32x16_bf16 v[64:79], v[184:187], a[120:123], v[64:79]
    ds_read_b64_tr_b16 v[182:183], v226 offset:31744
    s_waitcnt lgkmcnt(4)
    v_mfma_f32_32x32x16_bf16 v[48:63], v[188:191], a[52:55], v[48:63]
    ds_read_b64_tr_b16 v[184:185], v226 offset:32768
    v_mfma_f32_32x32x16_bf16 v[64:79], v[188:191], a[124:127], v[64:79]
    ds_read_b64_tr_b16 v[186:187], v226 offset:33792
    s_waitcnt lgkmcnt(4)
    v_mfma_f32_32x32x16_bf16 v[48:63], v[176:179], a[56:59], v[48:63]
    ds_read_b64_tr_b16 v[188:189], v226 offset:34816
    v_mfma_f32_32x32x16_bf16 v[64:79], v[176:179], a[128:131], v[64:79]
    ds_read_b64_tr_b16 v[190:191], v226 offset:35840
    s_waitcnt lgkmcnt(4)
    v_mfma_f32_32x32x16_bf16 v[48:63], v[180:183], a[60:63], v[48:63]
    s_waitcnt vmcnt(18)
    s_barrier
    ds_read_b64_tr_b16 v[176:177], v227 offset:0
    v_mfma_f32_32x32x16_bf16 v[64:79], v[180:183], a[132:135], v[64:79]
    ds_read_b64_tr_b16 v[178:179], v227 offset:1024
    s_add_u32 s84, s83, 8
    s_cmp_ge_u32 s84, 9
    s_cselect_b32 s62, 9, 0
    s_sub_u32 s84, s84, s62
    s_mul_i32 s84, s84, 128
    s_add_u32 s61, s67, s84
    s_add_u32 m0, s66, 0
    s_add_u32 s61, s61, 0
    buffer_load_dwordx4 v224, s[40:43], s61 offen lds
    s_waitcnt lgkmcnt(4)
    v_mfma_f32_32x32x16_bf16 v[48:63], v[184:187], a[64:67], v[48:63]
    ds_read_b64_tr_b16 v[180:181], v227 offset:2048
    v_mfma_f32_32x32x16_bf16 v[64:79], v[184:187], a[136:139], v[64:79]
    ds_read_b64_tr_b16 v[182:183], v227 offset:3072
    s_add_u32 s61, s67, s84
    s_add_u32 m0, s66, 4096
    s_add_u32 s61, s61, 36864
    buffer_load_dwordx4 v224, s[40:43], s61 offen lds
    s_waitcnt lgkmcnt(4)
    v_mfma_f32_32x32x16_bf16 v[48:63], v[188:191], a[68:71], v[48:63]
    ds_read_b64_tr_b16 v[184:185], v227 offset:4096
    v_mfma_f32_32x32x16_bf16 v[64:79], v[188:191], a[140:143], v[64:79]
    ds_read_b64_tr_b16 v[186:187], v227 offset:5120
    s_add_u32 s61, s67, s84
    s_add_u32 m0, s66, 8192
    s_add_u32 s61, s61, 73728
    buffer_load_dwordx4 v224, s[40:43], s61 offen lds
    s_waitcnt lgkmcnt(4)
    v_mfma_f32_32x32x16_bf16 v[16:31], v[176:179], a[0:3], 0
    ds_read_b64_tr_b16 v[188:189], v227 offset:6144
    s_add_u32 s61, s67, s84
    s_add_u32 m0, s66, 12288
    s_add_u32 s61, s61, 110592
    buffer_load_dwordx4 v224, s[40:43], s61 offen lds
    v_mfma_f32_32x32x16_bf16 v[32:47], v[176:179], a[72:75], 0
    ds_read_b64_tr_b16 v[190:191], v227 offset:7168
    s_waitcnt lgkmcnt(4)
    v_mfma_f32_32x32x16_bf16 v[16:31], v[180:183], a[4:7], v[16:31]
    ds_read_b64_tr_b16 v[176:177], v227 offset:8192
    s_add_u32 s61, s67, s84
    s_add_u32 m0, s66, 16384
    s_add_u32 s61, s61, 147456
    buffer_load_dwordx4 v224, s[40:43], s61 offen lds
    v_mfma_f32_32x32x16_bf16 v[32:47], v[180:183], a[76:79], v[32:47]
    ds_read_b64_tr_b16 v[178:179], v227 offset:9216
    s_waitcnt lgkmcnt(4)
    v_mfma_f32_32x32x16_bf16 v[16:31], v[184:187], a[8:11], v[16:31]
    ds_read_b64_tr_b16 v[180:181], v227 offset:10240
    s_add_u32 s61, s67, s84
    s_add_u32 m0, s66, 20480
    s_add_u32 s61, s61, 184320
    buffer_load_dwordx4 v224, s[40:43], s61 offen lds
    v_mfma_f32_32x32x16_bf16 v[32:47], v[184:187], a[80:83], v[32:47]
    ds_read_b64_tr_b16 v[182:183], v227 offset:11264
    v_cvt_pk_bf16_f32 v200, v48, v49
    v_cvt_pk_bf16_f32 v201, v50, v51
    s_waitcnt lgkmcnt(4)
    v_mfma_f32_32x32x16_bf16 v[16:31], v[188:191], a[12:15], v[16:31]
    ds_read_b64_tr_b16 v[184:185], v227 offset:12288
    s_add_u32 s61, s67, s84
    s_add_u32 m0, s66, 24576
    s_add_u32 s61, s61, 221184
    buffer_load_dwordx4 v224, s[40:43], s61 offen lds
    v_mfma_f32_32x32x16_bf16 v[32:47], v[188:191], a[84:87], v[32:47]
    ds_read_b64_tr_b16 v[186:187], v227 offset:13312
    v_cvt_pk_bf16_f32 v202, v52, v53
    v_cvt_pk_bf16_f32 v203, v54, v55
    s_waitcnt lgkmcnt(4)
    v_mfma_f32_32x32x16_bf16 v[16:31], v[176:179], a[16:19], v[16:31]
    ds_read_b64_tr_b16 v[188:189], v227 offset:14336
    s_add_u32 s61, s67, s84
    s_add_u32 m0, s66, 28672
    s_add_u32 s61, s61, 258048
    buffer_load_dwordx4 v224, s[40:43], s61 offen lds
    v_mfma_f32_32x32x16_bf16 v[32:47], v[176:179], a[88:91], v[32:47]
    ds_read_b64_tr_b16 v[190:191], v227 offset:15360
    v_cvt_pk_bf16_f32 v204, v56, v57
    v_cvt_pk_bf16_f32 v205, v58, v59
    s_waitcnt lgkmcnt(4)
    v_mfma_f32_32x32x16_bf16 v[16:31], v[180:183], a[20:23], v[16:31]
    ds_read_b64_tr_b16 v[176:177], v227 offset:16384
    s_add_u32 s61, s68, s84
    s_add_u32 m0, s66, 32768
    s_add_u32 s61, s61, 0
    buffer_load_dwordx4 v224, s[40:43], s61 offen lds
    v_mfma_f32_32x32x16_bf16 v[32:47], v[180:183], a[92:95], v[32:47]
    ds_read_b64_tr_b16 v[178:179], v227 offset:17408
    v_cvt_pk_bf16_f32 v206, v60, v61
    v_cvt_pk_bf16_f32 v207, v62, v63
    s_waitcnt lgkmcnt(4)
    v_mfma_f32_32x32x16_bf16 v[16:31], v[184:187], a[24:27], v[16:31]
    ds_read_b64_tr_b16 v[180:181], v227 offset:18432
    s_add_u32 s85, s83, 5
    s_cmp_ge_u32 s85, 9
    s_cselect_b32 s87, 9, 0
    s_sub_u32 s85, s85, s87
    s_mul_i32 s85, s85, 65536
    s_add_u32 s69, s65, s85
    s_add_u32 s69, s69, 0
    buffer_store_dwordx4 v[200:203], v1, s[44:47], s69 offen sc1
    v_mfma_f32_32x32x16_bf16 v[32:47], v[184:187], a[96:99], v[32:47]
    ds_read_b64_tr_b16 v[182:183], v227 offset:19456
    s_waitcnt lgkmcnt(4)
    v_mfma_f32_32x32x16_bf16 v[16:31], v[188:191], a[28:31], v[16:31]
    ds_read_b64_tr_b16 v[184:185], v227 offset:20480
    s_add_u32 s69, s65, s85
    s_add_u32 s69, s69, 16384
    buffer_store_dwordx4 v[204:207], v1, s[44:47], s69 offen sc1
    v_mfma_f32_32x32x16_bf16 v[32:47], v[188:191], a[100:103], v[32:47]
    ds_read_b64_tr_b16 v[186:187], v227 offset:21504
    v_cvt_pk_bf16_f32 v208, v64, v65
    v_cvt_pk_bf16_f32 v209, v66, v67
    s_waitcnt lgkmcnt(4)
    v_mfma_f32_32x32x16_bf16 v[16:31], v[176:179], a[32:35], v[16:31]
    ds_read_b64_tr_b16 v[188:189], v227 offset:22528
    v_cvt_pk_bf16_f32 v210, v68, v69
    v_cvt_pk_bf16_f32 v211, v70, v71
    v_mfma_f32_32x32x16_bf16 v[32:47], v[176:179], a[104:107], v[32:47]
    ds_read_b64_tr_b16 v[190:191], v227 offset:23552
    v_cvt_pk_bf16_f32 v212, v72, v73
    v_cvt_pk_bf16_f32 v213, v74, v75
    s_waitcnt lgkmcnt(4)
    v_mfma_f32_32x32x16_bf16 v[16:31], v[180:183], a[36:39], v[16:31]
    ds_read_b64_tr_b16 v[176:177], v227 offset:24576
    v_cvt_pk_bf16_f32 v214, v76, v77
    v_cvt_pk_bf16_f32 v215, v78, v79
    v_mfma_f32_32x32x16_bf16 v[32:47], v[180:183], a[108:111], v[32:47]
    ds_read_b64_tr_b16 v[178:179], v227 offset:25600
    s_add_u32 s69, s65, s85
    s_add_u32 s69, s69, 589824
    buffer_store_dwordx4 v[208:211], v1, s[44:47], s69 offen sc1
    s_waitcnt lgkmcnt(4)
    v_mfma_f32_32x32x16_bf16 v[16:31], v[184:187], a[40:43], v[16:31]
    ds_read_b64_tr_b16 v[180:181], v227 offset:26624
    v_mfma_f32_32x32x16_bf16 v[32:47], v[184:187], a[112:115], v[32:47]
    ds_read_b64_tr_b16 v[182:183], v227 offset:27648
    s_add_u32 s69, s65, s85
    s_add_u32 s69, s69, 606208
    buffer_store_dwordx4 v[212:215], v1, s[44:47], s69 offen sc1
    s_waitcnt lgkmcnt(4)
    v_mfma_f32_32x32x16_bf16 v[16:31], v[188:191], a[44:47], v[16:31]
    ds_read_b64_tr_b16 v[184:185], v227 offset:28672
    v_mfma_f32_32x32x16_bf16 v[32:47], v[188:191], a[116:119], v[32:47]
    ds_read_b64_tr_b16 v[186:187], v227 offset:29696
    s_waitcnt lgkmcnt(4)
    v_mfma_f32_32x32x16_bf16 v[16:31], v[176:179], a[48:51], v[16:31]
    ds_read_b64_tr_b16 v[188:189], v227 offset:30720
    v_mfma_f32_32x32x16_bf16 v[32:47], v[176:179], a[120:123], v[32:47]
    ds_read_b64_tr_b16 v[190:191], v227 offset:31744
    s_waitcnt lgkmcnt(4)
    v_mfma_f32_32x32x16_bf16 v[16:31], v[180:183], a[52:55], v[16:31]
    ds_read_b64_tr_b16 v[176:177], v227 offset:32768
    v_mfma_f32_32x32x16_bf16 v[32:47], v[180:183], a[124:127], v[32:47]
    ds_read_b64_tr_b16 v[178:179], v227 offset:33792
    s_waitcnt lgkmcnt(4)
    v_mfma_f32_32x32x16_bf16 v[16:31], v[184:187], a[56:59], v[16:31]
    ds_read_b64_tr_b16 v[180:181], v227 offset:34816
    v_mfma_f32_32x32x16_bf16 v[32:47], v[184:187], a[128:131], v[32:47]
    ds_read_b64_tr_b16 v[182:183], v227 offset:35840
    s_waitcnt lgkmcnt(4)
    v_mfma_f32_32x32x16_bf16 v[16:31], v[188:191], a[60:63], v[16:31]
    s_waitcnt vmcnt(17)
    s_barrier
    ds_read_b64_tr_b16 v[184:185], v228 offset:0
    v_mfma_f32_32x32x16_bf16 v[32:47], v[188:191], a[132:135], v[32:47]
    ds_read_b64_tr_b16 v[186:187], v228 offset:1024
    s_waitcnt lgkmcnt(4)
    v_mfma_f32_32x32x16_bf16 v[16:31], v[176:179], a[64:67], v[16:31]
    ds_read_b64_tr_b16 v[188:189], v228 offset:2048
    v_mfma_f32_32x32x16_bf16 v[32:47], v[176:179], a[136:139], v[32:47]
    ds_read_b64_tr_b16 v[190:191], v228 offset:3072
    s_waitcnt lgkmcnt(4)
    v_mfma_f32_32x32x16_bf16 v[16:31], v[180:183], a[68:71], v[16:31]
    ds_read_b64_tr_b16 v[176:177], v228 offset:4096
    v_mfma_f32_32x32x16_bf16 v[32:47], v[180:183], a[140:143], v[32:47]
    ds_read_b64_tr_b16 v[178:179], v228 offset:5120
    s_waitcnt lgkmcnt(4)
    v_mfma_f32_32x32x16_bf16 v[48:63], v[184:187], a[0:3], 0
    ds_read_b64_tr_b16 v[180:181], v228 offset:6144
    v_mfma_f32_32x32x16_bf16 v[64:79], v[184:187], a[72:75], 0
    ds_read_b64_tr_b16 v[182:183], v228 offset:7168
    s_waitcnt lgkmcnt(4)
    v_mfma_f32_32x32x16_bf16 v[48:63], v[188:191], a[4:7], v[48:63]
    ds_read_b64_tr_b16 v[184:185], v228 offset:8192
    v_mfma_f32_32x32x16_bf16 v[64:79], v[188:191], a[76:79], v[64:79]
    ds_read_b64_tr_b16 v[186:187], v228 offset:9216
    s_waitcnt lgkmcnt(4)
    v_mfma_f32_32x32x16_bf16 v[48:63], v[176:179], a[8:11], v[48:63]
    ds_read_b64_tr_b16 v[188:189], v228 offset:10240
    v_cvt_pk_bf16_f32 v200, v16, v17
    v_cvt_pk_bf16_f32 v201, v18, v19
    v_mfma_f32_32x32x16_bf16 v[64:79], v[176:179], a[80:83], v[64:79]
    ds_read_b64_tr_b16 v[190:191], v228 offset:11264
    v_cvt_pk_bf16_f32 v202, v20, v21
    v_cvt_pk_bf16_f32 v203, v22, v23
    s_waitcnt lgkmcnt(4)
    v_mfma_f32_32x32x16_bf16 v[48:63], v[180:183], a[12:15], v[48:63]
    ds_read_b64_tr_b16 v[176:177], v228 offset:12288
    v_cvt_pk_bf16_f32 v204, v24, v25
    v_cvt_pk_bf16_f32 v205, v26, v27
    v_mfma_f32_32x32x16_bf16 v[64:79], v[180:183], a[84:87], v[64:79]
    ds_read_b64_tr_b16 v[178:179], v228 offset:13312
    v_cvt_pk_bf16_f32 v206, v28, v29
    v_cvt_pk_bf16_f32 v207, v30, v31
    s_waitcnt lgkmcnt(4)
    v_mfma_f32_32x32x16_bf16 v[48:63], v[184:187], a[16:19], v[48:63]
    ds_read_b64_tr_b16 v[180:181], v228 offset:14336
    s_add_u32 s85, s83, 6
    s_cmp_ge_u32 s85, 9
    s_cselect_b32 s87, 9, 0
    s_sub_u32 s85, s85, s87
    s_mul_i32 s85, s85, 65536
    s_add_u32 s69, s65, s85
    s_add_u32 s69, s69, 0
    buffer_store_dwordx4 v[200:203], v1, s[44:47], s69 offen sc1
    v_mfma_f32_32x32x16_bf16 v[64:79], v[184:187], a[88:91], v[64:79]
    ds_read_b64_tr_b16 v[182:183], v228 offset:15360
    s_waitcnt lgkmcnt(4)
    v_mfma_f32_32x32x16_bf16 v[48:63], v[188:191], a[20:23], v[48:63]
    ds_read_b64_tr_b16 v[184:185], v228 offset:16384
    s_add_u32 s69, s65, s85
    s_add_u32 s69, s69, 16384
    buffer_store_dwordx4 v[204:207], v1, s[44:47], s69 offen sc1
    v_mfma_f32_32x32x16_bf16 v[64:79], v[188:191], a[92:95], v[64:79]
    ds_read_b64_tr_b16 v[186:187], v228 offset:17408
    v_cvt_pk_bf16_f32 v208, v32, v33
    v_cvt_pk_bf16_f32 v209, v34, v35
    s_waitcnt lgkmcnt(4)
    v_mfma_f32_32x32x16_bf16 v[48:63], v[176:179], a[24:27], v[48:63]
    ds_read_b64_tr_b16 v[188:189], v228 offset:18432
    v_cvt_pk_bf16_f32 v210, v36, v37
    v_cvt_pk_bf16_f32 v211, v38, v39
    v_mfma_f32_32x32x16_bf16 v[64:79], v[176:179], a[96:99], v[64:79]
    ds_read_b64_tr_b16 v[190:191], v228 offset:19456
    v_cvt_pk_bf16_f32 v212, v40, v41
    v_cvt_pk_bf16_f32 v213, v42, v43
    s_waitcnt lgkmcnt(4)
    v_mfma_f32_32x32x16_bf16 v[48:63], v[180:183], a[28:31], v[48:63]
    ds_read_b64_tr_b16 v[176:177], v228 offset:20480
    v_cvt_pk_bf16_f32 v214, v44, v45
    v_cvt_pk_bf16_f32 v215, v46, v47
    v_mfma_f32_32x32x16_bf16 v[64:79], v[180:183], a[100:103], v[64:79]
    ds_read_b64_tr_b16 v[178:179], v228 offset:21504
    s_add_u32 s69, s65, s85
    s_add_u32 s69, s69, 589824
    buffer_store_dwordx4 v[208:211], v1, s[44:47], s69 offen sc1
    s_waitcnt lgkmcnt(4)
    v_mfma_f32_32x32x16_bf16 v[48:63], v[184:187], a[32:35], v[48:63]
    ds_read_b64_tr_b16 v[180:181], v228 offset:22528
    v_mfma_f32_32x32x16_bf16 v[64:79], v[184:187], a[104:107], v[64:79]
    ds_read_b64_tr_b16 v[182:183], v228 offset:23552
    s_add_u32 s69, s65, s85
    s_add_u32 s69, s69, 606208
    buffer_store_dwordx4 v[212:215], v1, s[44:47], s69 offen sc1
    s_waitcnt lgkmcnt(4)
    v_mfma_f32_32x32x16_bf16 v[48:63], v[188:191], a[36:39], v[48:63]
    ds_read_b64_tr_b16 v[184:185], v228 offset:24576
    v_mfma_f32_32x32x16_bf16 v[64:79], v[188:191], a[108:111], v[64:79]
    ds_read_b64_tr_b16 v[186:187], v228 offset:25600
    s_waitcnt lgkmcnt(4)
    v_mfma_f32_32x32x16_bf16 v[48:63], v[176:179], a[40:43], v[48:63]
    ds_read_b64_tr_b16 v[188:189], v228 offset:26624
    v_mfma_f32_32x32x16_bf16 v[64:79], v[176:179], a[112:115], v[64:79]
    ds_read_b64_tr_b16 v[190:191], v228 offset:27648
    s_waitcnt lgkmcnt(4)
    v_mfma_f32_32x32x16_bf16 v[48:63], v[180:183], a[44:47], v[48:63]
    ds_read_b64_tr_b16 v[176:177], v228 offset:28672
    v_mfma_f32_32x32x16_bf16 v[64:79], v[180:183], a[116:119], v[64:79]
    ds_read_b64_tr_b16 v[178:179], v228 offset:29696
    s_waitcnt lgkmcnt(4)
    v_mfma_f32_32x32x16_bf16 v[48:63], v[184:187], a[48:51], v[48:63]
    ds_read_b64_tr_b16 v[180:181], v228 offset:30720
    v_mfma_f32_32x32x16_bf16 v[64:79], v[184:187], a[120:123], v[64:79]
    ds_read_b64_tr_b16 v[182:183], v228 offset:31744
    s_waitcnt lgkmcnt(4)
    v_mfma_f32_32x32x16_bf16 v[48:63], v[188:191], a[52:55], v[48:63]
    ds_read_b64_tr_b16 v[184:185], v228 offset:32768
    v_mfma_f32_32x32x16_bf16 v[64:79], v[188:191], a[124:127], v[64:79]
    ds_read_b64_tr_b16 v[186:187], v228 offset:33792
    s_waitcnt lgkmcnt(4)
    v_mfma_f32_32x32x16_bf16 v[48:63], v[176:179], a[56:59], v[48:63]
    ds_read_b64_tr_b16 v[188:189], v228 offset:34816
    v_mfma_f32_32x32x16_bf16 v[64:79], v[176:179], a[128:131], v[64:79]
    ds_read_b64_tr_b16 v[190:191], v228 offset:35840
    s_waitcnt lgkmcnt(4)
    v_mfma_f32_32x32x16_bf16 v[48:63], v[180:183], a[60:63], v[48:63]
    s_waitcnt vmcnt(8)
    s_barrier
    ds_read_b64_tr_b16 v[176:177], v225 offset:0
    v_mfma_f32_32x32x16_bf16 v[64:79], v[180:183], a[132:135], v[64:79]
    ds_read_b64_tr_b16 v[178:179], v225 offset:1024
    s_waitcnt lgkmcnt(4)
    v_mfma_f32_32x32x16_bf16 v[48:63], v[184:187], a[64:67], v[48:63]
    ds_read_b64_tr_b16 v[180:181], v225 offset:2048
    v_mfma_f32_32x32x16_bf16 v[64:79], v[184:187], a[136:139], v[64:79]
    ds_read_b64_tr_b16 v[182:183], v225 offset:3072
    s_waitcnt lgkmcnt(4)
    v_mfma_f32_32x32x16_bf16 v[48:63], v[188:191], a[68:71], v[48:63]
    ds_read_b64_tr_b16 v[184:185], v225 offset:4096
    v_mfma_f32_32x32x16_bf16 v[64:79], v[188:191], a[140:143], v[64:79]
    ds_read_b64_tr_b16 v[186:187], v225 offset:5120
    s_waitcnt lgkmcnt(4)
    v_mfma_f32_32x32x16_bf16 v[16:31], v[176:179], a[0:3], 0
    ds_read_b64_tr_b16 v[188:189], v225 offset:6144
    v_mfma_f32_32x32x16_bf16 v[32:47], v[176:179], a[72:75], 0
    ds_read_b64_tr_b16 v[190:191], v225 offset:7168
    s_waitcnt lgkmcnt(4)
    v_mfma_f32_32x32x16_bf16 v[16:31], v[180:183], a[4:7], v[16:31]
    ds_read_b64_tr_b16 v[176:177], v225 offset:8192
    v_mfma_f32_32x32x16_bf16 v[32:47], v[180:183], a[76:79], v[32:47]
    ds_read_b64_tr_b16 v[178:179], v225 offset:9216
    s_waitcnt lgkmcnt(4)
    v_mfma_f32_32x32x16_bf16 v[16:31], v[184:187], a[8:11], v[16:31]
    ds_read_b64_tr_b16 v[180:181], v225 offset:10240
    v_cvt_pk_bf16_f32 v200, v48, v49
    v_cvt_pk_bf16_f32 v201, v50, v51
    v_mfma_f32_32x32x16_bf16 v[32:47], v[184:187], a[80:83], v[32:47]
    ds_read_b64_tr_b16 v[182:183], v225 offset:11264
    v_cvt_pk_bf16_f32 v202, v52, v53
    v_cvt_pk_bf16_f32 v203, v54, v55
    s_waitcnt lgkmcnt(4)
    v_mfma_f32_32x32x16_bf16 v[16:31], v[188:191], a[12:15], v[16:31]
    ds_read_b64_tr_b16 v[184:185], v225 offset:12288
    v_cvt_pk_bf16_f32 v204, v56, v57
    v_cvt_pk_bf16_f32 v205, v58, v59
    v_mfma_f32_32x32x16_bf16 v[32:47], v[188:191], a[84:87], v[32:47]
    ds_read_b64_tr_b16 v[186:187], v225 offset:13312
    v_cvt_pk_bf16_f32 v206, v60, v61
    v_cvt_pk_bf16_f32 v207, v62, v63
    s_waitcnt lgkmcnt(4)
    v_mfma_f32_32x32x16_bf16 v[16:31], v[176:179], a[16:19], v[16:31]
    ds_read_b64_tr_b16 v[188:189], v225 offset:14336
    s_add_u32 s85, s83, 7
    s_cmp_ge_u32 s85, 9
    s_cselect_b32 s87, 9, 0
    s_sub_u32 s85, s85, s87
    s_mul_i32 s85, s85, 65536
    s_add_u32 s69, s65, s85
    s_add_u32 s69, s69, 0
    buffer_store_dwordx4 v[200:203], v1, s[44:47], s69 offen sc1
    v_mfma_f32_32x32x16_bf16 v[32:47], v[176:179], a[88:91], v[32:47]
    ds_read_b64_tr_b16 v[190:191], v225 offset:15360
    s_waitcnt lgkmcnt(4)
    v_mfma_f32_32x32x16_bf16 v[16:31], v[180:183], a[20:23], v[16:31]
    ds_read_b64_tr_b16 v[176:177], v225 offset:16384
    s_add_u32 s69, s65, s85
    s_add_u32 s69, s69, 16384
    buffer_store_dwordx4 v[204:207], v1, s[44:47], s69 offen sc1
    v_mfma_f32_32x32x16_bf16 v[32:47], v[180:183], a[92:95], v[32:47]
    ds_read_b64_tr_b16 v[178:179], v225 offset:17408
    v_cvt_pk_bf16_f32 v208, v64, v65
    v_cvt_pk_bf16_f32 v209, v66, v67
    s_waitcnt lgkmcnt(4)
    v_mfma_f32_32x32x16_bf16 v[16:31], v[184:187], a[24:27], v[16:31]
    ds_read_b64_tr_b16 v[180:181], v225 offset:18432
    v_cvt_pk_bf16_f32 v210, v68, v69
    v_cvt_pk_bf16_f32 v211, v70, v71
    v_mfma_f32_32x32x16_bf16 v[32:47], v[184:187], a[96:99], v[32:47]
    ds_read_b64_tr_b16 v[182:183], v225 offset:19456
    v_cvt_pk_bf16_f32 v212, v72, v73
    v_cvt_pk_bf16_f32 v213, v74, v75
    s_waitcnt lgkmcnt(4)
    v_mfma_f32_32x32x16_bf16 v[16:31], v[188:191], a[28:31], v[16:31]
    ds_read_b64_tr_b16 v[184:185], v225 offset:20480
    v_cvt_pk_bf16_f32 v214, v76, v77
    v_cvt_pk_bf16_f32 v215, v78, v79
    v_mfma_f32_32x32x16_bf16 v[32:47], v[188:191], a[100:103], v[32:47]
    ds_read_b64_tr_b16 v[186:187], v225 offset:21504
    s_add_u32 s69, s65, s85
    s_add_u32 s69, s69, 589824
    buffer_store_dwordx4 v[208:211], v1, s[44:47], s69 offen sc1
    s_waitcnt lgkmcnt(4)
    v_mfma_f32_32x32x16_bf16 v[16:31], v[176:179], a[32:35], v[16:31]
    ds_read_b64_tr_b16 v[188:189], v225 offset:22528
    v_mfma_f32_32x32x16_bf16 v[32:47], v[176:179], a[104:107], v[32:47]
    ds_read_b64_tr_b16 v[190:191], v225 offset:23552
    s_add_u32 s69, s65, s85
    s_add_u32 s69, s69, 606208
    buffer_store_dwordx4 v[212:215], v1, s[44:47], s69 offen sc1
    s_waitcnt lgkmcnt(4)
    v_mfma_f32_32x32x16_bf16 v[16:31], v[180:183], a[36:39], v[16:31]
    ds_read_b64_tr_b16 v[176:177], v225 offset:24576
    v_mfma_f32_32x32x16_bf16 v[32:47], v[180:183], a[108:111], v[32:47]
    ds_read_b64_tr_b16 v[178:179], v225 offset:25600
    s_waitcnt lgkmcnt(4)
    v_mfma_f32_32x32x16_bf16 v[16:31], v[184:187], a[40:43], v[16:31]
    ds_read_b64_tr_b16 v[180:181], v225 offset:26624
    v_mfma_f32_32x32x16_bf16 v[32:47], v[184:187], a[112:115], v[32:47]
    ds_read_b64_tr_b16 v[182:183], v225 offset:27648
    s_waitcnt lgkmcnt(4)
    v_mfma_f32_32x32x16_bf16 v[16:31], v[188:191], a[44:47], v[16:31]
    ds_read_b64_tr_b16 v[184:185], v225 offset:28672
    v_mfma_f32_32x32x16_bf16 v[32:47], v[188:191], a[116:119], v[32:47]
    ds_read_b64_tr_b16 v[186:187], v225 offset:29696
    s_waitcnt lgkmcnt(4)
    v_mfma_f32_32x32x16_bf16 v[16:31], v[176:179], a[48:51], v[16:31]
    ds_read_b64_tr_b16 v[188:189], v225 offset:30720
    v_mfma_f32_32x32x16_bf16 v[32:47], v[176:179], a[120:123], v[32:47]
    ds_read_b64_tr_b16 v[190:191], v225 offset:31744
    s_waitcnt lgkmcnt(4)
    v_mfma_f32_32x32x16_bf16 v[16:31], v[180:183], a[52:55], v[16:31]
    ds_read_b64_tr_b16 v[176:177], v225 offset:32768
    v_mfma_f32_32x32x16_bf16 v[32:47], v[180:183], a[124:127], v[32:47]
    ds_read_b64_tr_b16 v[178:179], v225 offset:33792
    s_waitcnt lgkmcnt(4)
    v_mfma_f32_32x32x16_bf16 v[16:31], v[184:187], a[56:59], v[16:31]
    ds_read_b64_tr_b16 v[180:181], v225 offset:34816
    v_mfma_f32_32x32x16_bf16 v[32:47], v[184:187], a[128:131], v[32:47]
    ds_read_b64_tr_b16 v[182:183], v225 offset:35840
    s_waitcnt lgkmcnt(4)
    v_mfma_f32_32x32x16_bf16 v[16:31], v[188:191], a[60:63], v[16:31]
    v_mfma_f32_32x32x16_bf16 v[32:47], v[188:191], a[132:135], v[32:47]
    s_waitcnt lgkmcnt(2)
    v_mfma_f32_32x32x16_bf16 v[16:31], v[176:179], a[64:67], v[16:31]
    v_mfma_f32_32x32x16_bf16 v[32:47], v[176:179], a[136:139], v[32:47]
    s_waitcnt lgkmcnt(0)
    v_mfma_f32_32x32x16_bf16 v[16:31], v[180:183], a[68:71], v[16:31]
    v_mfma_f32_32x32x16_bf16 v[32:47], v[180:183], a[140:143], v[32:47]
    s_nop 15
    s_nop 3
    v_cvt_pk_bf16_f32 v200, v16, v17
    v_cvt_pk_bf16_f32 v201, v18, v19
    v_cvt_pk_bf16_f32 v202, v20, v21
    v_cvt_pk_bf16_f32 v203, v22, v23
    v_cvt_pk_bf16_f32 v204, v24, v25
    v_cvt_pk_bf16_f32 v205, v26, v27
    v_cvt_pk_bf16_f32 v206, v28, v29
    v_cvt_pk_bf16_f32 v207, v30, v31
    s_add_u32 s85, s83, 8
    s_cmp_ge_u32 s85, 9
    s_cselect_b32 s87, 9, 0
    s_sub_u32 s85, s85, s87
    s_mul_i32 s85, s85, 65536
    s_add_u32 s69, s65, s85
    s_add_u32 s69, s69, 0
    buffer_store_dwordx4 v[200:203], v1, s[44:47], s69 offen sc1
    s_add_u32 s69, s65, s85
    s_add_u32 s69, s69, 16384
    buffer_store_dwordx4 v[204:207], v1, s[44:47], s69 offen sc1
    v_cvt_pk_bf16_f32 v208, v32, v33
    v_cvt_pk_bf16_f32 v209, v34, v35
    v_cvt_pk_bf16_f32 v210, v36, v37
    v_cvt_pk_bf16_f32 v211, v38, v39
    v_cvt_pk_bf16_f32 v212, v40, v41
    v_cvt_pk_bf16_f32 v213, v42, v43
    v_cvt_pk_bf16_f32 v214, v44, v45
    v_cvt_pk_bf16_f32 v215, v46, v47
    s_add_u32 s69, s65, s85
    s_add_u32 s69, s69, 589824
    buffer_store_dwordx4 v[208:211], v1, s[44:47], s69 offen sc1
    s_add_u32 s69, s65, s85
    s_add_u32 s69, s69, 606208
    buffer_store_dwordx4 v[212:215], v1, s[44:47], s69 offen sc1
    s_branch L_ffn_done
L_ffn_noa1:
    s_add_u32 s61, s67, s84
    s_add_u32 m0, s66, 49152
    s_add_u32 s61, s61, 110592
    buffer_load_dwordx4 v224, s[40:43], s61 offen lds
    s_add_u32 s61, s67, s84
    s_add_u32 m0, s66, 53248
    s_add_u32 s61, s61, 147456
    buffer_load_dwordx4 v224, s[40:43], s61 offen lds
    s_add_u32 s61, s67, s84
    s_add_u32 m0, s66, 57344
    s_add_u32 s61, s61, 184320
    buffer_load_dwordx4 v224, s[40:43], s61 offen lds
    s_add_u32 s61, s67, s84
    s_add_u32 m0, s66, 61440
    s_add_u32 s61, s61, 221184
    buffer_load_dwordx4 v224, s[40:43], s61 offen lds
    s_add_u32 s61, s67, s84
    s_add_u32 m0, s66, 65536
    s_add_u32 s61, s61, 258048
    buffer_load_dwordx4 v224, s[40:43], s61 offen lds
    s_add_u32 s61, s68, s84
    s_add_u32 m0, s66, 69632
    s_add_u32 s61, s61, 0
    buffer_load_dwordx4 v224, s[40:43], s61 offen lds
    s_waitcnt vmcnt(14)
    s_barrier
    ds_read_b128 a[0:3], v229 offset:0
    ds_read_b128 a[72:75], v229 offset:18432
    ds_read_b128 a[4:7], v229 offset:1024
    ds_read_b128 a[76:79], v229 offset:19456
    ds_read_b128 a[8:11], v229 offset:2048
    ds_read_b128 a[80:83], v229 offset:20480
    ds_read_b128 a[12:15], v229 offset:3072
    ds_read_b128 a[84:87], v229 offset:21504
    ds_read_b64_tr_b16 v[176:177], v225 offset:0
    ds_read_b64_tr_b16 v[178:179], v225 offset:1024
    ds_read_b64_tr_b16 v[180:181], v225 offset:2048
    ds_read_b64_tr_b16 v[182:183], v225 offset:3072
    ds_read_b64_tr_b16 v[184:185], v225 offset:4096
    ds_read_b64_tr_b16 v[186:187], v225 offset:5120
    s_waitcnt lgkmcnt(4)
    v_mfma_f32_32x32x16_bf16 v[48:63], v[176:179], a[0:3], 0
    ds_read_b128 a[16:19], v229 offset:4096
    ds_read_b128 a[88:91], v229 offset:22528
    ds_read_b64_tr_b16 v[188:189], v225 offset:6144
    v_mfma_f32_32x32x16_bf16 v[64:79], v[176:179], a[72:75], 0
    ds_read_b128 a[20:23], v229 offset:5120
    ds_read_b128 a[92:95], v229 offset:23552
    ds_read_b64_tr_b16 v[190:191], v225 offset:7168
    v_mul_f32 v200, v16, v16
    v_mul_f32 v201, v17, v17
    v_fma_f32 v200, v200, s64, v14
    v_fma_f32 v201, v201, s64, v14
    v_mul_f32 v200, v200, v16
    s_waitcnt lgkmcnt(8)
    v_mfma_f32_32x32x16_bf16 v[48:63], v[180:183], a[4:7], v[48:63]
    ds_read_b128 a[24:27], v229 offset:6144
    ds_read_b128 a[96:99], v229 offset:24576
    ds_read_b64_tr_b16 v[176:177], v225 offset:8192
    v_mul_f32 v201, v201, v17
    v_exp_f32 v200, v200
    v_exp_f32 v201, v201
    v_mul_f32 v202, v16, v24
    v_mul_f32 v203, v17, v25
    v_mfma_f32_32x32x16_bf16 v[64:79], v[180:183], a[76:79], v[64:79]
    ds_read_b128 a[28:31], v229 offset:7168
    ds_read_b128 a[100:103], v229 offset:25600
    ds_read_b64_tr_b16 v[178:179], v225 offset:9216
    v_add_f32 v200, 1.0, v200
    v_add_f32 v201, 1.0, v201
    v_rcp_f32 v200, v200
    v_rcp_f32 v201, v201
    v_mul_f32 v202, v202, v200
    s_waitcnt lgkmcnt(12)
    v_mfma_f32_32x32x16_bf16 v[48:63], v[184:187], a[8:11], v[48:63]
    ds_read_b128 a[32:35], v229 offset:8192
    ds_read_b128 a[104:107], v229 offset:26624
    ds_read_b64_tr_b16 v[180:181], v225 offset:10240
    v_mul_f32 v203, v203, v201
    v_cvt_pk_bf16_f32 v216, v202, v203
    v_mul_f32 v204, v18, v18
    v_mul_f32 v205, v19, v19
    v_fma_f32 v204, v204, s64, v14
    v_mfma_f32_32x32x16_bf16 v[64:79], v[184:187], a[80:83], v[64:79]
    ds_read_b128 a[36:39], v229 offset:9216
    ds_read_b128 a[108:111], v229 offset:27648
    ds_read_b64_tr_b16 v[182:183], v225 offset:11264
    v_fma_f32 v205, v205, s64, v14
    v_mul_f32 v204, v204, v18
    v_mul_f32 v205, v205, v19
    v_exp_f32 v204, v204
    v_exp_f32 v205, v205
    s_waitcnt lgkmcnt(12)
    v_mfma_f32_32x32x16_bf16 v[48:63], v[188:191], a[12:15], v[48:63]
    ds_read_b128 a[40:43], v229 offset:10240
    ds_read_b128 a[112:115], v229 offset:28672
    ds_read_b64_tr_b16 v[184:185], v225 offset:12288
    v_mul_f32 v206, v18, v26
    v_mul_f32 v207, v19, v27
    v_add_f32 v204, 1.0, v204
    v_add_f32 v205, 1.0, v205
    v_rcp_f32 v204, v204
    v_mfma_f32_32x32x16_bf16 v[64:79], v[188:191], a[84:87], v[64:79]
    ds_read_b128 a[44:47], v229 offset:11264
    ds_read_b128 a[116:119], v229 offset:29696
    ds_read_b64_tr_b16 v[186:187], v225 offset:13312
    v_rcp_f32 v205, v205
    v_mul_f32 v206, v206, v204
    v_mul_f32 v207, v207, v205
    v_cvt_pk_bf16_f32 v217, v206, v207
    v_mul_f32 v200, v20, v20
    s_waitcnt lgkmcnt(12)
    v_mfma_f32_32x32x16_bf16 v[48:63], v[176:179], a[16:19], v[48:63]
    ds_read_b128 a[48:51], v229 offset:12288
    ds_read_b128 a[120:123], v229 offset:30720
    ds_read_b64_tr_b16 v[188:189], v225 offset:14336
    v_mul_f32 v201, v21, v21
    v_fma_f32 v200, v200, s64, v14
    v_fma_f32 v201, v201, s64, v14
    v_mul_f32 v200, v200, v20
    v_mul_f32 v201, v201, v21
    v_mfma_f32_32x32x16_bf16 v[64:79], v[176:179], a[88:91], v[64:79]
    ds_read_b128 a[52:55], v229 offset:13312
    ds_read_b128 a[124:127], v229 offset:31744
    ds_read_b64_tr_b16 v[190:191], v225 offset:15360
    v_exp_f32 v200, v200
    v_exp_f32 v201, v201
    v_mul_f32 v202, v20, v28
    v_mul_f32 v203, v21, v29
    v_add_f32 v200, 1.0, v200
    s_waitcnt lgkmcnt(12)
    v_mfma_f32_32x32x16_bf16 v[48:63], v[180:183], a[20:23], v[48:63]
    ds_read_b128 a[56:59], v229 offset:14336
    ds_read_b128 a[128:131], v229 offset:32768
    ds_read_b64_tr_b16 v[176:177], v225 offset:16384
    v_add_f32 v201, 1.0, v201
    v_rcp_f32 v200, v200
    v_rcp_f32 v201, v201
    v_mul_f32 v202, v202, v200
    v_mul_f32 v203, v203, v201
    v_mfma_f32_32x32x16_bf16 v[64:79], v[180:183], a[92:95], v[64:79]
    ds_read_b128 a[60:63], v229 offset:15360
    ds_read_b128 a[132:135], v229 offset:33792
    ds_read_b64_tr_b16 v[178:179], v225 offset:17408
    v_cvt_pk_bf16_f32 v218, v202, v203
    v_mul_f32 v204, v22, v22
    v_mul_f32 v205, v23, v23
    v_fma_f32 v204, v204, s64, v14
    v_fma_f32 v205, v205, s64, v14
    s_waitcnt lgkmcnt(12)
    v_mfma_f32_32x32x16_bf16 v[48:63], v[184:187], a[24:27], v[48:63]
    ds_read_b64_tr_b16 v[180:181], v225 offset:18432
    v_mul_f32 v204, v204, v22
    v_mul_f32 v205, v205, v23
    v_exp_f32 v204, v204
    v_exp_f32 v205, v205
    v_mul_f32 v206, v22, v30
    v_mfma_f32_32x32x16_bf16 v[64:79], v[184:187], a[96:99], v[64:79]
    ds_read_b64_tr_b16 v[182:183], v225 offset:19456
    v_mul_f32 v207, v23, v31
    v_add_f32 v204, 1.0, v204
    v_add_f32 v205, 1.0, v205
    v_rcp_f32 v204, v204
    v_rcp_f32 v205, v205
    s_waitcnt lgkmcnt(8)
    v_mfma_f32_32x32x16_bf16 v[48:63], v[188:191], a[28:31], v[48:63]
    ds_read_b64_tr_b16 v[184:185], v225 offset:20480
    v_mul_f32 v206, v206, v204
    v_mul_f32 v207, v207, v205
    v_cvt_pk_bf16_f32 v219, v206, v207
    ds_write_b128 v13, v[216:219] offset:0
    v_mul_f32 v200, v32, v32
    v_mfma_f32_32x32x16_bf16 v[64:79], v[188:191], a[100:103], v[64:79]
    ds_read_b64_tr_b16 v[186:187], v225 offset:21504
    v_mul_f32 v201, v33, v33
    v_fma_f32 v200, v200, s64, v14
    v_fma_f32 v201, v201, s64, v14
    v_mul_f32 v200, v200, v32
    v_mul_f32 v201, v201, v33
    s_waitcnt lgkmcnt(5)
    v_mfma_f32_32x32x16_bf16 v[48:63], v[176:179], a[32:35], v[48:63]
    ds_read_b64_tr_b16 v[188:189], v225 offset:22528
    v_exp_f32 v200, v200
    v_exp_f32 v201, v201
    v_mul_f32 v202, v32, v40
    v_mul_f32 v203, v33, v41
    v_add_f32 v200, 1.0, v200
    v_mfma_f32_32x32x16_bf16 v[64:79], v[176:179], a[104:107], v[64:79]
    ds_read_b64_tr_b16 v[190:191], v225 offset:23552
    v_add_f32 v201, 1.0, v201
    v_rcp_f32 v200, v200
    v_rcp_f32 v201, v201
    v_mul_f32 v202, v202, v200
    v_mul_f32 v203, v203, v201
    s_waitcnt lgkmcnt(5)
    v_mfma_f32_32x32x16_bf16 v[48:63], v[180:183], a[36:39], v[48:63]
    ds_read_b64_tr_b16 v[176:177], v225 offset:24576
    v_cvt_pk_bf16_f32 v220, v202, v203
    v_mul_f32 v204, v34, v34
    v_mul_f32 v205, v35, v35
    v_fma_f32 v204, v204, s64, v14
    v_fma_f32 v205, v205, s64, v14
    v_mfma_f32_32x32x16_bf16 v[64:79], v[180:183], a[108:111], v[64:79]
    ds_read_b64_tr_b16 v[178:179], v225 offset:25600
    v_mul_f32 v204, v204, v34
    v_mul_f32 v205, v205, v35
    v_exp_f32 v204, v204
    v_exp_f32 v205, v205
    v_mul_f32 v206, v34, v42
    s_waitcnt lgkmcnt(4)
    v_mfma_f32_32x32x16_bf16 v[48:63], v[184:187], a[40:43], v[48:63]
    ds_read_b64_tr_b16 v[180:181], v225 offset:26624
    v_mul_f32 v207, v35, v43
    v_add_f32 v204, 1.0, v204
    v_add_f32 v205, 1.0, v205
    v_rcp_f32 v204, v204
    v_rcp_f32 v205, v205
    v_mfma_f32_32x32x16_bf16 v[64:79], v[184:187], a[112:115], v[64:79]
    ds_read_b64_tr_b16 v[182:183], v225 offset:27648
    v_mul_f32 v206, v206, v204
    v_mul_f32 v207, v207, v205
    v_cvt_pk_bf16_f32 v221, v206, v207
    v_mul_f32 v200, v36, v36
    v_mul_f32 v201, v37, v37
    s_waitcnt lgkmcnt(4)
    v_mfma_f32_32x32x16_bf16 v[48:63], v[188:191], a[44:47], v[48:63]
    ds_read_b64_tr_b16 v[184:185], v225 offset:28672
    v_fma_f32 v200, v200, s64, v14
    v_fma_f32 v201, v201, s64, v14
    v_mul_f32 v200, v200, v36
    v_mul_f32 v201, v201, v37
    v_exp_f32 v200, v200
    v_mfma_f32_32x32x16_bf16 v[64:79], v[188:191], a[116:119], v[64:79]
    ds_read_b64_tr_b16 v[186:187], v225 offset:29696
    v_exp_f32 v201, v201
    v_mul_f32 v202, v36, v44
    v_mul_f32 v203, v37, v45
    v_add_f32 v200, 1.0, v200
    v_add_f32 v201, 1.0, v201
    s_waitcnt lgkmcnt(4)
    v_mfma_f32_32x32x16_bf16 v[48:63], v[176:179], a[48:51], v[48:63]
    v_rcp_f32 v200, v200
    v_rcp_f32 v201, v201
    v_mul_f32 v202, v202, v200
    v_mul_f32 v203, v203, v201
    v_cvt_pk_bf16_f32 v222, v202, v203
    v_mul_f32 v204, v38, v38
    v_mul_f32 v205, v39, v39
    v_fma_f32 v204, v204, s64, v14
    v_fma_f32 v205, v205, s64, v14
    v_mul_f32 v204, v204, v38
    v_mul_f32 v205, v205, v39
    v_exp_f32 v204, v204
    v_exp_f32 v205, v205
    v_mul_f32 v206, v38, v46
    v_mul_f32 v207, v39, v47
    v_add_f32 v204, 1.0, v204
    v_add_f32 v205, 1.0, v205
    v_rcp_f32 v204, v204
    v_rcp_f32 v205, v205
    v_mul_f32 v206, v206, v204
    v_mul_f32 v207, v207, v205
    v_cvt_pk_bf16_f32 v223, v206, v207
    ds_write_b128 v13, v[220:223] offset:18432
    s_waitcnt lgkmcnt(0)
    s_barrier
    ds_read_b128 a[64:67], v229 offset:16384
    ds_read_b128 a[136:139], v229 offset:34816
    ds_read_b64_tr_b16 v[188:189], v225 offset:30720
    v_mfma_f32_32x32x16_bf16 v[64:79], v[176:179], a[120:123], v[64:79]
    ds_read_b128 a[68:71], v229 offset:17408
    ds_read_b128 a[140:143], v229 offset:35840
    ds_read_b64_tr_b16 v[190:191], v225 offset:31744
    v_mfma_f32_32x32x16_bf16 v[48:63], v[180:183], a[52:55], v[48:63]
    ds_read_b64_tr_b16 v[176:177], v225 offset:32768
    v_mfma_f32_32x32x16_bf16 v[64:79], v[180:183], a[124:127], v[64:79]
    ds_read_b64_tr_b16 v[178:179], v225 offset:33792
    v_mfma_f32_32x32x16_bf16 v[48:63], v[184:187], a[56:59], v[48:63]
    ds_read_b64_tr_b16 v[180:181], v225 offset:34816
    v_mfma_f32_32x32x16_bf16 v[64:79], v[184:187], a[128:131], v[64:79]
    ds_read_b64_tr_b16 v[182:183], v225 offset:35840
    s_waitcnt lgkmcnt(4)
    v_mfma_f32_32x32x16_bf16 v[48:63], v[188:191], a[60:63], v[48:63]
    s_waitcnt vmcnt(0)
    s_barrier
    ds_read_b64_tr_b16 v[184:185], v226 offset:0
    v_mfma_f32_32x32x16_bf16 v[64:79], v[188:191], a[132:135], v[64:79]
    ds_read_b64_tr_b16 v[186:187], v226 offset:1024
    s_add_u32 s84, s83, 2
    s_cmp_ge_u32 s84, 9
    s_cselect_b32 s62, 9, 0
    s_sub_u32 s84, s84, s62
    s_mul_i32 s84, s84, 128
    s_add_u32 s61, s67, s84
    s_add_u32 m0, s66, 73728
    s_add_u32 s61, s61, 0
    buffer_load_dwordx4 v224, s[40:43], s61 offen lds
    s_waitcnt lgkmcnt(4)
    v_mfma_f32_32x32x16_bf16 v[48:63], v[176:179], a[64:67], v[48:63]
    ds_read_b64_tr_b16 v[188:189], v226 offset:2048
    v_mfma_f32_32x32x16_bf16 v[64:79], v[176:179], a[136:139], v[64:79]
    ds_read_b64_tr_b16 v[190:191], v226 offset:3072
    s_add_u32 s61, s67, s84
    s_add_u32 m0, s66, 77824
    s_add_u32 s61, s61, 36864
    buffer_load_dwordx4 v224, s[40:43], s61 offen lds
    s_waitcnt lgkmcnt(4)
    v_mfma_f32_32x32x16_bf16 v[48:63], v[180:183], a[68:71], v[48:63]
    ds_read_b64_tr_b16 v[176:177], v226 offset:4096
    v_mfma_f32_32x32x16_bf16 v[64:79], v[180:183], a[140:143], v[64:79]
    ds_read_b64_tr_b16 v[178:179], v226 offset:5120
    s_add_u32 s61, s67, s84
    s_add_u32 m0, s66, 81920
    s_add_u32 s61, s61, 73728
    buffer_load_dwordx4 v224, s[40:43], s61 offen lds
    s_waitcnt lgkmcnt(4)
    v_mfma_f32_32x32x16_bf16 v[16:31], v[184:187], a[0:3], 0
    ds_read_b64_tr_b16 v[180:181], v226 offset:6144
    s_add_u32 s61, s67, s84
    s_add_u32 m0, s66, 86016
    s_add_u32 s61, s61, 110592
    buffer_load_dwordx4 v224, s[40:43], s61 offen lds
    v_mfma_f32_32x32x16_bf16 v[32:47], v[184:187], a[72:75], 0
    ds_read_b64_tr_b16 v[182:183], v226 offset:7168
    s_waitcnt lgkmcnt(4)
    v_mfma_f32_32x32x16_bf16 v[16:31], v[188:191], a[4:7], v[16:31]
    ds_read_b64_tr_b16 v[184:185], v226 offset:8192
    s_add_u32 s61, s67, s84
    s_add_u32 m0, s66, 90112
    s_add_u32 s61, s61, 147456
    buffer_load_dwordx4 v224, s[40:43], s61 offen lds
    v_mfma_f32_32x32x16_bf16 v[32:47], v[188:191], a[76:79], v[32:47]
    ds_read_b64_tr_b16 v[186:187], v226 offset:9216
    s_waitcnt lgkmcnt(4)
    v_mfma_f32_32x32x16_bf16 v[16:31], v[176:179], a[8:11], v[16:31]
    ds_read_b64_tr_b16 v[188:189], v226 offset:10240
    s_add_u32 s61, s67, s84
    s_add_u32 m0, s66, 94208
    s_add_u32 s61, s61, 184320
    buffer_load_dwordx4 v224, s[40:43], s61 offen lds
    v_mfma_f32_32x32x16_bf16 v[32:47], v[176:179], a[80:83], v[32:47]
    ds_read_b64_tr_b16 v[190:191], v226 offset:11264
    v_cvt_pk_bf16_f32 v200, v48, v49
    v_cvt_pk_bf16_f32 v201, v50, v51
    s_waitcnt lgkmcnt(4)
    v_mfma_f32_32x32x16_bf16 v[16:31], v[180:183], a[12:15], v[16:31]
    ds_read_b64_tr_b16 v[176:177], v226 offset:12288
    s_add_u32 s61, s67, s84
    s_add_u32 m0, s66, 98304
    s_add_u32 s61, s61, 221184
    buffer_load_dwordx4 v224, s[40:43], s61 offen lds
    v_mfma_f32_32x32x16_bf16 v[32:47], v[180:183], a[84:87], v[32:47]
    ds_read_b64_tr_b16 v[178:179], v226 offset:13312
    v_cvt_pk_bf16_f32 v202, v52, v53
    v_cvt_pk_bf16_f32 v203, v54, v55
    s_waitcnt lgkmcnt(4)
    v_mfma_f32_32x32x16_bf16 v[16:31], v[184:187], a[16:19], v[16:31]
    ds_read_b64_tr_b16 v[180:181], v226 offset:14336
    s_add_u32 s61, s67, s84
    s_add_u32 m0, s66, 102400
    s_add_u32 s61, s61, 258048
    buffer_load_dwordx4 v224, s[40:43], s61 offen lds
    v_mfma_f32_32x32x16_bf16 v[32:47], v[184:187], a[88:91], v[32:47]
    ds_read_b64_tr_b16 v[182:183], v226 offset:15360
    v_cvt_pk_bf16_f32 v204, v56, v57
    v_cvt_pk_bf16_f32 v205, v58, v59
    s_waitcnt lgkmcnt(4)
    v_mfma_f32_32x32x16_bf16 v[16:31], v[188:191], a[20:23], v[16:31]
    ds_read_b64_tr_b16 v[184:185], v226 offset:16384
    s_add_u32 s61, s68, s84
    s_add_u32 m0, s66, 106496
    s_add_u32 s61, s61, 0
    buffer_load_dwordx4 v224, s[40:43], s61 offen lds
    v_mfma_f32_32x32x16_bf16 v[32:47], v[188:191], a[92:95], v[32:47]
    ds_read_b64_tr_b16 v[186:187], v226 offset:17408
    v_cvt_pk_bf16_f32 v206, v60, v61
    v_cvt_pk_bf16_f32 v207, v62, v63
    s_waitcnt lgkmcnt(4)
    v_mfma_f32_32x32x16_bf16 v[16:31], v[176:179], a[24:27], v[16:31]
    ds_read_b64_tr_b16 v[188:189], v226 offset:18432
    s_add_u32 s84, s83, 3
    s_cmp_ge_u32 s84, 9
    s_cselect_b32 s62, 9, 0
    s_sub_u32 s84, s84, s62
    s_mul_i32 s84, s84, 128
    s_add_u32 s61, s67, s84
    s_add_u32 m0, s66, 110592
    s_add_u32 s61, s61, 0
    buffer_load_dwordx4 v224, s[40:43], s61 offen lds
    v_mfma_f32_32x32x16_bf16 v[32:47], v[176:179], a[96:99], v[32:47]
    ds_read_b64_tr_b16 v[190:191], v226 offset:19456
    s_waitcnt lgkmcnt(4)
    v_mfma_f32_32x32x16_bf16 v[16:31], v[180:183], a[28:31], v[16:31]
    ds_read_b64_tr_b16 v[176:177], v226 offset:20480
    s_add_u32 s61, s67, s84
    s_add_u32 m0, s66, 114688
    s_add_u32 s61, s61, 36864
    buffer_load_dwordx4 v224, s[40:43], s61 offen lds
    v_mfma_f32_32x32x16_bf16 v[32:47], v[180:183], a[100:103], v[32:47]
    ds_read_b64_tr_b16 v[178:179], v226 offset:21504
    s_waitcnt lgkmcnt(4)
    v_mfma_f32_32x32x16_bf16 v[16:31], v[184:187], a[32:35], v[16:31]
    ds_read_b64_tr_b16 v[180:181], v226 offset:22528
    s_add_u32 s61, s67, s84
    s_add_u32 m0, s66, 118784
    s_add_u32 s61, s61, 73728
    buffer_load_dwordx4 v224, s[40:43], s61 offen lds
    v_mfma_f32_32x32x16_bf16 v[32:47], v[184:187], a[104:107], v[32:47]
    ds_read_b64_tr_b16 v[182:183], v226 offset:23552
    s_waitcnt lgkmcnt(4)
    v_mfma_f32_32x32x16_bf16 v[16:31], v[188:191], a[36:39], v[16:31]
    ds_read_b64_tr_b16 v[184:185], v226 offset:24576
    s_add_u32 s61, s67, s84
    s_add_u32 m0, s66, 122880
    s_add_u32 s61, s61, 110592
    buffer_load_dwordx4 v224, s[40:43], s61 offen lds
    v_mfma_f32_32x32x16_bf16 v[32:47], v[188:191], a[108:111], v[32:47]
    ds_read_b64_tr_b16 v[186:187], v226 offset:25600
    s_waitcnt lgkmcnt(4)
    v_mfma_f32_32x32x16_bf16 v[16:31], v[176:179], a[40:43], v[16:31]
    ds_read_b64_tr_b16 v[188:189], v226 offset:26624
    s_add_u32 s61, s67, s84
    s_add_u32 m0, s66, 126976
    s_add_u32 s61, s61, 147456
    buffer_load_dwordx4 v224, s[40:43], s61 offen lds
    v_mfma_f32_32x32x16_bf16 v[32:47], v[176:179], a[112:115], v[32:47]
    ds_read_b64_tr_b16 v[190:191], v226 offset:27648
    s_waitcnt lgkmcnt(4)
    v_mfma_f32_32x32x16_bf16 v[16:31], v[180:183], a[44:47], v[16:31]
    ds_read_b64_tr_b16 v[176:177], v226 offset:28672
    s_add_u32 s61, s67, s84
    s_add_u32 m0, s66, 131072
    s_add_u32 s61, s61, 184320
    buffer_load_dwordx4 v224, s[40:43], s61 offen lds
    v_mfma_f32_32x32x16_bf16 v[32:47], v[180:183], a[116:119], v[32:47]
    ds_read_b64_tr_b16 v[178:179], v226 offset:29696
    s_waitcnt lgkmcnt(4)
    v_mfma_f32_32x32x16_bf16 v[16:31], v[184:187], a[48:51], v[16:31]
    ds_read_b64_tr_b16 v[180:181], v226 offset:30720
    s_add_u32 s61, s67, s84
    s_add_u32 m0, s66, 135168
    s_add_u32 s61, s61, 221184
    buffer_load_dwordx4 v224, s[40:43], s61 offen lds
    v_mfma_f32_32x32x16_bf16 v[32:47], v[184:187], a[120:123], v[32:47]
    ds_read_b64_tr_b16 v[182:183], v226 offset:31744
    s_waitcnt lgkmcnt(4)
    v_mfma_f32_32x32x16_bf16 v[16:31], v[188:191], a[52:55], v[16:31]
    ds_read_b64_tr_b16 v[184:185], v226 offset:32768
    s_add_u32 s61, s67, s84
    s_add_u32 m0, s66, 139264
    s_add_u32 s61, s61, 258048
    buffer_load_dwordx4 v224, s[40:43], s61 offen lds
    v_mfma_f32_32x32x16_bf16 v[32:47], v[188:191], a[124:127], v[32:47]
    ds_read_b64_tr_b16 v[186:187], v226 offset:33792
    s_waitcnt lgkmcnt(4)
    v_mfma_f32_32x32x16_bf16 v[16:31], v[176:179], a[56:59], v[16:31]
    ds_read_b64_tr_b16 v[188:189], v226 offset:34816
    s_add_u32 s61, s68, s84
    s_add_u32 m0, s66, 143360
    s_add_u32 s61, s61, 0
    buffer_load_dwordx4 v224, s[40:43], s61 offen lds
    v_mfma_f32_32x32x16_bf16 v[32:47], v[176:179], a[128:131], v[32:47]
    ds_read_b64_tr_b16 v[190:191], v226 offset:35840
    s_waitcnt lgkmcnt(4)
    v_mfma_f32_32x32x16_bf16 v[16:31], v[180:183], a[60:63], v[16:31]
    s_waitcnt vmcnt(9)
    s_barrier
    ds_read_b64_tr_b16 v[176:177], v227 offset:0
    v_mfma_f32_32x32x16_bf16 v[32:47], v[180:183], a[132:135], v[32:47]
    ds_read_b64_tr_b16 v[178:179], v227 offset:1024
    s_add_u32 s84, s83, 4
    s_cmp_ge_u32 s84, 9
    s_cselect_b32 s62, 9, 0
    s_sub_u32 s84, s84, s62
    s_mul_i32 s84, s84, 128
    s_add_u32 s61, s67, s84
    s_add_u32 m0, s66, 0
    s_add_u32 s61, s61, 0
    buffer_load_dwordx4 v224, s[40:43], s61 offen lds
    s_waitcnt lgkmcnt(4)
    v_mfma_f32_32x32x16_bf16 v[16:31], v[184:187], a[64:67], v[16:31]
    ds_read_b64_tr_b16 v[180:181], v227 offset:2048
    v_mfma_f32_32x32x16_bf16 v[32:47], v[184:187], a[136:139], v[32:47]
    ds_read_b64_tr_b16 v[182:183], v227 offset:3072
    s_add_u32 s61, s67, s84
    s_add_u32 m0, s66, 4096
    s_add_u32 s61, s61, 36864
    buffer_load_dwordx4 v224, s[40:43], s61 offen lds
    s_waitcnt lgkmcnt(4)
    v_mfma_f32_32x32x16_bf16 v[16:31], v[188:191], a[68:71], v[16:31]
    ds_read_b64_tr_b16 v[184:185], v227 offset:4096
    v_mfma_f32_32x32x16_bf16 v[32:47], v[188:191], a[140:143], v[32:47]
    ds_read_b64_tr_b16 v[186:187], v227 offset:5120
    s_add_u32 s61, s67, s84
    s_add_u32 m0, s66, 8192
    s_add_u32 s61, s61, 73728
    buffer_load_dwordx4 v224, s[40:43], s61 offen lds
    s_add_u32 s85, s83, 0
    s_cmp_ge_u32 s85, 9
    s_cselect_b32 s87, 9, 0
    s_sub_u32 s85, s85, s87
    s_mul_i32 s85, s85, 65536
    s_add_u32 s69, s65, s85
    s_add_u32 s69, s69, 0
    buffer_store_dwordx4 v[200:203], v1, s[44:47], s69 offen sc1
    s_add_u32 s69, s65, s85
    s_add_u32 s69, s69, 16384
    buffer_store_dwordx4 v[204:207], v1, s[44:47], s69 offen sc1
    v_cvt_pk_bf16_f32 v208, v64, v65
    v_cvt_pk_bf16_f32 v209, v66, v67
    v_cvt_pk_bf16_f32 v210, v68, v69
    v_cvt_pk_bf16_f32 v211, v70, v71
    v_cvt_pk_bf16_f32 v212, v72, v73
    v_cvt_pk_bf16_f32 v213, v74, v75
    v_cvt_pk_bf16_f32 v214, v76, v77
    v_cvt_pk_bf16_f32 v215, v78, v79
    s_add_u32 s69, s65, s85
    s_add_u32 s69, s69, 589824
    buffer_store_dwordx4 v[208:211], v1, s[44:47], s69 offen sc1
    s_add_u32 s69, s65, s85
    s_add_u32 s69, s69, 606208
    buffer_store_dwordx4 v[212:215], v1, s[44:47], s69 offen sc1
    s_waitcnt lgkmcnt(4)
    v_mfma_f32_32x32x16_bf16 v[48:63], v[176:179], a[0:3], 0
    ds_read_b64_tr_b16 v[188:189], v227 offset:6144
    s_add_u32 s61, s67, s84
    s_add_u32 m0, s66, 12288
    s_add_u32 s61, s61, 110592
    buffer_load_dwordx4 v224, s[40:43], s61 offen lds
    v_mfma_f32_32x32x16_bf16 v[64:79], v[176:179], a[72:75], 0
    ds_read_b64_tr_b16 v[190:191], v227 offset:7168
    s_waitcnt lgkmcnt(4)
    v_mfma_f32_32x32x16_bf16 v[48:63], v[180:183], a[4:7], v[48:63]
    ds_read_b64_tr_b16 v[176:177], v227 offset:8192
    s_add_u32 s61, s67, s84
    s_add_u32 m0, s66, 16384
    s_add_u32 s61, s61, 147456
    buffer_load_dwordx4 v224, s[40:43], s61 offen lds
    v_mfma_f32_32x32x16_bf16 v[64:79], v[180:183], a[76:79], v[64:79]
    ds_read_b64_tr_b16 v[178:179], v227 offset:9216
    s_waitcnt lgkmcnt(4)
    v_mfma_f32_32x32x16_bf16 v[48:63], v[184:187], a[8:11], v[48:63]
    ds_read_b64_tr_b16 v[180:181], v227 offset:10240
    s_add_u32 s61, s67, s84
    s_add_u32 m0, s66, 20480
    s_add_u32 s61, s61, 184320
    buffer_load_dwordx4 v224, s[40:43], s61 offen lds
    v_mfma_f32_32x32x16_bf16 v[64:79], v[184:187], a[80:83], v[64:79]
    ds_read_b64_tr_b16 v[182:183], v227 offset:11264
    v_cvt_pk_bf16_f32 v200, v16, v17
    v_cvt_pk_bf16_f32 v201, v18, v19
    s_waitcnt lgkmcnt(4)
    v_mfma_f32_32x32x16_bf16 v[48:63], v[188:191], a[12:15], v[48:63]
    ds_read_b64_tr_b16 v[184:185], v227 offset:12288
    s_add_u32 s61, s67, s84
    s_add_u32 m0, s66, 24576
    s_add_u32 s61, s61, 221184
    buffer_load_dwordx4 v224, s[40:43], s61 offen lds
    v_mfma_f32_32x32x16_bf16 v[64:79], v[188:191], a[84:87], v[64:79]
    ds_read_b64_tr_b16 v[186:187], v227 offset:13312
    v_cvt_pk_bf16_f32 v202, v20, v21
    v_cvt_pk_bf16_f32 v203, v22, v23
    s_waitcnt lgkmcnt(4)
    v_mfma_f32_32x32x16_bf16 v[48:63], v[176:179], a[16:19], v[48:63]
    ds_read_b64_tr_b16 v[188:189], v227 offset:14336
    s_add_u32 s61, s67, s84
    s_add_u32 m0, s66, 28672
    s_add_u32 s61, s61, 258048
    buffer_load_dwordx4 v224, s[40:43], s61 offen lds
    v_mfma_f32_32x32x16_bf16 v[64:79], v[176:179], a[88:91], v[64:79]
    ds_read_b64_tr_b16 v[190:191], v227 offset:15360
    v_cvt_pk_bf16_f32 v204, v24, v25
    v_cvt_pk_bf16_f32 v205, v26, v27
    s_waitcnt lgkmcnt(4)
    v_mfma_f32_32x32x16_bf16 v[48:63], v[180:183], a[20:23], v[48:63]
    ds_read_b64_tr_b16 v[176:177], v227 offset:16384
    s_add_u32 s61, s68, s84
    s_add_u32 m0, s66, 32768
    s_add_u32 s61, s61, 0
    buffer_load_dwordx4 v224, s[40:43], s61 offen lds
    v_mfma_f32_32x32x16_bf16 v[64:79], v[180:183], a[92:95], v[64:79]
    ds_read_b64_tr_b16 v[178:179], v227 offset:17408
    v_cvt_pk_bf16_f32 v206, v28, v29
    v_cvt_pk_bf16_f32 v207, v30, v31
    s_waitcnt lgkmcnt(4)
    v_mfma_f32_32x32x16_bf16 v[48:63], v[184:187], a[24:27], v[48:63]
    ds_read_b64_tr_b16 v[180:181], v227 offset:18432
    s_add_u32 s85, s83, 1
    s_cmp_ge_u32 s85, 9
    s_cselect_b32 s87, 9, 0
    s_sub_u32 s85, s85, s87
    s_mul_i32 s85, s85, 65536
    s_add_u32 s69, s65, s85
    s_add_u32 s69, s69, 0
    buffer_store_dwordx4 v[200:203], v1, s[44:47], s69 offen sc1
    v_mfma_f32_32x32x16_bf16 v[64:79], v[184:187], a[96:99], v[64:79]
    ds_read_b64_tr_b16 v[182:183], v227 offset:19456
    s_waitcnt lgkmcnt(4)
    v_mfma_f32_32x32x16_bf16 v[48:63], v[188:191], a[28:31], v[48:63]
    ds_read_b64_tr_b16 v[184:185], v227 offset:20480
    s_add_u32 s69, s65, s85
    s_add_u32 s69, s69, 16384
    buffer_store_dwordx4 v[204:207], v1, s[44:47], s69 offen sc1
    v_mfma_f32_32x32x16_bf16 v[64:79], v[188:191], a[100:103], v[64:79]
    ds_read_b64_tr_b16 v[186:187], v227 offset:21504
    v_cvt_pk_bf16_f32 v208, v32, v33
    v_cvt_pk_bf16_f32 v209, v34, v35
    s_waitcnt lgkmcnt(4)
    v_mfma_f32_32x32x16_bf16 v[48:63], v[176:179], a[32:35], v[48:63]
    ds_read_b64_tr_b16 v[188:189], v227 offset:22528
    v_cvt_pk_bf16_f32 v210, v36, v37
    v_cvt_pk_bf16_f32 v211, v38, v39
    v_mfma_f32_32x32x16_bf16 v[64:79], v[176:179], a[104:107], v[64:79]
    ds_read_b64_tr_b16 v[190:191], v227 offset:23552
    v_cvt_pk_bf16_f32 v212, v40, v41
    v_cvt_pk_bf16_f32 v213, v42, v43
    s_waitcnt lgkmcnt(4)
    v_mfma_f32_32x32x16_bf16 v[48:63], v[180:183], a[36:39], v[48:63]
    ds_read_b64_tr_b16 v[176:177], v227 offset:24576
    v_cvt_pk_bf16_f32 v214, v44, v45
    v_cvt_pk_bf16_f32 v215, v46, v47
    v_mfma_f32_32x32x16_bf16 v[64:79], v[180:183], a[108:111], v[64:79]
    ds_read_b64_tr_b16 v[178:179], v227 offset:25600
    s_add_u32 s69, s65, s85
    s_add_u32 s69, s69, 589824
    buffer_store_dwordx4 v[208:211], v1, s[44:47], s69 offen sc1
    s_waitcnt lgkmcnt(4)
    v_mfma_f32_32x32x16_bf16 v[48:63], v[184:187], a[40:43], v[48:63]
    ds_read_b64_tr_b16 v[180:181], v227 offset:26624
    v_mfma_f32_32x32x16_bf16 v[64:79], v[184:187], a[112:115], v[64:79]
    ds_read_b64_tr_b16 v[182:183], v227 offset:27648
    s_add_u32 s69, s65, s85
    s_add_u32 s69, s69, 606208
    buffer_store_dwordx4 v[212:215], v1, s[44:47], s69 offen sc1
    s_waitcnt lgkmcnt(4)
    v_mfma_f32_32x32x16_bf16 v[48:63], v[188:191], a[44:47], v[48:63]
    ds_read_b64_tr_b16 v[184:185], v227 offset:28672
    s_sub_u32 s82, s52, 9
    s_lshl_b32 s82, s82, 4
    v_mfma_f32_32x32x16_bf16 v[64:79], v[188:191], a[116:119], v[64:79]
    ds_read_b64_tr_b16 v[186:187], v227 offset:29696
    s_add_u32 s82, s82, s51
    s_mul_i32 s82, s82, 3
    s_waitcnt lgkmcnt(4)
    v_mfma_f32_32x32x16_bf16 v[48:63], v[176:179], a[48:51], v[48:63]
    ds_read_b64_tr_b16 v[188:189], v227 offset:30720
    s_add_u32 s82, s82, s48
    v_mfma_f32_32x32x16_bf16 v[64:79], v[176:179], a[120:123], v[64:79]
    ds_read_b64_tr_b16 v[190:191], v227 offset:31744
    s_cmp_lt_u32 s52, 9
    s_cselect_b32 s82, 0x7fff, s82
    s_waitcnt lgkmcnt(4)
    v_mfma_f32_32x32x16_bf16 v[48:63], v[180:183], a[52:55], v[48:63]
    ds_read_b64_tr_b16 v[176:177], v227 offset:32768
    s_cmp_ge_u32 s48, 3
    s_cselect_b32 s82, 0x7fff, s82
    v_mfma_f32_32x32x16_bf16 v[64:79], v[180:183], a[124:127], v[64:79]
    ds_read_b64_tr_b16 v[178:179], v227 offset:33792
    s_cmp_gt_u32 s82, 288
    s_cselect_b32 s82, 0x7fff, s82
    v_and_b32 v233, 15, v248
    s_waitcnt lgkmcnt(4)
    v_mfma_f32_32x32x16_bf16 v[48:63], v[184:187], a[56:59], v[48:63]
    ds_read_b64_tr_b16 v[180:181], v227 offset:34816
    v_lshlrev_b32 v233, 2, v233
    v_bfe_u32 v232, v248, 4, 1
    v_mfma_f32_32x32x16_bf16 v[64:79], v[184:187], a[128:131], v[64:79]
    ds_read_b64_tr_b16 v[182:183], v227 offset:35840
    v_mul_u32_u24 v232, 576, v232
    v_add_u32 v233, v233, v232
    s_waitcnt lgkmcnt(4)
    v_mfma_f32_32x32x16_bf16 v[48:63], v[188:191], a[60:63], v[48:63]
    s_waitcnt vmcnt(17)
    s_barrier
    ds_read_b64_tr_b16 v[184:185], v228 offset:0
    s_lshr_b32 s101, s82, 5
    s_lshl_b32 s101, s101, 6
    v_mfma_f32_32x32x16_bf16 v[64:79], v[188:191], a[132:135], v[64:79]
    ds_read_b64_tr_b16 v[186:187], v228 offset:1024
    s_add_u32 s84, s83, 5
    s_cmp_ge_u32 s84, 9
    s_cselect_b32 s62, 9, 0
    s_sub_u32 s84, s84, s62
    s_mul_i32 s84, s84, 128
    s_add_u32 s61, s67, s84
    s_add_u32 m0, s66, 36864
    s_add_u32 s61, s61, 0
    buffer_load_dwordx4 v224, s[40:43], s61 offen lds
    s_waitcnt lgkmcnt(4)
    v_mfma_f32_32x32x16_bf16 v[48:63], v[176:179], a[64:67], v[48:63]
    ds_read_b64_tr_b16 v[188:189], v228 offset:2048
    v_add_u32 v233, s101, v233
    v_lshrrev_b32 v232, 3, v248
    v_mfma_f32_32x32x16_bf16 v[64:79], v[176:179], a[136:139], v[64:79]
    ds_read_b64_tr_b16 v[190:191], v228 offset:3072
    s_add_u32 s61, s67, s84
    s_add_u32 m0, s66, 40960
    s_add_u32 s61, s61, 36864
    buffer_load_dwordx4 v224, s[40:43], s61 offen lds
    s_waitcnt lgkmcnt(4)
    v_mfma_f32_32x32x16_bf16 v[48:63], v[180:183], a[68:71], v[48:63]
    ds_read_b64_tr_b16 v[176:177], v228 offset:4096
    v_lshlrev_b32 v232, 7, v232
    v_bfe_u32 v235, v248, 4, 1
    v_mfma_f32_32x32x16_bf16 v[64:79], v[180:183], a[140:143], v[64:79]
    ds_read_b64_tr_b16 v[178:179], v228 offset:5120
    s_add_u32 s61, s67, s84
    s_add_u32 m0, s66, 45056
    s_add_u32 s61, s61, 73728
    buffer_load_dwordx4 v224, s[40:43], s61 offen lds
    v_lshlrev_b32 v235, 1, v235
    v_bfe_u32 v236, v248, 1, 2
    v_xor_b32 v236, v236, v235
    v_lshl_add_u32 v232, v236, 5, v232
    v_and_b32 v236, 1, v248
    v_lshl_add_u32 v232, v236, 4, v232
    s_add_u32 s32, s26, 9961472
    s_addc_u32 s33, s27, 0
    s_mov_b32 s34, 38912
    s_mov_b32 s35, 0x00020000
    s_add_u32 s36, s26, 12582912
    s_addc_u32 s37, s27, 0
    s_mov_b32 s38, 2367488
    s_mov_b32 s39, 0x00020000
    s_cmp_gt_u32 s82, 288
    s_cselect_b32 s100, 0x7ff00000, 0
    s_add_u32 s61, s100, 0
    buffer_load_dwordx4 a[144:147], v1, s[32:35], s61 offen
    s_add_u32 s61, s100, 1024
    buffer_load_dwordx4 a[148:151], v1, s[32:35], s61 offen
    s_add_u32 s61, s100, 2048
    buffer_load_dwordx4 a[152:155], v1, s[32:35], s61 offen
    s_waitcnt lgkmcnt(4)
    v_mfma_f32_32x32x16_bf16 v[16:31], v[184:187], a[0:3], 0
    ds_read_b64_tr_b16 v[180:181], v228 offset:6144
    s_add_u32 s61, s67, s84
    s_add_u32 m0, s66, 49152
    s_add_u32 s61, s61, 110592
    buffer_load_dwordx4 v224, s[40:43], s61 offen lds
    v_mfma_f32_32x32x16_bf16 v[32:47], v[184:187], a[72:75], 0
    ds_read_b64_tr_b16 v[182:183], v228 offset:7168
    s_waitcnt lgkmcnt(4)
    v_mfma_f32_32x32x16_bf16 v[16:31], v[188:191], a[4:7], v[16:31]
    ds_read_b64_tr_b16 v[184:185], v228 offset:8192
    s_add_u32 s61, s67, s84
    s_add_u32 m0, s66, 53248
    s_add_u32 s61, s61, 147456
    buffer_load_dwordx4 v224, s[40:43], s61 offen lds
    v_mfma_f32_32x32x16_bf16 v[32:47], v[188:191], a[76:79], v[32:47]
    ds_read_b64_tr_b16 v[186:187], v228 offset:9216
    s_waitcnt lgkmcnt(4)
    v_mfma_f32_32x32x16_bf16 v[16:31], v[176:179], a[8:11], v[16:31]
    ds_read_b64_tr_b16 v[188:189], v228 offset:10240
    s_add_u32 s61, s67, s84
    s_add_u32 m0, s66, 57344
    s_add_u32 s61, s61, 184320
    buffer_load_dwordx4 v224, s[40:43], s61 offen lds
    v_mfma_f32_32x32x16_bf16 v[32:47], v[176:179], a[80:83], v[32:47]
    ds_read_b64_tr_b16 v[190:191], v228 offset:11264
    v_cvt_pk_bf16_f32 v200, v48, v49
    v_cvt_pk_bf16_f32 v201, v50, v51
    s_waitcnt lgkmcnt(4)
    v_mfma_f32_32x32x16_bf16 v[16:31], v[180:183], a[12:15], v[16:31]
    ds_read_b64_tr_b16 v[176:177], v228 offset:12288
    s_add_u32 s61, s67, s84
    s_add_u32 m0, s66, 61440
    s_add_u32 s61, s61, 221184
    buffer_load_dwordx4 v224, s[40:43], s61 offen lds
    v_mfma_f32_32x32x16_bf16 v[32:47], v[180:183], a[84:87], v[32:47]
    ds_read_b64_tr_b16 v[178:179], v228 offset:13312
    v_cvt_pk_bf16_f32 v202, v52, v53
    v_cvt_pk_bf16_f32 v203, v54, v55
    s_waitcnt lgkmcnt(4)
    v_mfma_f32_32x32x16_bf16 v[16:31], v[184:187], a[16:19], v[16:31]
    ds_read_b64_tr_b16 v[180:181], v228 offset:14336
    s_add_u32 s61, s67, s84
    s_add_u32 m0, s66, 65536
    s_add_u32 s61, s61, 258048
    buffer_load_dwordx4 v224, s[40:43], s61 offen lds
    v_mfma_f32_32x32x16_bf16 v[32:47], v[184:187], a[88:91], v[32:47]
    ds_read_b64_tr_b16 v[182:183], v228 offset:15360
    v_cvt_pk_bf16_f32 v204, v56, v57
    v_cvt_pk_bf16_f32 v205, v58, v59
    s_waitcnt lgkmcnt(4)
    v_mfma_f32_32x32x16_bf16 v[16:31], v[188:191], a[20:23], v[16:31]
    ds_read_b64_tr_b16 v[184:185], v228 offset:16384
    s_add_u32 s61, s68, s84
    s_add_u32 m0, s66, 69632
    s_add_u32 s61, s61, 0
    buffer_load_dwordx4 v224, s[40:43], s61 offen lds
    v_mfma_f32_32x32x16_bf16 v[32:47], v[188:191], a[92:95], v[32:47]
    ds_read_b64_tr_b16 v[186:187], v228 offset:17408
    v_cvt_pk_bf16_f32 v206, v60, v61
    v_cvt_pk_bf16_f32 v207, v62, v63
    s_waitcnt lgkmcnt(4)
    v_mfma_f32_32x32x16_bf16 v[16:31], v[176:179], a[24:27], v[16:31]
    ds_read_b64_tr_b16 v[188:189], v228 offset:18432
    s_add_u32 s85, s83, 2
    s_cmp_ge_u32 s85, 9
    s_cselect_b32 s87, 9, 0
    s_sub_u32 s85, s85, s87
    s_mul_i32 s85, s85, 65536
    s_add_u32 s69, s65, s85
    s_add_u32 s69, s69, 0
    buffer_store_dwordx4 v[200:203], v1, s[44:47], s69 offen sc1
    v_mfma_f32_32x32x16_bf16 v[32:47], v[176:179], a[96:99], v[32:47]
    ds_read_b64_tr_b16 v[190:191], v228 offset:19456
    s_waitcnt lgkmcnt(4)
    v_mfma_f32_32x32x16_bf16 v[16:31], v[180:183], a[28:31], v[16:31]
    ds_read_b64_tr_b16 v[176:177], v228 offset:20480
    s_add_u32 s69, s65, s85
    s_add_u32 s69, s69, 16384
    buffer_store_dwordx4 v[204:207], v1, s[44:47], s69 offen sc1
    v_mfma_f32_32x32x16_bf16 v[32:47], v[180:183], a[100:103], v[32:47]
    ds_read_b64_tr_b16 v[178:179], v228 offset:21504
    v_cvt_pk_bf16_f32 v208, v64, v65
    v_cvt_pk_bf16_f32 v209, v66, v67
    s_waitcnt lgkmcnt(4)
    v_mfma_f32_32x32x16_bf16 v[16:31], v[184:187], a[32:35], v[16:31]
    ds_read_b64_tr_b16 v[180:181], v228 offset:22528
    v_cvt_pk_bf16_f32 v210, v68, v69
    v_cvt_pk_bf16_f32 v211, v70, v71
    v_mfma_f32_32x32x16_bf16 v[32:47], v[184:187], a[104:107], v[32:47]
    ds_read_b64_tr_b16 v[182:183], v228 offset:23552
    v_cvt_pk_bf16_f32 v212, v72, v73
    v_cvt_pk_bf16_f32 v213, v74, v75
    s_waitcnt lgkmcnt(4)
    v_mfma_f32_32x32x16_bf16 v[16:31], v[188:191], a[36:39], v[16:31]
    ds_read_b64_tr_b16 v[184:185], v228 offset:24576
    v_cvt_pk_bf16_f32 v214, v76, v77
    v_cvt_pk_bf16_f32 v215, v78, v79
    v_mfma_f32_32x32x16_bf16 v[32:47], v[188:191], a[108:111], v[32:47]
    ds_read_b64_tr_b16 v[186:187], v228 offset:25600
    s_add_u32 s69, s65, s85
    s_add_u32 s69, s69, 589824
    buffer_store_dwordx4 v[208:211], v1, s[44:47], s69 offen sc1
    s_waitcnt lgkmcnt(4)
    v_mfma_f32_32x32x16_bf16 v[16:31], v[176:179], a[40:43], v[16:31]
    ds_read_b64_tr_b16 v[188:189], v228 offset:26624
    v_mfma_f32_32x32x16_bf16 v[32:47], v[176:179], a[112:115], v[32:47]
    ds_read_b64_tr_b16 v[190:191], v228 offset:27648
    s_add_u32 s69, s65, s85
    s_add_u32 s69, s69, 606208
    buffer_store_dwordx4 v[212:215], v1, s[44:47], s69 offen sc1
    s_waitcnt lgkmcnt(4)
    v_mfma_f32_32x32x16_bf16 v[16:31], v[180:183], a[44:47], v[16:31]
    ds_read_b64_tr_b16 v[176:177], v228 offset:28672
    v_mfma_f32_32x32x16_bf16 v[32:47], v[180:183], a[116:119], v[32:47]
    ds_read_b64_tr_b16 v[178:179], v228 offset:29696
    s_add_u32 s61, s100, 3072
    buffer_load_dwordx4 a[156:159], v1, s[32:35], s61 offen
    s_waitcnt lgkmcnt(4)
    v_mfma_f32_32x32x16_bf16 v[16:31], v[184:187], a[48:51], v[16:31]
    ds_read_b64_tr_b16 v[180:181], v228 offset:30720
    v_mfma_f32_32x32x16_bf16 v[32:47], v[184:187], a[120:123], v[32:47]
    ds_read_b64_tr_b16 v[182:183], v228 offset:31744
    s_add_u32 s61, s100, 4096
    buffer_load_dwordx4 a[160:163], v1, s[32:35], s61 offen
    s_waitcnt lgkmcnt(4)
    v_mfma_f32_32x32x16_bf16 v[16:31], v[188:191], a[52:55], v[16:31]
    ds_read_b64_tr_b16 v[184:185], v228 offset:32768
    v_mfma_f32_32x32x16_bf16 v[32:47], v[188:191], a[124:127], v[32:47]
    ds_read_b64_tr_b16 v[186:187], v228 offset:33792
    s_add_u32 s61, s100, 5120
    buffer_load_dwordx4 a[164:167], v1, s[32:35], s61 offen
    s_waitcnt lgkmcnt(4)
    v_mfma_f32_32x32x16_bf16 v[16:31], v[176:179], a[56:59], v[16:31]
    ds_read_b64_tr_b16 v[188:189], v228 offset:34816
    v_mfma_f32_32x32x16_bf16 v[32:47], v[176:179], a[128:131], v[32:47]
    ds_read_b64_tr_b16 v[190:191], v228 offset:35840
    s_add_u32 s61, s100, 22528
    buffer_load_dwordx4 a[168:171], v1, s[32:35], s61 offen
    s_waitcnt lgkmcnt(4)
    v_mfma_f32_32x32x16_bf16 v[16:31], v[180:183], a[60:63], v[16:31]
    s_waitcnt vmcnt(24)
    s_barrier
    ds_read_b64_tr_b16 v[176:177], v225 offset:0
    v_mfma_f32_32x32x16_bf16 v[32:47], v[180:183], a[132:135], v[32:47]
    ds_read_b64_tr_b16 v[178:179], v225 offset:1024
    s_add_u32 s84, s83, 6
    s_cmp_ge_u32 s84, 9
    s_cselect_b32 s62, 9, 0
    s_sub_u32 s84, s84, s62
    s_mul_i32 s84, s84, 128
    s_add_u32 s61, s67, s84
    s_add_u32 m0, s66, 73728
    s_add_u32 s61, s61, 0
    buffer_load_dwordx4 v224, s[40:43], s61 offen lds
    s_waitcnt lgkmcnt(4)
    v_mfma_f32_32x32x16_bf16 v[16:31], v[184:187], a[64:67], v[16:31]
    ds_read_b64_tr_b16 v[180:181], v225 offset:2048
    v_mfma_f32_32x32x16_bf16 v[32:47], v[184:187], a[136:139], v[32:47]
    ds_read_b64_tr_b16 v[182:183], v225 offset:3072
    s_add_u32 s61, s67, s84
    s_add_u32 m0, s66, 77824
    s_add_u32 s61, s61, 36864
    buffer_load_dwordx4 v224, s[40:43], s61 offen lds
    s_waitcnt lgkmcnt(4)
    v_mfma_f32_32x32x16_bf16 v[16:31], v[188:191], a[68:71], v[16:31]
    ds_read_b64_tr_b16 v[184:185], v225 offset:4096
    v_mfma_f32_32x32x16_bf16 v[32:47], v[188:191], a[140:143], v[32:47]
    ds_read_b64_tr_b16 v[186:187], v225 offset:5120
    s_add_u32 s61, s67, s84
    s_add_u32 m0, s66, 81920
    s_add_u32 s61, s61, 73728
    buffer_load_dwordx4 v224, s[40:43], s61 offen lds
    s_add_u32 s61, s100, 23552
    buffer_load_dwordx4 a[172:175], v1, s[32:35], s61 offen
    v_and_b32 v238, 31, v248
    v_cvt_f32_u32 v238, v238
    v_mul_f32 v238, 0x3a000000, v238
    v_bfe_u32 v239, v248, 5, 1
    v_cvt_f32_u32 v239, v239
    v_mul_f32 v239, 4.0, v239
    v_mul_f32 v239, v239, v238
    v_fmamk_f32 v240, v238, 0x00000000, v239
    v_cos_f32 v112, v240
    v_sin_f32 v144, v240
    v_fmamk_f32 v241, v238, 0x3f800000, v239
    v_cos_f32 v113, v241
    v_sin_f32 v145, v241
    v_fmamk_f32 v240, v238, 0x40000000, v239
    v_cos_f32 v114, v240
    v_sin_f32 v146, v240
    v_fmamk_f32 v241, v238, 0x40400000, v239
    v_cos_f32 v115, v241
    v_sin_f32 v147, v241
    v_fmamk_f32 v240, v238, 0x41000000, v239
    v_cos_f32 v116, v240
    v_sin_f32 v148, v240
    v_fmamk_f32 v241, v238, 0x41100000, v239
    v_cos_f32 v117, v241
    v_sin_f32 v149, v241
    v_fmamk_f32 v240, v238, 0x41200000, v239
    v_cos_f32 v118, v240
    v_sin_f32 v150, v240
    v_fmamk_f32 v241, v238, 0x41300000, v239
    v_cos_f32 v119, v241
    v_sin_f32 v151, v241
    v_fmamk_f32 v240, v238, 0x41800000, v239
    v_cos_f32 v120, v240
    v_sin_f32 v152, v240
    s_waitcnt lgkmcnt(4)
    v_mfma_f32_32x32x16_bf16 v[48:63], v[176:179], a[0:3], 0
    ds_read_b64_tr_b16 v[188:189], v225 offset:6144
    s_add_u32 s61, s67, s84
    s_add_u32 m0, s66, 86016
    s_add_u32 s61, s61, 110592
    buffer_load_dwordx4 v224, s[40:43], s61 offen lds
    v_mfma_f32_32x32x16_bf16 v[64:79], v[176:179], a[72:75], 0
    ds_read_b64_tr_b16 v[190:191], v225 offset:7168
    s_waitcnt lgkmcnt(4)
    v_mfma_f32_32x32x16_bf16 v[48:63], v[180:183], a[4:7], v[48:63]
    ds_read_b64_tr_b16 v[176:177], v225 offset:8192
    s_add_u32 s61, s67, s84
    s_add_u32 m0, s66, 90112
    s_add_u32 s61, s61, 147456
    buffer_load_dwordx4 v224, s[40:43], s61 offen lds
    v_mfma_f32_32x32x16_bf16 v[64:79], v[180:183], a[76:79], v[64:79]
    ds_read_b64_tr_b16 v[178:179], v225 offset:9216
    s_waitcnt lgkmcnt(4)
    v_mfma_f32_32x32x16_bf16 v[48:63], v[184:187], a[8:11], v[48:63]
    ds_read_b64_tr_b16 v[180:181], v225 offset:10240
    s_add_u32 s61, s67, s84
    s_add_u32 m0, s66, 94208
    s_add_u32 s61, s61, 184320
    buffer_load_dwordx4 v224, s[40:43], s61 offen lds
    v_mfma_f32_32x32x16_bf16 v[64:79], v[184:187], a[80:83], v[64:79]
    ds_read_b64_tr_b16 v[182:183], v225 offset:11264
    v_cvt_pk_bf16_f32 v200, v16, v17
    v_cvt_pk_bf16_f32 v201, v18, v19
    s_waitcnt lgkmcnt(4)
    v_mfma_f32_32x32x16_bf16 v[48:63], v[188:191], a[12:15], v[48:63]
    ds_read_b64_tr_b16 v[184:185], v225 offset:12288
    s_add_u32 s61, s67, s84
    s_add_u32 m0, s66, 98304
    s_add_u32 s61, s61, 221184
    buffer_load_dwordx4 v224, s[40:43], s61 offen lds
    v_mfma_f32_32x32x16_bf16 v[64:79], v[188:191], a[84:87], v[64:79]
    ds_read_b64_tr_b16 v[186:187], v225 offset:13312
    v_cvt_pk_bf16_f32 v202, v20, v21
    v_cvt_pk_bf16_f32 v203, v22, v23
    s_waitcnt lgkmcnt(4)
    v_mfma_f32_32x32x16_bf16 v[48:63], v[176:179], a[16:19], v[48:63]
    ds_read_b64_tr_b16 v[188:189], v225 offset:14336
    s_add_u32 s61, s67, s84
    s_add_u32 m0, s66, 102400
    s_add_u32 s61, s61, 258048
    buffer_load_dwordx4 v224, s[40:43], s61 offen lds
    v_mfma_f32_32x32x16_bf16 v[64:79], v[176:179], a[88:91], v[64:79]
    ds_read_b64_tr_b16 v[190:191], v225 offset:15360
    v_cvt_pk_bf16_f32 v204, v24, v25
    v_cvt_pk_bf16_f32 v205, v26, v27
    s_waitcnt lgkmcnt(4)
    v_mfma_f32_32x32x16_bf16 v[48:63], v[180:183], a[20:23], v[48:63]
    ds_read_b64_tr_b16 v[176:177], v225 offset:16384
    s_add_u32 s61, s68, s84
    s_add_u32 m0, s66, 106496
    s_add_u32 s61, s61, 0
    buffer_load_dwordx4 v224, s[40:43], s61 offen lds
    v_mfma_f32_32x32x16_bf16 v[64:79], v[180:183], a[92:95], v[64:79]
    ds_read_b64_tr_b16 v[178:179], v225 offset:17408
    v_cvt_pk_bf16_f32 v206, v28, v29
    v_cvt_pk_bf16_f32 v207, v30, v31
    s_waitcnt lgkmcnt(4)
    v_mfma_f32_32x32x16_bf16 v[48:63], v[184:187], a[24:27], v[48:63]
    ds_read_b64_tr_b16 v[180:181], v225 offset:18432
    s_add_u32 s85, s83, 3
    s_cmp_ge_u32 s85, 9
    s_cselect_b32 s87, 9, 0
    s_sub_u32 s85, s85, s87
    s_mul_i32 s85, s85, 65536
    s_add_u32 s69, s65, s85
    s_add_u32 s69, s69, 0
    buffer_store_dwordx4 v[200:203], v1, s[44:47], s69 offen sc1
    v_mfma_f32_32x32x16_bf16 v[64:79], v[184:187], a[96:99], v[64:79]
    ds_read_b64_tr_b16 v[182:183], v225 offset:19456
    s_waitcnt lgkmcnt(4)
    v_mfma_f32_32x32x16_bf16 v[48:63], v[188:191], a[28:31], v[48:63]
    ds_read_b64_tr_b16 v[184:185], v225 offset:20480
    s_add_u32 s69, s65, s85
    s_add_u32 s69, s69, 16384
    buffer_store_dwordx4 v[204:207], v1, s[44:47], s69 offen sc1
    v_mfma_f32_32x32x16_bf16 v[64:79], v[188:191], a[100:103], v[64:79]
    ds_read_b64_tr_b16 v[186:187], v225 offset:21504
    v_cvt_pk_bf16_f32 v208, v32, v33
    v_cvt_pk_bf16_f32 v209, v34, v35
    s_waitcnt lgkmcnt(4)
    v_mfma_f32_32x32x16_bf16 v[48:63], v[176:179], a[32:35], v[48:63]
    ds_read_b64_tr_b16 v[188:189], v225 offset:22528
    v_cvt_pk_bf16_f32 v210, v36, v37
    v_cvt_pk_bf16_f32 v211, v38, v39
    v_mfma_f32_32x32x16_bf16 v[64:79], v[176:179], a[104:107], v[64:79]
    ds_read_b64_tr_b16 v[190:191], v225 offset:23552
    v_cvt_pk_bf16_f32 v212, v40, v41
    v_cvt_pk_bf16_f32 v213, v42, v43
    s_waitcnt lgkmcnt(4)
    v_mfma_f32_32x32x16_bf16 v[48:63], v[180:183], a[36:39], v[48:63]
    ds_read_b64_tr_b16 v[176:177], v225 offset:24576
    v_cvt_pk_bf16_f32 v214, v44, v45
    v_cvt_pk_bf16_f32 v215, v46, v47
    v_mfma_f32_32x32x16_bf16 v[64:79], v[180:183], a[108:111], v[64:79]
    ds_read_b64_tr_b16 v[178:179], v225 offset:25600
    s_add_u32 s69, s65, s85
    s_add_u32 s69, s69, 589824
    buffer_store_dwordx4 v[208:211], v1, s[44:47], s69 offen sc1
    s_waitcnt lgkmcnt(4)
    v_mfma_f32_32x32x16_bf16 v[48:63], v[184:187], a[40:43], v[48:63]
    ds_read_b64_tr_b16 v[180:181], v225 offset:26624
    v_mfma_f32_32x32x16_bf16 v[64:79], v[184:187], a[112:115], v[64:79]
    ds_read_b64_tr_b16 v[182:183], v225 offset:27648
    s_add_u32 s69, s65, s85
    s_add_u32 s69, s69, 606208
    buffer_store_dwordx4 v[212:215], v1, s[44:47], s69 offen sc1
    s_waitcnt lgkmcnt(4)
    v_mfma_f32_32x32x16_bf16 v[48:63], v[188:191], a[44:47], v[48:63]
    ds_read_b64_tr_b16 v[184:185], v225 offset:28672
    v_mfma_f32_32x32x16_bf16 v[64:79], v[188:191], a[116:119], v[64:79]
    ds_read_b64_tr_b16 v[186:187], v225 offset:29696
    s_add_u32 s61, s100, 24576
    buffer_load_dwordx4 a[176:179], v1, s[32:35], s61 offen
    s_waitcnt lgkmcnt(4)
    v_mfma_f32_32x32x16_bf16 v[48:63], v[176:179], a[48:51], v[48:63]
    ds_read_b64_tr_b16 v[188:189], v225 offset:30720
    v_mfma_f32_32x32x16_bf16 v[64:79], v[176:179], a[120:123], v[64:79]
    ds_read_b64_tr_b16 v[190:191], v225 offset:31744
    s_add_u32 s61, s100, 25600
    buffer_load_dwordx4 a[180:183], v1, s[32:35], s61 offen
    s_waitcnt lgkmcnt(4)
    v_mfma_f32_32x32x16_bf16 v[48:63], v[180:183], a[52:55], v[48:63]
    ds_read_b64_tr_b16 v[176:177], v225 offset:32768
    v_mfma_f32_32x32x16_bf16 v[64:79], v[180:183], a[124:127], v[64:79]
    ds_read_b64_tr_b16 v[178:179], v225 offset:33792
    s_add_u32 s61, s100, 26624
    buffer_load_dwordx4 a[184:187], v1, s[32:35], s61 offen
    s_waitcnt lgkmcnt(4)
    v_mfma_f32_32x32x16_bf16 v[48:63], v[184:187], a[56:59], v[48:63]
    ds_read_b64_tr_b16 v[180:181], v225 offset:34816
    v_mfma_f32_32x32x16_bf16 v[64:79], v[184:187], a[128:131], v[64:79]
    ds_read_b64_tr_b16 v[182:183], v225 offset:35840
    s_add_u32 s61, s100, 27648
    buffer_load_dwordx4 a[188:191], v1, s[32:35], s61 offen
    s_waitcnt lgkmcnt(4)
    v_mfma_f32_32x32x16_bf16 v[48:63], v[188:191], a[60:63], v[48:63]
    s_waitcnt vmcnt(26)
    s_barrier
    ds_read_b64_tr_b16 v[184:185], v226 offset:0
    v_mfma_f32_32x32x16_bf16 v[64:79], v[188:191], a[132:135], v[64:79]
    ds_read_b64_tr_b16 v[186:187], v226 offset:1024
    s_add_u32 s84, s83, 7
    s_cmp_ge_u32 s84, 9
    s_cselect_b32 s62, 9, 0
    s_sub_u32 s84, s84, s62
    s_mul_i32 s84, s84, 128
    s_add_u32 s61, s67, s84
    s_add_u32 m0, s66, 110592
    s_add_u32 s61, s61, 0
    buffer_load_dwordx4 v224, s[40:43], s61 offen lds
    s_waitcnt lgkmcnt(4)
    v_mfma_f32_32x32x16_bf16 v[48:63], v[176:179], a[64:67], v[48:63]
    ds_read_b64_tr_b16 v[188:189], v226 offset:2048
    v_mfma_f32_32x32x16_bf16 v[64:79], v[176:179], a[136:139], v[64:79]
    ds_read_b64_tr_b16 v[190:191], v226 offset:3072
    s_add_u32 s61, s67, s84
    s_add_u32 m0, s66, 114688
    s_add_u32 s61, s61, 36864
    buffer_load_dwordx4 v224, s[40:43], s61 offen lds
    s_waitcnt lgkmcnt(4)
    v_mfma_f32_32x32x16_bf16 v[48:63], v[180:183], a[68:71], v[48:63]
    ds_read_b64_tr_b16 v[176:177], v226 offset:4096
    v_mfma_f32_32x32x16_bf16 v[64:79], v[180:183], a[140:143], v[64:79]
    ds_read_b64_tr_b16 v[178:179], v226 offset:5120
    s_add_u32 s61, s67, s84
    s_add_u32 m0, s66, 118784
    s_add_u32 s61, s61, 73728
    buffer_load_dwordx4 v224, s[40:43], s61 offen lds
    s_add_u32 s61, s100, 28672
    buffer_load_dwordx4 a[192:195], v1, s[32:35], s61 offen
    v_fmamk_f32 v241, v238, 0x41880000, v239
    v_cos_f32 v121, v241
    v_sin_f32 v153, v241
    v_fmamk_f32 v240, v238, 0x41900000, v239
    v_cos_f32 v122, v240
    v_sin_f32 v154, v240
    v_fmamk_f32 v241, v238, 0x41980000, v239
    v_cos_f32 v123, v241
    v_sin_f32 v155, v241
    v_fmamk_f32 v240, v238, 0x41c00000, v239
    v_cos_f32 v124, v240
    v_sin_f32 v156, v240
    v_fmamk_f32 v241, v238, 0x41c80000, v239
    v_cos_f32 v125, v241
    v_sin_f32 v157, v241
    v_fmamk_f32 v240, v238, 0x41d00000, v239
    v_cos_f32 v126, v240
    v_sin_f32 v158, v240
    v_fmamk_f32 v241, v238, 0x41d80000, v239
    v_cos_f32 v127, v241
    v_sin_f32 v159, v241
    v_fmamk_f32 v240, v238, 0x42000000, v239
    v_cos_f32 v128, v240
    v_sin_f32 v160, v240
    v_fmamk_f32 v241, v238, 0x42040000, v239
    v_cos_f32 v129, v241
    v_sin_f32 v161, v241
    v_fmamk_f32 v240, v238, 0x42080000, v239
    v_cos_f32 v130, v240
    v_sin_f32 v162, v240
    v_fmamk_f32 v241, v238, 0x420c0000, v239
    v_cos_f32 v131, v241
    v_sin_f32 v163, v241
    v_fmamk_f32 v240, v238, 0x42200000, v239
    v_cos_f32 v132, v240
    v_sin_f32 v164, v240
    s_getpc_b64 s[72:73]
L_k2_pc_1:
    s_add_u32 s72, s72, fin_kernel-L_k2_pc_1
    s_addc_u32 s73, s73, 0
    v_lshlrev_b32 v249, 6, v0
    v_min_u32 v249, L_code_end-fin_kernel-64, v249
    global_load_dword v250, v249, s[72:73]
    s_waitcnt lgkmcnt(4)
    v_mfma_f32_32x32x16_bf16 v[16:31], v[184:187], a[0:3], 0
    ds_read_b64_tr_b16 v[180:181], v226 offset:6144
    s_add_u32 s61, s67, s84
    s_add_u32 m0, s66, 122880
    s_add_u32 s61, s61, 110592
    buffer_load_dwordx4 v224, s[40:43], s61 offen lds
    v_mfma_f32_32x32x16_bf16 v[32:47], v[184:187], a[72:75], 0
    ds_read_b64_tr_b16 v[182:183], v226 offset:7168
    s_waitcnt lgkmcnt(4)
    v_mfma_f32_32x32x16_bf16 v[16:31], v[188:191], a[4:7], v[16:31]
    ds_read_b64_tr_b16 v[184:185], v226 offset:8192
    s_add_u32 s61, s67, s84
    s_add_u32 m0, s66, 126976
    s_add_u32 s61, s61, 147456
    buffer_load_dwordx4 v224, s[40:43], s61 offen lds
    v_mfma_f32_32x32x16_bf16 v[32:47], v[188:191], a[76:79], v[32:47]
    ds_read_b64_tr_b16 v[186:187], v226 offset:9216
    s_waitcnt lgkmcnt(4)
    v_mfma_f32_32x32x16_bf16 v[16:31], v[176:179], a[8:11], v[16:31]
    ds_read_b64_tr_b16 v[188:189], v226 offset:10240
    s_add_u32 s61, s67, s84
    s_add_u32 m0, s66, 131072
    s_add_u32 s61, s61, 184320
    buffer_load_dwordx4 v224, s[40:43], s61 offen lds
    v_mfma_f32_32x32x16_bf16 v[32:47], v[176:179], a[80:83], v[32:47]
    ds_read_b64_tr_b16 v[190:191], v226 offset:11264
    v_cvt_pk_bf16_f32 v200, v48, v49
    v_cvt_pk_bf16_f32 v201, v50, v51
    s_waitcnt lgkmcnt(4)
    v_mfma_f32_32x32x16_bf16 v[16:31], v[180:183], a[12:15], v[16:31]
    ds_read_b64_tr_b16 v[176:177], v226 offset:12288
    s_add_u32 s61, s67, s84
    s_add_u32 m0, s66, 135168
    s_add_u32 s61, s61, 221184
    buffer_load_dwordx4 v224, s[40:43], s61 offen lds
    v_mfma_f32_32x32x16_bf16 v[32:47], v[180:183], a[84:87], v[32:47]
    ds_read_b64_tr_b16 v[178:179], v226 offset:13312
    v_cvt_pk_bf16_f32 v202, v52, v53
    v_cvt_pk_bf16_f32 v203, v54, v55
    s_waitcnt lgkmcnt(4)
    v_mfma_f32_32x32x16_bf16 v[16:31], v[184:187], a[16:19], v[16:31]
    ds_read_b64_tr_b16 v[180:181], v226 offset:14336
    s_add_u32 s61, s67, s84
    s_add_u32 m0, s66, 139264
    s_add_u32 s61, s61, 258048
    buffer_load_dwordx4 v224, s[40:43], s61 offen lds
    v_mfma_f32_32x32x16_bf16 v[32:47], v[184:187], a[88:91], v[32:47]
    ds_read_b64_tr_b16 v[182:183], v226 offset:15360
    v_cvt_pk_bf16_f32 v204, v56, v57
    v_cvt_pk_bf16_f32 v205, v58, v59
    s_waitcnt lgkmcnt(4)
    v_mfma_f32_32x32x16_bf16 v[16:31], v[188:191], a[20:23], v[16:31]
    ds_read_b64_tr_b16 v[184:185], v226 offset:16384
    s_add_u32 s61, s68, s84
    s_add_u32 m0, s66, 143360
    s_add_u32 s61, s61, 0
    buffer_load_dwordx4 v224, s[40:43], s61 offen lds
    v_mfma_f32_32x32x16_bf16 v[32:47], v[188:191], a[92:95], v[32:47]
    ds_read_b64_tr_b16 v[186:187], v226 offset:17408
    v_cvt_pk_bf16_f32 v206, v60, v61
    v_cvt_pk_bf16_f32 v207, v62, v63
    s_waitcnt lgkmcnt(4)
    v_mfma_f32_32x32x16_bf16 v[16:31], v[176:179], a[24:27], v[16:31]
    ds_read_b64_tr_b16 v[188:189], v226 offset:18432
    s_add_u32 s85, s83, 4
    s_cmp_ge_u32 s85, 9
    s_cselect_b32 s87, 9, 0
    s_sub_u32 s85, s85, s87
    s_mul_i32 s85, s85, 65536
    s_add_u32 s69, s65, s85
    s_add_u32 s69, s69, 0
    buffer_store_dwordx4 v[200:203], v1, s[44:47], s69 offen sc1
    v_mfma_f32_32x32x16_bf16 v[32:47], v[176:179], a[96:99], v[32:47]
    ds_read_b64_tr_b16 v[190:191], v226 offset:19456
    s_waitcnt lgkmcnt(4)
    v_mfma_f32_32x32x16_bf16 v[16:31], v[180:183], a[28:31], v[16:31]
    ds_read_b64_tr_b16 v[176:177], v226 offset:20480
    s_add_u32 s69, s65, s85
    s_add_u32 s69, s69, 16384
    buffer_store_dwordx4 v[204:207], v1, s[44:47], s69 offen sc1
    v_mfma_f32_32x32x16_bf16 v[32:47], v[180:183], a[100:103], v[32:47]
    ds_read_b64_tr_b16 v[178:179], v226 offset:21504
    v_cvt_pk_bf16_f32 v208, v64, v65
    v_cvt_pk_bf16_f32 v209, v66, v67
    s_waitcnt lgkmcnt(4)
    v_mfma_f32_32x32x16_bf16 v[16:31], v[184:187], a[32:35], v[16:31]
    ds_read_b64_tr_b16 v[180:181], v226 offset:22528
    v_cvt_pk_bf16_f32 v210, v68, v69
    v_cvt_pk_bf16_f32 v211, v70, v71
    v_mfma_f32_32x32x16_bf16 v[32:47], v[184:187], a[104:107], v[32:47]
    ds_read_b64_tr_b16 v[182:183], v226 offset:23552
    v_cvt_pk_bf16_f32 v212, v72, v73
    v_cvt_pk_bf16_f32 v213, v74, v75
    s_waitcnt lgkmcnt(4)
    v_mfma_f32_32x32x16_bf16 v[16:31], v[188:191], a[36:39], v[16:31]
    ds_read_b64_tr_b16 v[184:185], v226 offset:24576
    v_cvt_pk_bf16_f32 v214, v76, v77
    v_cvt_pk_bf16_f32 v215, v78, v79
    v_mfma_f32_32x32x16_bf16 v[32:47], v[188:191], a[108:111], v[32:47]
    ds_read_b64_tr_b16 v[186:187], v226 offset:25600
    s_add_u32 s69, s65, s85
    s_add_u32 s69, s69, 589824
    buffer_store_dwordx4 v[208:211], v1, s[44:47], s69 offen sc1
    s_waitcnt lgkmcnt(4)
    v_mfma_f32_32x32x16_bf16 v[16:31], v[176:179], a[40:43], v[16:31]
    ds_read_b64_tr_b16 v[188:189], v226 offset:26624
    v_mfma_f32_32x32x16_bf16 v[32:47], v[176:179], a[112:115], v[32:47]
    ds_read_b64_tr_b16 v[190:191], v226 offset:27648
    s_add_u32 s69, s65, s85
    s_add_u32 s69, s69, 606208
    buffer_store_dwordx4 v[212:215], v1, s[44:47], s69 offen sc1
    s_waitcnt lgkmcnt(4)
    v_mfma_f32_32x32x16_bf16 v[16:31], v[180:183], a[44:47], v[16:31]
    ds_read_b64_tr_b16 v[176:177], v226 offset:28672
    v_mfma_f32_32x32x16_bf16 v[32:47], v[180:183], a[116:119], v[32:47]
    ds_read_b64_tr_b16 v[178:179], v226 offset:29696
    s_add_u32 s61, s100, 29696
    buffer_load_dwordx4 a[196:199], v1, s[32:35], s61 offen
    s_waitcnt lgkmcnt(4)
    v_mfma_f32_32x32x16_bf16 v[16:31], v[184:187], a[48:51], v[16:31]
    ds_read_b64_tr_b16 v[180:181], v226 offset:30720
    v_mfma_f32_32x32x16_bf16 v[32:47], v[184:187], a[120:123], v[32:47]
    ds_read_b64_tr_b16 v[182:183], v226 offset:31744
    s_add_u32 s61, s100, 30720
    buffer_load_dwordx4 a[200:203], v1, s[32:35], s61 offen
    s_waitcnt lgkmcnt(4)
    v_mfma_f32_32x32x16_bf16 v[16:31], v[188:191], a[52:55], v[16:31]
    ds_read_b64_tr_b16 v[184:185], v226 offset:32768
    v_mfma_f32_32x32x16_bf16 v[32:47], v[188:191], a[124:127], v[32:47]
    ds_read_b64_tr_b16 v[186:187], v226 offset:33792
    s_add_u32 s61, s100, 31744
    buffer_load_dwordx4 a[204:207], v1, s[32:35], s61 offen
    s_waitcnt lgkmcnt(4)
    v_mfma_f32_32x32x16_bf16 v[16:31], v[176:179], a[56:59], v[16:31]
    ds_read_b64_tr_b16 v[188:189], v226 offset:34816
    v_mfma_f32_32x32x16_bf16 v[32:47], v[176:179], a[128:131], v[32:47]
    ds_read_b64_tr_b16 v[190:191], v226 offset:35840
    s_add_u32 s61, s100, 32768
    buffer_load_dwordx4 a[208:211], v1, s[32:35], s61 offen
    s_waitcnt lgkmcnt(4)
    v_mfma_f32_32x32x16_bf16 v[16:31], v[180:183], a[60:63], v[16:31]
    s_waitcnt vmcnt(27)
    s_barrier
    ds_read_b64_tr_b16 v[176:177], v227 offset:0
    v_mfma_f32_32x32x16_bf16 v[32:47], v[180:183], a[132:135], v[32:47]
    ds_read_b64_tr_b16 v[178:179], v227 offset:1024
    s_add_u32 s84, s83, 8
    s_cmp_ge_u32 s84, 9
    s_cselect_b32 s62, 9, 0
    s_sub_u32 s84, s84, s62
    s_mul_i32 s84, s84, 128
    s_add_u32 s61, s67, s84
    s_add_u32 m0, s66, 0
    s_add_u32 s61, s61, 0
    buffer_load_dwordx4 v224, s[40:43], s61 offen lds
    s_waitcnt lgkmcnt(4)
    v_mfma_f32_32x32x16_bf16 v[16:31], v[184:187], a[64:67], v[16:31]
    ds_read_b64_tr_b16 v[180:181], v227 offset:2048
    v_mfma_f32_32x32x16_bf16 v[32:47], v[184:187], a[136:139], v[32:47]
    ds_read_b64_tr_b16 v[182:183], v227 offset:3072
    s_add_u32 s61, s67, s84
    s_add_u32 m0, s66, 4096
    s_add_u32 s61, s61, 36864
    buffer_load_dwordx4 v224, s[40:43], s61 offen lds
    s_waitcnt lgkmcnt(4)
    v_mfma_f32_32x32x16_bf16 v[16:31], v[188:191], a[68:71], v[16:31]
    ds_read_b64_tr_b16 v[184:185], v227 offset:4096
    v_mfma_f32_32x32x16_bf16 v[32:47], v[188:191], a[140:143], v[32:47]
    ds_read_b64_tr_b16 v[186:187], v227 offset:5120
    s_add_u32 s61, s67, s84
    s_add_u32 m0, s66, 8192
    s_add_u32 s61, s61, 73728
    buffer_load_dwordx4 v224, s[40:43], s61 offen lds
    s_add_u32 s61, s100, 33792
    buffer_load_dwordx4 a[212:215], v1, s[32:35], s61 offen
    v_fmamk_f32 v241, v238, 0x42240000, v239
    v_cos_f32 v133, v241
    v_sin_f32 v165, v241
    v_fmamk_f32 v240, v238, 0x42280000, v239
    v_cos_f32 v134, v240
    v_sin_f32 v166, v240
    v_fmamk_f32 v241, v238, 0x422c0000, v239
    v_cos_f32 v135, v241
    v_sin_f32 v167, v241
    v_fmamk_f32 v240, v238, 0x42400000, v239
    v_cos_f32 v136, v240
    v_sin_f32 v168, v240
    v_fmamk_f32 v241, v238, 0x42440000, v239
    v_cos_f32 v137, v241
    v_sin_f32 v169, v241
    v_fmamk_f32 v240, v238, 0x42480000, v239
    v_cos_f32 v138, v240
    v_sin_f32 v170, v240
    v_fmamk_f32 v241, v238, 0x424c0000, v239
    v_cos_f32 v139, v241
    v_sin_f32 v171, v241
    v_fmamk_f32 v240, v238, 0x42600000, v239
    v_cos_f32 v140, v240
    v_sin_f32 v172, v240
    v_fmamk_f32 v241, v238, 0x42640000, v239
    v_cos_f32 v141, v241
    v_sin_f32 v173, v241
    v_fmamk_f32 v240, v238, 0x42680000, v239
    v_cos_f32 v142, v240
    v_sin_f32 v174, v240
    v_fmamk_f32 v241, v238, 0x426c0000, v239
    v_cos_f32 v143, v241
    v_sin_f32 v175, v241
    s_waitcnt lgkmcnt(4)
    v_mfma_f32_32x32x16_bf16 v[48:63], v[176:179], a[0:3], 0
    ds_read_b64_tr_b16 v[188:189], v227 offset:6144
    s_add_u32 s61, s67, s84
    s_add_u32 m0, s66, 12288
    s_add_u32 s61, s61, 110592
    buffer_load_dwordx4 v224, s[40:43], s61 offen lds
    v_mfma_f32_32x32x16_bf16 v[64:79], v[176:179], a[72:75], 0
    ds_read_b64_tr_b16 v[190:191], v227 offset:7168
    s_waitcnt lgkmcnt(4)
    v_mfma_f32_32x32x16_bf16 v[48:63], v[180:183], a[4:7], v[48:63]
    ds_read_b64_tr_b16 v[176:177], v227 offset:8192
    s_add_u32 s61, s67, s84
    s_add_u32 m0, s66, 16384
    s_add_u32 s61, s61, 147456
    buffer_load_dwordx4 v224, s[40:43], s61 offen lds
    v_mfma_f32_32x32x16_bf16 v[64:79], v[180:183], a[76:79], v[64:79]
    ds_read_b64_tr_b16 v[178:179], v227 offset:9216
    s_waitcnt lgkmcnt(4)
    v_mfma_f32_32x32x16_bf16 v[48:63], v[184:187], a[8:11], v[48:63]
    ds_read_b64_tr_b16 v[180:181], v227 offset:10240
    s_add_u32 s61, s67, s84
    s_add_u32 m0, s66, 20480
    s_add_u32 s61, s61, 184320
    buffer_load_dwordx4 v224, s[40:43], s61 offen lds
    v_mfma_f32_32x32x16_bf16 v[64:79], v[184:187], a[80:83], v[64:79]
    ds_read_b64_tr_b16 v[182:183], v227 offset:11264
    v_cvt_pk_bf16_f32 v200, v16, v17
    v_cvt_pk_bf16_f32 v201, v18, v19
    s_waitcnt lgkmcnt(4)
    v_mfma_f32_32x32x16_bf16 v[48:63], v[188:191], a[12:15], v[48:63]
    ds_read_b64_tr_b16 v[184:185], v227 offset:12288
    s_add_u32 s61, s67, s84
    s_add_u32 m0, s66, 24576
    s_add_u32 s61, s61, 221184
    buffer_load_dwordx4 v224, s[40:43], s61 offen lds
    v_mfma_f32_32x32x16_bf16 v[64:79], v[188:191], a[84:87], v[64:79]
    ds_read_b64_tr_b16 v[186:187], v227 offset:13312
    v_cvt_pk_bf16_f32 v202, v20, v21
    v_cvt_pk_bf16_f32 v203, v22, v23
    s_waitcnt lgkmcnt(4)
    v_mfma_f32_32x32x16_bf16 v[48:63], v[176:179], a[16:19], v[48:63]
    ds_read_b64_tr_b16 v[188:189], v227 offset:14336
    s_add_u32 s61, s67, s84
    s_add_u32 m0, s66, 28672
    s_add_u32 s61, s61, 258048
    buffer_load_dwordx4 v224, s[40:43], s61 offen lds
    v_mfma_f32_32x32x16_bf16 v[64:79], v[176:179], a[88:91], v[64:79]
    ds_read_b64_tr_b16 v[190:191], v227 offset:15360
    v_cvt_pk_bf16_f32 v204, v24, v25
    v_cvt_pk_bf16_f32 v205, v26, v27
    s_waitcnt lgkmcnt(4)
    v_mfma_f32_32x32x16_bf16 v[48:63], v[180:183], a[20:23], v[48:63]
    ds_read_b64_tr_b16 v[176:177], v227 offset:16384
    s_add_u32 s61, s68, s84
    s_add_u32 m0, s66, 32768
    s_add_u32 s61, s61, 0
    buffer_load_dwordx4 v224, s[40:43], s61 offen lds
    v_mfma_f32_32x32x16_bf16 v[64:79], v[180:183], a[92:95], v[64:79]
    ds_read_b64_tr_b16 v[178:179], v227 offset:17408
    v_cvt_pk_bf16_f32 v206, v28, v29
    v_cvt_pk_bf16_f32 v207, v30, v31
    s_waitcnt lgkmcnt(4)
    v_mfma_f32_32x32x16_bf16 v[48:63], v[184:187], a[24:27], v[48:63]
    ds_read_b64_tr_b16 v[180:181], v227 offset:18432
    s_add_u32 s85, s83, 5
    s_cmp_ge_u32 s85, 9
    s_cselect_b32 s87, 9, 0
    s_sub_u32 s85, s85, s87
    s_mul_i32 s85, s85, 65536
    s_add_u32 s69, s65, s85
    s_add_u32 s69, s69, 0
    buffer_store_dwordx4 v[200:203], v1, s[44:47], s69 offen sc1
    v_mfma_f32_32x32x16_bf16 v[64:79], v[184:187], a[96:99], v[64:79]
    ds_read_b64_tr_b16 v[182:183], v227 offset:19456
    s_waitcnt lgkmcnt(4)
    v_mfma_f32_32x32x16_bf16 v[48:63], v[188:191], a[28:31], v[48:63]
    ds_read_b64_tr_b16 v[184:185], v227 offset:20480
    s_add_u32 s69, s65, s85
    s_add_u32 s69, s69, 16384
    buffer_store_dwordx4 v[204:207], v1, s[44:47], s69 offen sc1
    v_mfma_f32_32x32x16_bf16 v[64:79], v[188:191], a[100:103], v[64:79]
    ds_read_b64_tr_b16 v[186:187], v227 offset:21504
    v_cvt_pk_bf16_f32 v208, v32, v33
    v_cvt_pk_bf16_f32 v209, v34, v35
    s_waitcnt lgkmcnt(4)
    v_mfma_f32_32x32x16_bf16 v[48:63], v[176:179], a[32:35], v[48:63]
    ds_read_b64_tr_b16 v[188:189], v227 offset:22528
    v_cvt_pk_bf16_f32 v210, v36, v37
    v_cvt_pk_bf16_f32 v211, v38, v39
    v_mfma_f32_32x32x16_bf16 v[64:79], v[176:179], a[104:107], v[64:79]
    ds_read_b64_tr_b16 v[190:191], v227 offset:23552
    v_cvt_pk_bf16_f32 v212, v40, v41
    v_cvt_pk_bf16_f32 v213, v42, v43
    s_waitcnt lgkmcnt(4)
    v_mfma_f32_32x32x16_bf16 v[48:63], v[180:183], a[36:39], v[48:63]
    ds_read_b64_tr_b16 v[176:177], v227 offset:24576
    v_cvt_pk_bf16_f32 v214, v44, v45
    v_cvt_pk_bf16_f32 v215, v46, v47
    v_mfma_f32_32x32x16_bf16 v[64:79], v[180:183], a[108:111], v[64:79]
    ds_read_b64_tr_b16 v[178:179], v227 offset:25600
    s_add_u32 s69, s65, s85
    s_add_u32 s69, s69, 589824
    buffer_store_dwordx4 v[208:211], v1, s[44:47], s69 offen sc1
    s_waitcnt lgkmcnt(4)
    v_mfma_f32_32x32x16_bf16 v[48:63], v[184:187], a[40:43], v[48:63]
    ds_read_b64_tr_b16 v[180:181], v227 offset:26624
    v_mfma_f32_32x32x16_bf16 v[64:79], v[184:187], a[112:115], v[64:79]
    ds_read_b64_tr_b16 v[182:183], v227 offset:27648
    s_add_u32 s69, s65, s85
    s_add_u32 s69, s69, 606208
    buffer_store_dwordx4 v[212:215], v1, s[44:47], s69 offen sc1
    s_waitcnt lgkmcnt(4)
    v_mfma_f32_32x32x16_bf16 v[48:63], v[188:191], a[44:47], v[48:63]
    ds_read_b64_tr_b16 v[184:185], v227 offset:28672
    v_mfma_f32_32x32x16_bf16 v[64:79], v[188:191], a[116:119], v[64:79]
    ds_read_b64_tr_b16 v[186:187], v227 offset:29696
    buffer_load_dword v234, v233, s[96:99], 0 offen sc1
    s_waitcnt lgkmcnt(4)
    v_mfma_f32_32x32x16_bf16 v[48:63], v[176:179], a[48:51], v[48:63]
    ds_read_b64_tr_b16 v[188:189], v227 offset:30720
    v_mfma_f32_32x32x16_bf16 v[64:79], v[176:179], a[120:123], v[64:79]
    ds_read_b64_tr_b16 v[190:191], v227 offset:31744
    s_add_u32 s61, s100, 34816
    buffer_load_dwordx4 a[216:219], v1, s[32:35], s61 offen
    s_waitcnt lgkmcnt(4)
    v_mfma_f32_32x32x16_bf16 v[48:63], v[180:183], a[52:55], v[48:63]
    ds_read_b64_tr_b16 v[176:177], v227 offset:32768
    v_mfma_f32_32x32x16_bf16 v[64:79], v[180:183], a[124:127], v[64:79]
    ds_read_b64_tr_b16 v[178:179], v227 offset:33792
    s_add_u32 s61, s100, 35840
    buffer_load_dwordx4 a[220:223], v1, s[32:35], s61 offen
    s_waitcnt lgkmcnt(4)
    v_mfma_f32_32x32x16_bf16 v[48:63], v[184:187], a[56:59], v[48:63]
    ds_read_b64_tr_b16 v[180:181], v227 offset:34816
    v_mfma_f32_32x32x16_bf16 v[64:79], v[184:187], a[128:131], v[64:79]
    ds_read_b64_tr_b16 v[182:183], v227 offset:35840
    s_add_u32 s61, s100, 36864
    buffer_load_dwordx4 a[224:227], v1, s[32:35], s61 offen
    s_waitcnt lgkmcnt(4)
    v_mfma_f32_32x32x16_bf16 v[48:63], v[188:191], a[60:63], v[48:63]
    s_waitcnt vmcnt(26)
    s_barrier
    ds_read_b64_tr_b16 v[184:185], v228 offset:0
    v_mfma_f32_32x32x16_bf16 v[64:79], v[188:191], a[132:135], v[64:79]
    ds_read_b64_tr_b16 v[186:187], v228 offset:1024
    s_add_u32 s61, s100, 37888
    buffer_load_dwordx4 a[228:231], v1, s[32:35], s61 offen
    s_waitcnt lgkmcnt(4)
    v_mfma_f32_32x32x16_bf16 v[48:63], v[176:179], a[64:67], v[48:63]
    ds_read_b64_tr_b16 v[188:189], v228 offset:2048
    v_mfma_f32_32x32x16_bf16 v[64:79], v[176:179], a[136:139], v[64:79]
    ds_read_b64_tr_b16 v[190:191], v228 offset:3072
    s_waitcnt lgkmcnt(4)
    v_mfma_f32_32x32x16_bf16 v[48:63], v[180:183], a[68:71], v[48:63]
    ds_read_b64_tr_b16 v[176:177], v228 offset:4096
    v_mfma_f32_32x32x16_bf16 v[64:79], v[180:183], a[140:143], v[64:79]
    ds_read_b64_tr_b16 v[178:179], v228 offset:5120
    s_waitcnt lgkmcnt(4)
    v_mfma_f32_32x32x16_bf16 v[16:31], v[184:187], a[0:3], 0
    ds_read_b64_tr_b16 v[180:181], v228 offset:6144
    v_mfma_f32_32x32x16_bf16 v[32:47], v[184:187], a[72:75], 0
    ds_read_b64_tr_b16 v[182:183], v228 offset:7168
    s_waitcnt lgkmcnt(4)
    v_mfma_f32_32x32x16_bf16 v[16:31], v[188:191], a[4:7], v[16:31]
    ds_read_b64_tr_b16 v[184:185], v228 offset:8192
    v_mfma_f32_32x32x16_bf16 v[32:47], v[188:191], a[76:79], v[32:47]
    ds_read_b64_tr_b16 v[186:187], v228 offset:9216
    s_waitcnt lgkmcnt(4)
    v_mfma_f32_32x32x16_bf16 v[16:31], v[176:179], a[8:11], v[16:31]
    ds_read_b64_tr_b16 v[188:189], v228 offset:10240
    v_cvt_pk_bf16_f32 v200, v48, v49
    v_cvt_pk_bf16_f32 v201, v50, v51
    v_mfma_f32_32x32x16_bf16 v[32:47], v[176:179], a[80:83], v[32:47]
    ds_read_b64_tr_b16 v[190:191], v228 offset:11264
    v_cvt_pk_bf16_f32 v202, v52, v53
    v_cvt_pk_bf16_f32 v203, v54, v55
    s_waitcnt lgkmcnt(4)
    v_mfma_f32_32x32x16_bf16 v[16:31], v[180:183], a[12:15], v[16:31]
    ds_read_b64_tr_b16 v[176:177], v228 offset:12288
    v_cvt_pk_bf16_f32 v204, v56, v57
    v_cvt_pk_bf16_f32 v205, v58, v59
    v_mfma_f32_32x32x16_bf16 v[32:47], v[180:183], a[84:87], v[32:47]
    ds_read_b64_tr_b16 v[178:179], v228 offset:13312
    v_cvt_pk_bf16_f32 v206, v60, v61
    v_cvt_pk_bf16_f32 v207, v62, v63
    s_waitcnt lgkmcnt(4)
    v_mfma_f32_32x32x16_bf16 v[16:31], v[184:187], a[16:19], v[16:31]
    ds_read_b64_tr_b16 v[180:181], v228 offset:14336
    s_add_u32 s85, s83, 6
    s_cmp_ge_u32 s85, 9
    s_cselect_b32 s87, 9, 0
    s_sub_u32 s85, s85, s87
    s_mul_i32 s85, s85, 65536
    s_add_u32 s69, s65, s85
    s_add_u32 s69, s69, 0
    buffer_store_dwordx4 v[200:203], v1, s[44:47], s69 offen sc1
    v_mfma_f32_32x32x16_bf16 v[32:47], v[184:187], a[88:91], v[32:47]
    ds_read_b64_tr_b16 v[182:183], v228 offset:15360
    s_waitcnt lgkmcnt(4)
    v_mfma_f32_32x32x16_bf16 v[16:31], v[188:191], a[20:23], v[16:31]
    ds_read_b64_tr_b16 v[184:185], v228 offset:16384
    s_add_u32 s69, s65, s85
    s_add_u32 s69, s69, 16384
    buffer_store_dwordx4 v[204:207], v1, s[44:47], s69 offen sc1
    v_mfma_f32_32x32x16_bf16 v[32:47], v[188:191], a[92:95], v[32:47]
    ds_read_b64_tr_b16 v[186:187], v228 offset:17408
    v_cvt_pk_bf16_f32 v208, v64, v65
    v_cvt_pk_bf16_f32 v209, v66, v67
    s_waitcnt lgkmcnt(4)
    v_mfma_f32_32x32x16_bf16 v[16:31], v[176:179], a[24:27], v[16:31]
    ds_read_b64_tr_b16 v[188:189], v228 offset:18432
    v_cvt_pk_bf16_f32 v210, v68, v69
    v_cvt_pk_bf16_f32 v211, v70, v71
    v_mfma_f32_32x32x16_bf16 v[32:47], v[176:179], a[96:99], v[32:47]
    ds_read_b64_tr_b16 v[190:191], v228 offset:19456
    v_cvt_pk_bf16_f32 v212, v72, v73
    v_cvt_pk_bf16_f32 v213, v74, v75
    s_waitcnt lgkmcnt(4)
    v_mfma_f32_32x32x16_bf16 v[16:31], v[180:183], a[28:31], v[16:31]
    ds_read_b64_tr_b16 v[176:177], v228 offset:20480
    v_cvt_pk_bf16_f32 v214, v76, v77
    v_cvt_pk_bf16_f32 v215, v78, v79
    v_mfma_f32_32x32x16_bf16 v[32:47], v[180:183], a[100:103], v[32:47]
    ds_read_b64_tr_b16 v[178:179], v228 offset:21504
    s_add_u32 s69, s65, s85
    s_add_u32 s69, s69, 589824
    buffer_store_dwordx4 v[208:211], v1, s[44:47], s69 offen sc1
    s_waitcnt lgkmcnt(4)
    v_mfma_f32_32x32x16_bf16 v[16:31], v[184:187], a[32:35], v[16:31]
    ds_read_b64_tr_b16 v[180:181], v228 offset:22528
    v_mfma_f32_32x32x16_bf16 v[32:47], v[184:187], a[104:107], v[32:47]
    ds_read_b64_tr_b16 v[182:183], v228 offset:23552
    s_add_u32 s69, s65, s85
    s_add_u32 s69, s69, 606208
    buffer_store_dwordx4 v[212:215], v1, s[44:47], s69 offen sc1
    s_waitcnt lgkmcnt(4)
    v_mfma_f32_32x32x16_bf16 v[16:31], v[188:191], a[36:39], v[16:31]
    ds_read_b64_tr_b16 v[184:185], v228 offset:24576
    s_waitcnt vmcnt(8)
    v_cmp_eq_u32 vcc, 1, v234
    s_nop 1
    s_cmp_eq_u64 vcc, exec
    s_cselect_b32 s71, 1, 0
    s_cmp_eq_u32 s82, 288
    s_cselect_b32 s71, 1, s71
    v_mfma_f32_32x32x16_bf16 v[32:47], v[188:191], a[108:111], v[32:47]
    ds_read_b64_tr_b16 v[186:187], v228 offset:25600
    s_lshl_b32 s61, s82, 13
    s_lshl_b32 s62, s48, 13
    s_add_u32 m0, s62, 36864
    s_add_u32 s61, s61, 0
    buffer_load_dwordx4 v232, s[76:79], s61 offen sc1 lds
    s_waitcnt lgkmcnt(4)
    v_mfma_f32_32x32x16_bf16 v[16:31], v[176:179], a[40:43], v[16:31]
    ds_read_b64_tr_b16 v[188:189], v228 offset:26624
    v_mfma_f32_32x32x16_bf16 v[32:47], v[176:179], a[112:115], v[32:47]
    ds_read_b64_tr_b16 v[190:191], v228 offset:27648
    s_lshl_b32 s61, s82, 13
    s_lshl_b32 s62, s48, 13
    s_add_u32 m0, s62, 37888
    s_add_u32 s61, s61, 1024
    buffer_load_dwordx4 v232, s[76:79], s61 offen sc1 lds
    s_waitcnt lgkmcnt(4)
    v_mfma_f32_32x32x16_bf16 v[16:31], v[180:183], a[44:47], v[16:31]
    ds_read_b64_tr_b16 v[176:177], v228 offset:28672
    v_mfma_f32_32x32x16_bf16 v[32:47], v[180:183], a[116:119], v[32:47]
    ds_read_b64_tr_b16 v[178:179], v228 offset:29696
    s_lshl_b32 s61, s82, 13
    s_lshl_b32 s62, s48, 13
    s_add_u32 m0, s62, 38912
    s_add_u32 s61, s61, 2048
    buffer_load_dwordx4 v232, s[76:79], s61 offen sc1 lds
    s_waitcnt lgkmcnt(4)
    v_mfma_f32_32x32x16_bf16 v[16:31], v[184:187], a[48:51], v[16:31]
    ds_read_b64_tr_b16 v[180:181], v228 offset:30720
    v_mfma_f32_32x32x16_bf16 v[32:47], v[184:187], a[120:123], v[32:47]
    ds_read_b64_tr_b16 v[182:183], v228 offset:31744
    s_lshl_b32 s61, s82, 13
    s_lshl_b32 s62, s48, 13
    s_add_u32 m0, s62, 39936
    s_add_u32 s61, s61, 3072
    buffer_load_dwordx4 v232, s[76:79], s61 offen sc1 lds
    s_waitcnt lgkmcnt(4)
    v_mfma_f32_32x32x16_bf16 v[16:31], v[188:191], a[52:55], v[16:31]
    ds_read_b64_tr_b16 v[184:185], v228 offset:32768
    v_mfma_f32_32x32x16_bf16 v[32:47], v[188:191], a[124:127], v[32:47]
    ds_read_b64_tr_b16 v[186:187], v228 offset:33792
    s_lshl_b32 s61, s82, 13
    s_lshl_b32 s62, s48, 13
    s_add_u32 m0, s62, 40960
    s_add_u32 s61, s61, 4096
    buffer_load_dwordx4 v232, s[76:79], s61 offen sc1 lds
    s_waitcnt lgkmcnt(4)
    v_mfma_f32_32x32x16_bf16 v[16:31], v[176:179], a[56:59], v[16:31]
    ds_read_b64_tr_b16 v[188:189], v228 offset:34816
    v_mfma_f32_32x32x16_bf16 v[32:47], v[176:179], a[128:131], v[32:47]
    ds_read_b64_tr_b16 v[190:191], v228 offset:35840
    s_lshl_b32 s61, s82, 13
    s_lshl_b32 s62, s48, 13
    s_add_u32 m0, s62, 41984
    s_add_u32 s61, s61, 5120
    buffer_load_dwordx4 v232, s[76:79], s61 offen sc1 lds
    s_waitcnt lgkmcnt(4)
    v_mfma_f32_32x32x16_bf16 v[16:31], v[180:183], a[60:63], v[16:31]
    s_barrier
    ds_read_b64_tr_b16 v[176:177], v225 offset:0
    v_mfma_f32_32x32x16_bf16 v[32:47], v[180:183], a[132:135], v[32:47]
    ds_read_b64_tr_b16 v[178:179], v225 offset:1024
    s_lshl_b32 s61, s82, 13
    s_lshl_b32 s62, s48, 13
    s_add_u32 m0, s62, 43008
    s_add_u32 s61, s61, 6144
    buffer_load_dwordx4 v232, s[76:79], s61 offen sc1 lds
    s_waitcnt lgkmcnt(4)
    v_mfma_f32_32x32x16_bf16 v[16:31], v[184:187], a[64:67], v[16:31]
    ds_read_b64_tr_b16 v[180:181], v225 offset:2048
    v_mfma_f32_32x32x16_bf16 v[32:47], v[184:187], a[136:139], v[32:47]
    ds_read_b64_tr_b16 v[182:183], v225 offset:3072
    s_lshl_b32 s61, s82, 13
    s_lshl_b32 s62, s48, 13
    s_add_u32 m0, s62, 44032
    s_add_u32 s61, s61, 7168
    buffer_load_dwordx4 v232, s[76:79], s61 offen sc1 lds
    s_waitcnt lgkmcnt(4)
    v_mfma_f32_32x32x16_bf16 v[16:31], v[188:191], a[68:71], v[16:31]
    ds_read_b64_tr_b16 v[184:185], v225 offset:4096
    v_mfma_f32_32x32x16_bf16 v[32:47], v[188:191], a[140:143], v[32:47]
    ds_read_b64_tr_b16 v[186:187], v225 offset:5120
    s_waitcnt lgkmcnt(4)
    v_mfma_f32_32x32x16_bf16 v[48:63], v[176:179], a[0:3], 0
    ds_read_b64_tr_b16 v[188:189], v225 offset:6144
    v_mfma_f32_32x32x16_bf16 v[64:79], v[176:179], a[72:75], 0
    ds_read_b64_tr_b16 v[190:191], v225 offset:7168
    s_waitcnt lgkmcnt(4)
    v_mfma_f32_32x32x16_bf16 v[48:63], v[180:183], a[4:7], v[48:63]
    ds_read_b64_tr_b16 v[176:177], v225 offset:8192
    v_mfma_f32_32x32x16_bf16 v[64:79], v[180:183], a[76:79], v[64:79]
    ds_read_b64_tr_b16 v[178:179], v225 offset:9216
    s_waitcnt lgkmcnt(4)
    v_mfma_f32_32x32x16_bf16 v[48:63], v[184:187], a[8:11], v[48:63]
    ds_read_b64_tr_b16 v[180:181], v225 offset:10240
    v_cvt_pk_bf16_f32 v200, v16, v17
    v_cvt_pk_bf16_f32 v201, v18, v19
    v_mfma_f32_32x32x16_bf16 v[64:79], v[184:187], a[80:83], v[64:79]
    ds_read_b64_tr_b16 v[182:183], v225 offset:11264
    v_cvt_pk_bf16_f32 v202, v20, v21
    v_cvt_pk_bf16_f32 v203, v22, v23
    s_waitcnt lgkmcnt(4)
    v_mfma_f32_32x32x16_bf16 v[48:63], v[188:191], a[12:15], v[48:63]
    ds_read_b64_tr_b16 v[184:185], v225 offset:12288
    v_cvt_pk_bf16_f32 v204, v24, v25
    v_cvt_pk_bf16_f32 v205, v26, v27
    v_mfma_f32_32x32x16_bf16 v[64:79], v[188:191], a[84:87], v[64:79]
    ds_read_b64_tr_b16 v[186:187], v225 offset:13312
    v_cvt_pk_bf16_f32 v206, v28, v29
    v_cvt_pk_bf16_f32 v207, v30, v31
    s_waitcnt lgkmcnt(4)
    v_mfma_f32_32x32x16_bf16 v[48:63], v[176:179], a[16:19], v[48:63]
    ds_read_b64_tr_b16 v[188:189], v225 offset:14336
    s_add_u32 s85, s83, 7
    s_cmp_ge_u32 s85, 9
    s_cselect_b32 s87, 9, 0
    s_sub_u32 s85, s85, s87
    s_mul_i32 s85, s85, 65536
    s_add_u32 s69, s65, s85
    s_add_u32 s69, s69, 0
    buffer_store_dwordx4 v[200:203], v1, s[44:47], s69 offen sc1
    v_mfma_f32_32x32x16_bf16 v[64:79], v[176:179], a[88:91], v[64:79]
    ds_read_b64_tr_b16 v[190:191], v225 offset:15360
    s_waitcnt lgkmcnt(4)
    v_mfma_f32_32x32x16_bf16 v[48:63], v[180:183], a[20:23], v[48:63]
    ds_read_b64_tr_b16 v[176:177], v225 offset:16384
    s_add_u32 s69, s65, s85
    s_add_u32 s69, s69, 16384
    buffer_store_dwordx4 v[204:207], v1, s[44:47], s69 offen sc1
    v_mfma_f32_32x32x16_bf16 v[64:79], v[180:183], a[92:95], v[64:79]
    ds_read_b64_tr_b16 v[178:179], v225 offset:17408
    v_cvt_pk_bf16_f32 v208, v32, v33
    v_cvt_pk_bf16_f32 v209, v34, v35
    s_waitcnt lgkmcnt(4)
    v_mfma_f32_32x32x16_bf16 v[48:63], v[184:187], a[24:27], v[48:63]
    ds_read_b64_tr_b16 v[180:181], v225 offset:18432
    v_cvt_pk_bf16_f32 v210, v36, v37
    v_cvt_pk_bf16_f32 v211, v38, v39
    v_mfma_f32_32x32x16_bf16 v[64:79], v[184:187], a[96:99], v[64:79]
    ds_read_b64_tr_b16 v[182:183], v225 offset:19456
    v_cvt_pk_bf16_f32 v212, v40, v41
    v_cvt_pk_bf16_f32 v213, v42, v43
    s_waitcnt lgkmcnt(4)
    v_mfma_f32_32x32x16_bf16 v[48:63], v[188:191], a[28:31], v[48:63]
    ds_read_b64_tr_b16 v[184:185], v225 offset:20480
    v_cvt_pk_bf16_f32 v214, v44, v45
    v_cvt_pk_bf16_f32 v215, v46, v47
    v_mfma_f32_32x32x16_bf16 v[64:79], v[188:191], a[100:103], v[64:79]
    ds_read_b64_tr_b16 v[186:187], v225 offset:21504
    s_add_u32 s69, s65, s85
    s_add_u32 s69, s69, 589824
    buffer_store_dwordx4 v[208:211], v1, s[44:47], s69 offen sc1
    s_waitcnt lgkmcnt(4)
    v_mfma_f32_32x32x16_bf16 v[48:63], v[176:179], a[32:35], v[48:63]
    ds_read_b64_tr_b16 v[188:189], v225 offset:22528
    v_mfma_f32_32x32x16_bf16 v[64:79], v[176:179], a[104:107], v[64:79]
    ds_read_b64_tr_b16 v[190:191], v225 offset:23552
    s_add_u32 s69, s65, s85
    s_add_u32 s69, s69, 606208
    buffer_store_dwordx4 v[212:215], v1, s[44:47], s69 offen sc1
    s_waitcnt lgkmcnt(4)
    v_mfma_f32_32x32x16_bf16 v[48:63], v[180:183], a[36:39], v[48:63]
    ds_read_b64_tr_b16 v[176:177], v225 offset:24576
    v_mfma_f32_32x32x16_bf16 v[64:79], v[180:183], a[108:111], v[64:79]
    ds_read_b64_tr_b16 v[178:179], v225 offset:25600
    s_waitcnt lgkmcnt(4)
    v_mfma_f32_32x32x16_bf16 v[48:63], v[184:187], a[40:43], v[48:63]
    ds_read_b64_tr_b16 v[180:181], v225 offset:26624
    v_mfma_f32_32x32x16_bf16 v[64:79], v[184:187], a[112:115], v[64:79]
    ds_read_b64_tr_b16 v[182:183], v225 offset:27648
    s_waitcnt lgkmcnt(4)
    v_mfma_f32_32x32x16_bf16 v[48:63], v[188:191], a[44:47], v[48:63]
    ds_read_b64_tr_b16 v[184:185], v225 offset:28672
    v_mfma_f32_32x32x16_bf16 v[64:79], v[188:191], a[116:119], v[64:79]
    ds_read_b64_tr_b16 v[186:187], v225 offset:29696
    s_waitcnt lgkmcnt(4)
    v_mfma_f32_32x32x16_bf16 v[48:63], v[176:179], a[48:51], v[48:63]
    ds_read_b64_tr_b16 v[188:189], v225 offset:30720
    v_mfma_f32_32x32x16_bf16 v[64:79], v[176:179], a[120:123], v[64:79]
    ds_read_b64_tr_b16 v[190:191], v225 offset:31744
    s_waitcnt lgkmcnt(4)
    v_mfma_f32_32x32x16_bf16 v[48:63], v[180:183], a[52:55], v[48:63]
    ds_read_b64_tr_b16 v[176:177], v225 offset:32768
    v_mfma_f32_32x32x16_bf16 v[64:79], v[180:183], a[124:127], v[64:79]
    ds_read_b64_tr_b16 v[178:179], v225 offset:33792
    s_waitcnt lgkmcnt(4)
    v_mfma_f32_32x32x16_bf16 v[48:63], v[184:187], a[56:59], v[48:63]
    ds_read_b64_tr_b16 v[180:181], v225 offset:34816
    v_mfma_f32_32x32x16_bf16 v[64:79], v[184:187], a[128:131], v[64:79]
    ds_read_b64_tr_b16 v[182:183], v225 offset:35840
    s_waitcnt lgkmcnt(4)
    v_mfma_f32_32x32x16_bf16 v[48:63], v[188:191], a[60:63], v[48:63]
    v_mfma_f32_32x32x16_bf16 v[64:79], v[188:191], a[132:135], v[64:79]
    s_waitcnt lgkmcnt(2)
    v_mfma_f32_32x32x16_bf16 v[48:63], v[176:179], a[64:67], v[48:63]
    v_mfma_f32_32x32x16_bf16 v[64:79], v[176:179], a[136:139], v[64:79]
    s_waitcnt lgkmcnt(0)
    v_mfma_f32_32x32x16_bf16 v[48:63], v[180:183], a[68:71], v[48:63]
    v_mfma_f32_32x32x16_bf16 v[64:79], v[180:183], a[140:143], v[64:79]
    s_nop 15
    s_nop 3
    v_cvt_pk_bf16_f32 v200, v48, v49
    v_cvt_pk_bf16_f32 v201, v50, v51
    v_cvt_pk_bf16_f32 v202, v52, v53
    v_cvt_pk_bf16_f32 v203, v54, v55
    v_cvt_pk_bf16_f32 v204, v56, v57
    v_cvt_pk_bf16_f32 v205, v58, v59
    v_cvt_pk_bf16_f32 v206, v60, v61
    v_cvt_pk_bf16_f32 v207, v62, v63
    s_add_u32 s85, s83, 8
    s_cmp_ge_u32 s85, 9
    s_cselect_b32 s87, 9, 0
    s_sub_u32 s85, s85, s87
    s_mul_i32 s85, s85, 65536
    s_add_u32 s69, s65, s85
    s_add_u32 s69, s69, 0
    buffer_store_dwordx4 v[200:203], v1, s[44:47], s69 offen sc1
    s_add_u32 s69, s65, s85
    s_add_u32 s69, s69, 16384
    buffer_store_dwordx4 v[204:207], v1, s[44:47], s69 offen sc1
    v_cvt_pk_bf16_f32 v208, v64, v65
    v_cvt_pk_bf16_f32 v209, v66, v67
    v_cvt_pk_bf16_f32 v210, v68, v69
    v_cvt_pk_bf16_f32 v211, v70, v71
    v_cvt_pk_bf16_f32 v212, v72, v73
    v_cvt_pk_bf16_f32 v213, v74, v75
    v_cvt_pk_bf16_f32 v214, v76, v77
    v_cvt_pk_bf16_f32 v215, v78, v79
    s_add_u32 s69, s65, s85
    s_add_u32 s69, s69, 589824
    buffer_store_dwordx4 v[208:211], v1, s[44:47], s69 offen sc1
    s_add_u32 s69, s65, s85
    s_add_u32 s69, s69, 606208
    buffer_store_dwordx4 v[212:215], v1, s[44:47], s69 offen sc1
    s_cmp_gt_u32 s82, 288
    s_cbranch_scc1 L_ffn_done
    s_mov_b32 s49, s82
    s_lshl_b32 s51, s48, 13
    s_add_u32 s51, s51, 36864
    s_lshl_b32 s50, s49, 13
    v_mov_b32 v2, v248
    s_waitcnt vmcnt(4)
    s_cmp_lg_u32 s71, 0
    s_cbranch_scc1 L_ffn_fgo
    s_mov_b32 s53, 0
L_ffn_fpoll:
    buffer_load_dword v4, v233, s[96:99], 0 offen sc1
    s_waitcnt vmcnt(0)
    v_cmp_eq_u32 vcc, 1, v4
    s_nop 1
    s_cmp_eq_u64 vcc, exec
    s_cbranch_scc1 L_ffn_frd
    s_sleep 8
    s_add_u32 s53, s53, 1
    s_cmp_lt_u32 s53, 100000
    s_cbranch_scc1 L_ffn_fpoll
L_ffn_frd:
    s_lshl_b32 s61, s82, 13
    s_lshl_b32 s62, s48, 13
    s_add_u32 m0, s62, 36864
    s_add_u32 s61, s61, 0
    buffer_load_dwordx4 v232, s[76:79], s61 offen sc1 lds
    s_lshl_b32 s61, s82, 13
    s_lshl_b32 s62, s48, 13
    s_add_u32 m0, s62, 37888
    s_add_u32 s61, s61, 1024
    buffer_load_dwordx4 v232, s[76:79], s61 offen sc1 lds
    s_lshl_b32 s61, s82, 13
    s_lshl_b32 s62, s48, 13
    s_add_u32 m0, s62, 38912
    s_add_u32 s61, s61, 2048
    buffer_load_dwordx4 v232, s[76:79], s61 offen sc1 lds
    s_lshl_b32 s61, s82, 13
    s_lshl_b32 s62, s48, 13
    s_add_u32 m0, s62, 39936
    s_add_u32 s61, s61, 3072
    buffer_load_dwordx4 v232, s[76:79], s61 offen sc1 lds
    s_lshl_b32 s61, s82, 13
    s_lshl_b32 s62, s48, 13
    s_add_u32 m0, s62, 40960
    s_add_u32 s61, s61, 4096
    buffer_load_dwordx4 v232, s[76:79], s61 offen sc1 lds
    s_lshl_b32 s61, s82, 13
    s_lshl_b32 s62, s48, 13
    s_add_u32 m0, s62, 41984
    s_add_u32 s61, s61, 5120
    buffer_load_dwordx4 v232, s[76:79], s61 offen sc1 lds
    s_lshl_b32 s61, s82, 13
    s_lshl_b32 s62, s48, 13
    s_add_u32 m0, s62, 43008
    s_add_u32 s61, s61, 6144
    buffer_load_dwordx4 v232, s[76:79], s61 offen sc1 lds
    s_lshl_b32 s61, s82, 13
    s_lshl_b32 s62, s48, 13
    s_add_u32 m0, s62, 44032
    s_add_u32 s61, s61, 7168
    buffer_load_dwordx4 v232, s[76:79], s61 offen sc1 lds
    s_waitcnt vmcnt(0)
L_ffn_fgo:
    s_mov_b32 s40, s36
    s_mov_b32 s41, s37
    s_mov_b32 s42, s38
    s_mov_b32 s43, s39
    v_bfe_u32 v8, v2, 4, 1
    v_bfe_u32 v9, v2, 5, 1
    v_bfe_u32 v10, v2, 2, 2
    v_and_b32 v11, 3, v2
    v_lshl_add_u32 v12, v9, 3, v10
    v_lshlrev_b32 v12, 7, v12
    v_lshl_add_u32 v12, v11, 3, v12
    v_add_u32 v12, s51, v12
    v_and_b32 v13, 2, v10
    v_xor_b32 v14, v8, v13
    v_lshl_add_u32 v16, v14, 5, v12
    v_xor_b32 v14, 2, v14
    v_lshl_add_u32 v17, v14, 5, v12
    ds_read_b64_tr_b16 v[200:201], v16 offset:0
    ds_read_b64_tr_b16 v[202:203], v16 offset:512
    ds_read_b64_tr_b16 v[204:205], v16 offset:2048
    ds_read_b64_tr_b16 v[206:207], v16 offset:2560
    ds_read_b64_tr_b16 v[208:209], v16 offset:4096
    ds_read_b64_tr_b16 v[210:211], v16 offset:4608
    ds_read_b64_tr_b16 v[212:213], v16 offset:6144
    ds_read_b64_tr_b16 v[214:215], v16 offset:6656
    ds_read_b64_tr_b16 v[216:217], v17 offset:0
    ds_read_b64_tr_b16 v[218:219], v17 offset:512
    ds_read_b64_tr_b16 v[220:221], v17 offset:2048
    ds_read_b64_tr_b16 v[222:223], v17 offset:2560
    ds_read_b64_tr_b16 v[224:225], v17 offset:4096
    ds_read_b64_tr_b16 v[226:227], v17 offset:4608
    ds_read_b64_tr_b16 v[228:229], v17 offset:6144
    ds_read_b64_tr_b16 v[230:231], v17 offset:6656
    v_and_b32 v18, 31, v2
    v_cvt_f32_u32 v18, v18
    v_mul_f32 v18, 0x3a000000, v18
    v_cvt_f32_u32 v19, v9
    v_mul_f32 v19, 4.0, v19
    v_mul_f32 v19, v19, v18
    v_lshlrev_b32 v6, 4, v2
    v_and_b32 v4, 31, v2
    v_lshlrev_b32 v4, 2, v4
    v_lshl_add_u32 v4, v9, 9, v4
    v_add_u32 v4, s51, v4
    v_add_u32 v7, s51, v6
    s_waitcnt lgkmcnt(0)
    v_mfma_f32_32x32x16_bf16 v[64:79], v[200:203], a[144:147], 0
    v_mfma_f32_32x32x16_bf16 v[80:95], v[200:203], a[160:163], 0
    v_mfma_f32_32x32x16_bf16 v[64:79], v[204:207], a[148:151], v[64:79]
    v_mfma_f32_32x32x16_bf16 v[80:95], v[204:207], a[164:167], v[80:95]
    v_mfma_f32_32x32x16_bf16 v[64:79], v[208:211], a[152:155], v[64:79]
    v_mfma_f32_32x32x16_bf16 v[80:95], v[208:211], a[144:147], v[80:95]
    v_mfma_f32_32x32x16_bf16 v[64:79], v[212:215], a[156:159], v[64:79]
    v_mfma_f32_32x32x16_bf16 v[80:95], v[212:215], a[148:151], v[80:95]
    v_mfma_f32_32x32x16_bf16 v[232:247], v[216:219], a[144:147], 0
    v_mfma_f32_32x32x16_bf16 v[96:111], v[216:219], a[160:163], 0
    s_nop 7
    s_nop 3
    v_mfma_f32_32x32x16_bf16 v[232:247], v[220:223], a[148:151], v[232:247]
    v_pk_mul_f32 v[58:59], v[64:65], v[112:113]
    v_pk_mul_f32 v[62:63], v[80:81], v[112:113]
    v_pk_fma_f32 v[58:59], v[80:81], v[144:145], v[58:59]
    v_pk_fma_f32 v[62:63], v[64:65], v[144:145], v[62:63] neg_lo:[1,0,0] neg_hi:[1,0,0]
    v_cvt_pk_bf16_f32 v20, v58, v59
    v_cvt_pk_bf16_f32 v24, v62, v63
    v_mfma_f32_32x32x16_bf16 v[96:111], v[220:223], a[164:167], v[96:111]
    v_pk_mul_f32 v[54:55], v[66:67], v[114:115]
    v_pk_mul_f32 v[56:57], v[82:83], v[114:115]
    v_pk_fma_f32 v[54:55], v[82:83], v[146:147], v[54:55]
    v_pk_fma_f32 v[56:57], v[66:67], v[146:147], v[56:57] neg_lo:[1,0,0] neg_hi:[1,0,0]
    v_cvt_pk_bf16_f32 v21, v54, v55
    v_cvt_pk_bf16_f32 v25, v56, v57
    v_mfma_f32_32x32x16_bf16 v[232:247], v[224:227], a[152:155], v[232:247]
    v_pk_mul_f32 v[58:59], v[68:69], v[116:117]
    v_pk_mul_f32 v[62:63], v[84:85], v[116:117]
    v_pk_fma_f32 v[58:59], v[84:85], v[148:149], v[58:59]
    v_pk_fma_f32 v[62:63], v[68:69], v[148:149], v[62:63] neg_lo:[1,0,0] neg_hi:[1,0,0]
    v_cvt_pk_bf16_f32 v22, v58, v59
    v_cvt_pk_bf16_f32 v26, v62, v63
    v_mfma_f32_32x32x16_bf16 v[96:111], v[224:227], a[144:147], v[96:111]
    v_pk_mul_f32 v[54:55], v[70:71], v[118:119]
    v_pk_mul_f32 v[56:57], v[86:87], v[118:119]
    v_pk_fma_f32 v[54:55], v[86:87], v[150:151], v[54:55]
    v_pk_fma_f32 v[56:57], v[70:71], v[150:151], v[56:57] neg_lo:[1,0,0] neg_hi:[1,0,0]
    v_cvt_pk_bf16_f32 v23, v54, v55
    v_cvt_pk_bf16_f32 v27, v56, v57
    v_mfma_f32_32x32x16_bf16 v[232:247], v[228:231], a[156:159], v[232:247]
    v_pk_mul_f32 v[58:59], v[72:73], v[120:121]
    v_pk_mul_f32 v[62:63], v[88:89], v[120:121]
    v_pk_fma_f32 v[58:59], v[88:89], v[152:153], v[58:59]
    v_pk_fma_f32 v[62:63], v[72:73], v[152:153], v[62:63] neg_lo:[1,0,0] neg_hi:[1,0,0]
    v_cvt_pk_bf16_f32 v28, v58, v59
    v_cvt_pk_bf16_f32 v32, v62, v63
    v_mfma_f32_32x32x16_bf16 v[96:111], v[228:231], a[148:151], v[96:111]
    v_pk_mul_f32 v[54:55], v[74:75], v[122:123]
    v_pk_mul_f32 v[56:57], v[90:91], v[122:123]
    v_pk_fma_f32 v[54:55], v[90:91], v[154:155], v[54:55]
    v_pk_fma_f32 v[56:57], v[74:75], v[154:155], v[56:57] neg_lo:[1,0,0] neg_hi:[1,0,0]
    v_cvt_pk_bf16_f32 v29, v54, v55
    v_cvt_pk_bf16_f32 v33, v56, v57
    v_pk_mul_f32 v[58:59], v[76:77], v[124:125]
    v_pk_mul_f32 v[62:63], v[92:93], v[124:125]
    v_pk_fma_f32 v[58:59], v[92:93], v[156:157], v[58:59]
    v_pk_fma_f32 v[62:63], v[76:77], v[156:157], v[62:63] neg_lo:[1,0,0] neg_hi:[1,0,0]
    v_cvt_pk_bf16_f32 v30, v58, v59
    v_cvt_pk_bf16_f32 v34, v62, v63
    v_pk_mul_f32 v[54:55], v[78:79], v[126:127]
    v_pk_mul_f32 v[56:57], v[94:95], v[126:127]
    v_pk_fma_f32 v[54:55], v[94:95], v[158:159], v[54:55]
    v_pk_fma_f32 v[56:57], v[78:79], v[158:159], v[56:57] neg_lo:[1,0,0] neg_hi:[1,0,0]
    v_cvt_pk_bf16_f32 v31, v54, v55
    v_cvt_pk_bf16_f32 v35, v56, v57
    s_nop 7
    v_pk_mul_f32 v[58:59], v[232:233], v[128:129]
    v_pk_mul_f32 v[62:63], v[96:97], v[128:129]
    v_pk_fma_f32 v[58:59], v[96:97], v[160:161], v[58:59]
    v_pk_fma_f32 v[62:63], v[232:233], v[160:161], v[62:63] neg_lo:[1,0,0] neg_hi:[1,0,0]
    v_cvt_pk_bf16_f32 v36, v58, v59
    v_cvt_pk_bf16_f32 v40, v62, v63
    v_mfma_f32_32x32x16_bf16 v[176:191], a[168:171], v[20:23], 0
    v_pk_mul_f32 v[54:55], v[234:235], v[130:131]
    v_pk_mul_f32 v[56:57], v[98:99], v[130:131]
    v_pk_fma_f32 v[54:55], v[98:99], v[162:163], v[54:55]
    v_pk_fma_f32 v[56:57], v[234:235], v[162:163], v[56:57] neg_lo:[1,0,0] neg_hi:[1,0,0]
    v_cvt_pk_bf16_f32 v37, v54, v55
    v_cvt_pk_bf16_f32 v41, v56, v57
    v_mfma_f32_32x32x16_bf16 v[192:207], a[184:187], v[20:23], 0
    v_pk_mul_f32 v[58:59], v[236:237], v[132:133]
    v_pk_mul_f32 v[62:63], v[100:101], v[132:133]
    v_pk_fma_f32 v[58:59], v[100:101], v[164:165], v[58:59]
    v_pk_fma_f32 v[62:63], v[236:237], v[164:165], v[62:63] neg_lo:[1,0,0] neg_hi:[1,0,0]
    v_cvt_pk_bf16_f32 v38, v58, v59
    v_cvt_pk_bf16_f32 v42, v62, v63
    v_mfma_f32_32x32x16_bf16 v[176:191], a[200:203], v[24:27], v[176:191]
    v_pk_mul_f32 v[54:55], v[238:239], v[134:135]
    v_pk_mul_f32 v[56:57], v[102:103], v[134:135]
    v_pk_fma_f32 v[54:55], v[102:103], v[166:167], v[54:55]
    v_pk_fma_f32 v[56:57], v[238:239], v[166:167], v[56:57] neg_lo:[1,0,0] neg_hi:[1,0,0]
    v_cvt_pk_bf16_f32 v39, v54, v55
    v_cvt_pk_bf16_f32 v43, v56, v57
    v_mfma_f32_32x32x16_bf16 v[192:207], a[216:219], v[24:27], v[192:207]
    v_pk_mul_f32 v[58:59], v[240:241], v[136:137]
    v_pk_mul_f32 v[62:63], v[104:105], v[136:137]
    v_pk_fma_f32 v[58:59], v[104:105], v[168:169], v[58:59]
    v_pk_fma_f32 v[62:63], v[240:241], v[168:169], v[62:63] neg_lo:[1,0,0] neg_hi:[1,0,0]
    v_cvt_pk_bf16_f32 v44, v58, v59
    v_cvt_pk_bf16_f32 v48, v62, v63
    v_mfma_f32_32x32x16_bf16 v[176:191], a[172:175], v[28:31], v[176:191]
    v_pk_mul_f32 v[54:55], v[242:243], v[138:139]
    v_pk_mul_f32 v[56:57], v[106:107], v[138:139]
    v_pk_fma_f32 v[54:55], v[106:107], v[170:171], v[54:55]
    v_pk_fma_f32 v[56:57], v[242:243], v[170:171], v[56:57] neg_lo:[1,0,0] neg_hi:[1,0,0]
    v_cvt_pk_bf16_f32 v45, v54, v55
    v_cvt_pk_bf16_f32 v49, v56, v57
    v_mfma_f32_32x32x16_bf16 v[192:207], a[188:191], v[28:31], v[192:207]
    v_pk_mul_f32 v[58:59], v[244:245], v[140:141]
    v_pk_mul_f32 v[62:63], v[108:109], v[140:141]
    v_pk_fma_f32 v[58:59], v[108:109], v[172:173], v[58:59]
    v_pk_fma_f32 v[62:63], v[244:245], v[172:173], v[62:63] neg_lo:[1,0,0] neg_hi:[1,0,0]
    v_cvt_pk_bf16_f32 v46, v58, v59
    v_cvt_pk_bf16_f32 v50, v62, v63
    v_mfma_f32_32x32x16_bf16 v[176:191], a[204:207], v[32:35], v[176:191]
    v_pk_mul_f32 v[54:55], v[246:247], v[142:143]
    v_pk_mul_f32 v[56:57], v[110:111], v[142:143]
    v_pk_fma_f32 v[54:55], v[110:111], v[174:175], v[54:55]
    v_pk_fma_f32 v[56:57], v[246:247], v[174:175], v[56:57] neg_lo:[1,0,0] neg_hi:[1,0,0]
    v_cvt_pk_bf16_f32 v47, v54, v55
    v_cvt_pk_bf16_f32 v51, v56, v57
    v_mfma_f32_32x32x16_bf16 v[192:207], a[220:223], v[32:35], v[192:207]
    s_nop 1
    v_mfma_f32_32x32x16_bf16 v[176:191], a[176:179], v[36:39], v[176:191]
    v_mfma_f32_32x32x16_bf16 v[192:207], a[192:195], v[36:39], v[192:207]
    v_mfma_f32_32x32x16_bf16 v[176:191], a[208:211], v[40:43], v[176:191]
    v_mfma_f32_32x32x16_bf16 v[192:207], a[224:227], v[40:43], v[192:207]
    v_mfma_f32_32x32x16_bf16 v[176:191], a[180:183], v[44:47], v[176:191]
    v_mfma_f32_32x32x16_bf16 v[192:207], a[196:199], v[44:47], v[192:207]
    v_mfma_f32_32x32x16_bf16 v[176:191], a[212:215], v[48:51], v[176:191]
    v_mfma_f32_32x32x16_bf16 v[192:207], a[228:231], v[48:51], v[192:207]
    s_nop 15
    s_nop 3
    ds_write_b32 v4, v176 offset:0
    ds_write_b32 v4, v177 offset:128
    ds_write_b32 v4, v178 offset:256
    ds_write_b32 v4, v179 offset:384
    ds_write_b32 v4, v180 offset:1024
    ds_write_b32 v4, v181 offset:1152
    ds_write_b32 v4, v182 offset:1280
    ds_write_b32 v4, v183 offset:1408
    ds_write_b32 v4, v184 offset:2048
    ds_write_b32 v4, v185 offset:2176
    ds_write_b32 v4, v186 offset:2304
    ds_write_b32 v4, v187 offset:2432
    ds_write_b32 v4, v188 offset:3072
    ds_write_b32 v4, v189 offset:3200
    ds_write_b32 v4, v190 offset:3328
    ds_write_b32 v4, v191 offset:3456
    ds_write_b32 v4, v192 offset:4096
    ds_write_b32 v4, v193 offset:4224
    ds_write_b32 v4, v194 offset:4352
    ds_write_b32 v4, v195 offset:4480
    ds_write_b32 v4, v196 offset:5120
    ds_write_b32 v4, v197 offset:5248
    ds_write_b32 v4, v198 offset:5376
    ds_write_b32 v4, v199 offset:5504
    ds_write_b32 v4, v200 offset:6144
    ds_write_b32 v4, v201 offset:6272
    ds_write_b32 v4, v202 offset:6400
    ds_write_b32 v4, v203 offset:6528
    ds_write_b32 v4, v204 offset:7168
    ds_write_b32 v4, v205 offset:7296
    ds_write_b32 v4, v206 offset:7424
    ds_write_b32 v4, v207 offset:7552
    s_waitcnt lgkmcnt(0)
    ds_read_b128 v[64:67], v7 offset:0
    ds_read_b128 v[68:71], v7 offset:1024
    ds_read_b128 v[72:75], v7 offset:2048
    ds_read_b128 v[76:79], v7 offset:3072
    ds_read_b128 v[80:83], v7 offset:4096
    ds_read_b128 v[84:87], v7 offset:5120
    ds_read_b128 v[88:91], v7 offset:6144
    ds_read_b128 v[92:95], v7 offset:7168
    s_waitcnt lgkmcnt(7)
    s_add_u32 s52, s50, 0
    buffer_store_dwordx4 v[64:67], v6, s[40:43], s52 offen sc1
    s_waitcnt lgkmcnt(6)
    s_add_u32 s52, s50, 1024
    buffer_store_dwordx4 v[68:71], v6, s[40:43], s52 offen sc1
    s_waitcnt lgkmcnt(5)
    s_add_u32 s52, s50, 2048
    buffer_store_dwordx4 v[72:75], v6, s[40:43], s52 offen sc1
    s_waitcnt lgkmcnt(4)
    s_add_u32 s52, s50, 3072
    buffer_store_dwordx4 v[76:79], v6, s[40:43], s52 offen sc1
    s_waitcnt lgkmcnt(3)
    s_add_u32 s52, s50, 4096
    buffer_store_dwordx4 v[80:83], v6, s[40:43], s52 offen sc1
    s_waitcnt lgkmcnt(2)
    s_add_u32 s52, s50, 5120
    buffer_store_dwordx4 v[84:87], v6, s[40:43], s52 offen sc1
    s_waitcnt lgkmcnt(1)
    s_add_u32 s52, s50, 6144
    buffer_store_dwordx4 v[88:91], v6, s[40:43], s52 offen sc1
    s_waitcnt lgkmcnt(0)
    s_add_u32 s52, s50, 7168
    buffer_store_dwordx4 v[92:95], v6, s[40:43], s52 offen sc1
L_ffn_done:
    s_endpgm
.text
.globl fin_kernel
.p2align 8
.type fin_kernel,@function
fin_kernel:
    s_cmp_ge_u32 s2, 256
    s_cbranch_scc1 L_k3_done
    s_load_dwordx2 s[4:5], s[0:1], 0
    s_load_dwordx4 s[8:11], s[0:1], 16
    s_load_dwordx2 s[12:13], s[0:1], 32
    s_load_dwordx8 s[16:23], s[0:1], 48
    s_load_dwordx4 s[24:27], s[0:1], 80
    s_waitcnt lgkmcnt(0)
    v_lshrrev_b32 v1, 6, v0
    v_and_b32 v2, 63, v0
    v_readfirstlane_b32 s48, v1
    s_add_u32 s32, s26, 25165824
    s_addc_u32 s33, s27, 0
    s_mov_b32 s34, 37748736
    s_mov_b32 s35, 0x00020000
    s_add_u32 s36, s26, 12582912
    s_addc_u32 s37, s27, 0
    s_mov_b32 s38, 2367488
    s_mov_b32 s39, 0x00020000
    s_mov_b32 s40, s4
    s_mov_b32 s41, s5
    s_mov_b32 s42, 2359296
    s_mov_b32 s43, 0x00020000
    s_mov_b32 s44, s22
    s_mov_b32 s45, s23
    s_mov_b32 s46, 2359296
    s_mov_b32 s47, 0x00020000
    s_mul_i32 s49, s2, 9
    s_add_u32 s49, s49, s48
    v_lshlrev_b32 v3, 4, v2
    s_lshl_b32 s53, s49, 14
    buffer_load_dwordx4 v[32:35], v3, s[32:35], s53 offen offset:0
    buffer_load_dwordx4 v[36:39], v3, s[32:35], s53 offen offset:1024
    buffer_load_dwordx4 v[40:43], v3, s[32:35], s53 offen offset:2048
    buffer_load_dwordx4 v[44:47], v3, s[32:35], s53 offen offset:3072
    s_add_u32 s53, s53, 4096
    buffer_load_dwordx4 v[48:51], v3, s[32:35], s53 offen offset:0
    buffer_load_dwordx4 v[52:55], v3, s[32:35], s53 offen offset:1024
    buffer_load_dwordx4 v[56:59], v3, s[32:35], s53 offen offset:2048
    buffer_load_dwordx4 v[60:63], v3, s[32:35], s53 offen offset:3072
    s_add_u32 s53, s53, 4096
    buffer_load_dwordx4 v[64:67], v3, s[32:35], s53 offen offset:0
    buffer_load_dwordx4 v[68:71], v3, s[32:35], s53 offen offset:1024
    buffer_load_dwordx4 v[72:75], v3, s[32:35], s53 offen offset:2048
    buffer_load_dwordx4 v[76:79], v3, s[32:35], s53 offen offset:3072
    s_add_u32 s53, s53, 4096
    buffer_load_dwordx4 v[80:83], v3, s[32:35], s53 offen offset:0
    buffer_load_dwordx4 v[84:87], v3, s[32:35], s53 offen offset:1024
    buffer_load_dwordx4 v[88:91], v3, s[32:35], s53 offen offset:2048
    buffer_load_dwordx4 v[92:95], v3, s[32:35], s53 offen offset:3072
    s_mul_hi_u32 s51, s49, 119304648
    s_mul_i32 s52, s51, 36
    s_sub_u32 s52, s49, s52
    s_and_b32 s50, s52, 1
    s_lshr_b32 s52, s52, 1
    v_and_b32 v4, 31, v2
    v_lshrrev_b32 v5, 5, v2
    s_lshl_b32 s55, s51, 5
    v_add_u32 v12, s55, v4
    s_movk_i32 s56, 1152
    v_mul_lo_u32 v7, v12, s56
    s_lshl_b32 s57, s52, 6
    s_lshl_b32 s58, s50, 5
    s_add_u32 s57, s57, s58
    v_add_u32 v7, s57, v7
    v_lshl_add_u32 v8, v5, 3, v7
    buffer_load_dwordx2 v[100:101], v8, s[40:43], 0 offen offset:0
    buffer_load_dwordx2 v[102:103], v8, s[40:43], 0 offen offset:16
    v_lshl_add_u32 v9, v5, 4, v7
    s_lshl_b32 s59, s52, 5
    s_lshl_b32 s58, s50, 4
    s_add_u32 s59, s59, s58
    s_cmp_le_u32 s52, 8
    s_cbranch_scc0 L_k3_mir
    v_lshlrev_b32 v6, 15, v5
    v_lshl_add_u32 v6, v12, 2, v6
    s_lshl_b32 s54, s59, 13
    s_movk_i32 s58, 8192
    s_branch L_k3_yad
L_k3_mir:
    v_sub_u32 v6, 2048, v12
    v_and_b32 v6, 2047, v6
    v_lshlrev_b32 v6, 2, v6
    v_xor_b32 v13, 1, v5
    v_lshl_add_u32 v6, v13, 15, v6
    s_sub_u32 s54, 572, s59
    s_lshl_b32 s54, s54, 13
    s_mov_b32 s58, 4294959104
L_k3_yad:
    s_mul_i32 s55, s58, 0
    s_add_u32 s55, s55, s54
    buffer_load_dword v104, v6, s[36:39], s55 offen
    s_mul_i32 s55, s58, 1
    s_add_u32 s55, s55, s54
    buffer_load_dword v105, v6, s[36:39], s55 offen
    s_mul_i32 s55, s58, 2
    s_add_u32 s55, s55, s54
    buffer_load_dword v106, v6, s[36:39], s55 offen
    s_mul_i32 s55, s58, 3
    s_add_u32 s55, s55, s54
    buffer_load_dword v107, v6, s[36:39], s55 offen
    s_mul_i32 s55, s58, 8
    s_add_u32 s55, s55, s54
    buffer_load_dword v108, v6, s[36:39], s55 offen
    s_mul_i32 s55, s58, 9
    s_add_u32 s55, s55, s54
    buffer_load_dword v109, v6, s[36:39], s55 offen
    s_mul_i32 s55, s58, 10
    s_add_u32 s55, s55, s54
    buffer_load_dword v110, v6, s[36:39], s55 offen
    s_mul_i32 s55, s58, 11
    s_add_u32 s55, s55, s54
    buffer_load_dword v111, v6, s[36:39], s55 offen
    s_waitcnt vmcnt(25)
    v_lshlrev_b32 v16, 16, v32
    v_and_b32 v17, 0xffff0000, v32
    v_lshlrev_b32 v18, 16, v33
    v_and_b32 v19, 0xffff0000, v33
    v_lshlrev_b32 v20, 16, v34
    v_and_b32 v21, 0xffff0000, v34
    v_lshlrev_b32 v22, 16, v35
    v_and_b32 v23, 0xffff0000, v35
    s_waitcnt vmcnt(24)
    v_lshlrev_b32 v10, 16, v36
    v_and_b32 v11, 0xffff0000, v36
    v_add_f32 v16, v16, v10
    v_add_f32 v17, v17, v11
    v_lshlrev_b32 v10, 16, v37
    v_and_b32 v11, 0xffff0000, v37
    v_add_f32 v18, v18, v10
    v_add_f32 v19, v19, v11
    v_lshlrev_b32 v10, 16, v38
    v_and_b32 v11, 0xffff0000, v38
    v_add_f32 v20, v20, v10
    v_add_f32 v21, v21, v11
    v_lshlrev_b32 v10, 16, v39
    v_and_b32 v11, 0xffff0000, v39
    v_add_f32 v22, v22, v10
    v_add_f32 v23, v23, v11
    s_waitcnt vmcnt(23)
    v_lshlrev_b32 v10, 16, v40
    v_and_b32 v11, 0xffff0000, v40
    v_add_f32 v16, v16, v10
    v_add_f32 v17, v17, v11
    v_lshlrev_b32 v10, 16, v41
    v_and_b32 v11, 0xffff0000, v41
    v_add_f32 v18, v18, v10
    v_add_f32 v19, v19, v11
    v_lshlrev_b32 v10, 16, v42
    v_and_b32 v11, 0xffff0000, v42
    v_add_f32 v20, v20, v10
    v_add_f32 v21, v21, v11
    v_lshlrev_b32 v10, 16, v43
    v_and_b32 v11, 0xffff0000, v43
    v_add_f32 v22, v22, v10
    v_add_f32 v23, v23, v11
    s_waitcnt vmcnt(22)
    v_lshlrev_b32 v10, 16, v44
    v_and_b32 v11, 0xffff0000, v44
    v_add_f32 v16, v16, v10
    v_add_f32 v17, v17, v11
    v_lshlrev_b32 v10, 16, v45
    v_and_b32 v11, 0xffff0000, v45
    v_add_f32 v18, v18, v10
    v_add_f32 v19, v19, v11
    v_lshlrev_b32 v10, 16, v46
    v_and_b32 v11, 0xffff0000, v46
    v_add_f32 v20, v20, v10
    v_add_f32 v21, v21, v11
    v_lshlrev_b32 v10, 16, v47
    v_and_b32 v11, 0xffff0000, v47
    v_add_f32 v22, v22, v10
    v_add_f32 v23, v23, v11
    s_waitcnt vmcnt(21)
    v_lshlrev_b32 v10, 16, v48
    v_and_b32 v11, 0xffff0000, v48
    v_add_f32 v16, v16, v10
    v_add_f32 v17, v17, v11
    v_lshlrev_b32 v10, 16, v49
    v_and_b32 v11, 0xffff0000, v49
    v_add_f32 v18, v18, v10
    v_add_f32 v19, v19, v11
    v_lshlrev_b32 v10, 16, v50
    v_and_b32 v11, 0xffff0000, v50
    v_add_f32 v20, v20, v10
    v_add_f32 v21, v21, v11
    v_lshlrev_b32 v10, 16, v51
    v_and_b32 v11, 0xffff0000, v51
    v_add_f32 v22, v22, v10
    v_add_f32 v23, v23, v11
    s_waitcnt vmcnt(20)
    v_lshlrev_b32 v10, 16, v52
    v_and_b32 v11, 0xffff0000, v52
    v_add_f32 v16, v16, v10
    v_add_f32 v17, v17, v11
    v_lshlrev_b32 v10, 16, v53
    v_and_b32 v11, 0xffff0000, v53
    v_add_f32 v18, v18, v10
    v_add_f32 v19, v19, v11
    v_lshlrev_b32 v10, 16, v54
    v_and_b32 v11, 0xffff0000, v54
    v_add_f32 v20, v20, v10
    v_add_f32 v21, v21, v11
    v_lshlrev_b32 v10, 16, v55
    v_and_b32 v11, 0xffff0000, v55
    v_add_f32 v22, v22, v10
    v_add_f32 v23, v23, v11
    s_waitcnt vmcnt(19)
    v_lshlrev_b32 v10, 16, v56
    v_and_b32 v11, 0xffff0000, v56
    v_add_f32 v16, v16, v10
    v_add_f32 v17, v17, v11
    v_lshlrev_b32 v10, 16, v57
    v_and_b32 v11, 0xffff0000, v57
    v_add_f32 v18, v18, v10
    v_add_f32 v19, v19, v11
    v_lshlrev_b32 v10, 16, v58
    v_and_b32 v11, 0xffff0000, v58
    v_add_f32 v20, v20, v10
    v_add_f32 v21, v21, v11
    v_lshlrev_b32 v10, 16, v59
    v_and_b32 v11, 0xffff0000, v59
    v_add_f32 v22, v22, v10
    v_add_f32 v23, v23, v11
    s_waitcnt vmcnt(18)
    v_lshlrev_b32 v10, 16, v60
    v_and_b32 v11, 0xffff0000, v60
    v_add_f32 v16, v16, v10
    v_add_f32 v17, v17, v11
    v_lshlrev_b32 v10, 16, v61
    v_and_b32 v11, 0xffff0000, v61
    v_add_f32 v18, v18, v10
    v_add_f32 v19, v19, v11
    v_lshlrev_b32 v10, 16, v62
    v_and_b32 v11, 0xffff0000, v62
    v_add_f32 v20, v20, v10
    v_add_f32 v21, v21, v11
    v_lshlrev_b32 v10, 16, v63
    v_and_b32 v11, 0xffff0000, v63
    v_add_f32 v22, v22, v10
    v_add_f32 v23, v23, v11
    s_waitcnt vmcnt(17)
    v_lshlrev_b32 v10, 16, v64
    v_and_b32 v11, 0xffff0000, v64
    v_add_f32 v16, v16, v10
    v_add_f32 v17, v17, v11
    v_lshlrev_b32 v10, 16, v65
    v_and_b32 v11, 0xffff0000, v65
    v_add_f32 v18, v18, v10
    v_add_f32 v19, v19, v11
    v_lshlrev_b32 v10, 16, v66
    v_and_b32 v11, 0xffff0000, v66
    v_add_f32 v20, v20, v10
    v_add_f32 v21, v21, v11
    v_lshlrev_b32 v10, 16, v67
    v_and_b32 v11, 0xffff0000, v67
    v_add_f32 v22, v22, v10
    v_add_f32 v23, v23, v11
    s_waitcnt vmcnt(16)
    v_lshlrev_b32 v10, 16, v68
    v_and_b32 v11, 0xffff0000, v68
    v_add_f32 v16, v16, v10
    v_add_f32 v17, v17, v11
    v_lshlrev_b32 v10, 16, v69
    v_and_b32 v11, 0xffff0000, v69
    v_add_f32 v18, v18, v10
    v_add_f32 v19, v19, v11
    v_lshlrev_b32 v10, 16, v70
    v_and_b32 v11, 0xffff0000, v70
    v_add_f32 v20, v20, v10
    v_add_f32 v21, v21, v11
    v_lshlrev_b32 v10, 16, v71
    v_and_b32 v11, 0xffff0000, v71
    v_add_f32 v22, v22, v10
    v_add_f32 v23, v23, v11
    s_waitcnt vmcnt(15)
    v_lshlrev_b32 v10, 16, v72
    v_and_b32 v11, 0xffff0000, v72
    v_add_f32 v16, v16, v10
    v_add_f32 v17, v17, v11
    v_lshlrev_b32 v10, 16, v73
    v_and_b32 v11, 0xffff0000, v73
    v_add_f32 v18, v18, v10
    v_add_f32 v19, v19, v11
    v_lshlrev_b32 v10, 16, v74
    v_and_b32 v11, 0xffff0000, v74
    v_add_f32 v20, v20, v10
    v_add_f32 v21, v21, v11
    v_lshlrev_b32 v10, 16, v75
    v_and_b32 v11, 0xffff0000, v75
    v_add_f32 v22, v22, v10
    v_add_f32 v23, v23, v11
    s_waitcnt vmcnt(14)
    v_lshlrev_b32 v10, 16, v76
    v_and_b32 v11, 0xffff0000, v76
    v_add_f32 v16, v16, v10
    v_add_f32 v17, v17, v11
    v_lshlrev_b32 v10, 16, v77
    v_and_b32 v11, 0xffff0000, v77
    v_add_f32 v18, v18, v10
    v_add_f32 v19, v19, v11
    v_lshlrev_b32 v10, 16, v78
    v_and_b32 v11, 0xffff0000, v78
    v_add_f32 v20, v20, v10
    v_add_f32 v21, v21, v11
    v_lshlrev_b32 v10, 16, v79
    v_and_b32 v11, 0xffff0000, v79
    v_add_f32 v22, v22, v10
    v_add_f32 v23, v23, v11
    s_waitcnt vmcnt(13)
    v_lshlrev_b32 v10, 16, v80
    v_and_b32 v11, 0xffff0000, v80
    v_add_f32 v16, v16, v10
    v_add_f32 v17, v17, v11
    v_lshlrev_b32 v10, 16, v81
    v_and_b32 v11, 0xffff0000, v81
    v_add_f32 v18, v18, v10
    v_add_f32 v19, v19, v11
    v_lshlrev_b32 v10, 16, v82
    v_and_b32 v11, 0xffff0000, v82
    v_add_f32 v20, v20, v10
    v_add_f32 v21, v21, v11
    v_lshlrev_b32 v10, 16, v83
    v_and_b32 v11, 0xffff0000, v83
    v_add_f32 v22, v22, v10
    v_add_f32 v23, v23, v11
    s_waitcnt vmcnt(12)
    v_lshlrev_b32 v10, 16, v84
    v_and_b32 v11, 0xffff0000, v84
    v_add_f32 v16, v16, v10
    v_add_f32 v17, v17, v11
    v_lshlrev_b32 v10, 16, v85
    v_and_b32 v11, 0xffff0000, v85
    v_add_f32 v18, v18, v10
    v_add_f32 v19, v19, v11
    v_lshlrev_b32 v10, 16, v86
    v_and_b32 v11, 0xffff0000, v86
    v_add_f32 v20, v20, v10
    v_add_f32 v21, v21, v11
    v_lshlrev_b32 v10, 16, v87
    v_and_b32 v11, 0xffff0000, v87
    v_add_f32 v22, v22, v10
    v_add_f32 v23, v23, v11
    s_waitcnt vmcnt(11)
    v_lshlrev_b32 v10, 16, v88
    v_and_b32 v11, 0xffff0000, v88
    v_add_f32 v16, v16, v10
    v_add_f32 v17, v17, v11
    v_lshlrev_b32 v10, 16, v89
    v_and_b32 v11, 0xffff0000, v89
    v_add_f32 v18, v18, v10
    v_add_f32 v19, v19, v11
    v_lshlrev_b32 v10, 16, v90
    v_and_b32 v11, 0xffff0000, v90
    v_add_f32 v20, v20, v10
    v_add_f32 v21, v21, v11
    v_lshlrev_b32 v10, 16, v91
    v_and_b32 v11, 0xffff0000, v91
    v_add_f32 v22, v22, v10
    v_add_f32 v23, v23, v11
    s_waitcnt vmcnt(10)
    v_lshlrev_b32 v10, 16, v92
    v_and_b32 v11, 0xffff0000, v92
    v_add_f32 v16, v16, v10
    v_add_f32 v17, v17, v11
    v_lshlrev_b32 v10, 16, v93
    v_and_b32 v11, 0xffff0000, v93
    v_add_f32 v18, v18, v10
    v_add_f32 v19, v19, v11
    v_lshlrev_b32 v10, 16, v94
    v_and_b32 v11, 0xffff0000, v94
    v_add_f32 v20, v20, v10
    v_add_f32 v21, v21, v11
    v_lshlrev_b32 v10, 16, v95
    v_and_b32 v11, 0xffff0000, v95
    v_add_f32 v22, v22, v10
    v_add_f32 v23, v23, v11
    s_waitcnt vmcnt(0)
    v_lshlrev_b32 v10, 16, v100
    v_and_b32 v11, 0xffff0000, v100
    v_add_f32 v16, v16, v10
    v_add_f32 v17, v17, v11
    v_lshlrev_b32 v10, 16, v101
    v_and_b32 v11, 0xffff0000, v101
    v_add_f32 v18, v18, v10
    v_add_f32 v19, v19, v11
    v_lshlrev_b32 v10, 16, v102
    v_and_b32 v11, 0xffff0000, v102
    v_add_f32 v20, v20, v10
    v_add_f32 v21, v21, v11
    v_lshlrev_b32 v10, 16, v103
    v_and_b32 v11, 0xffff0000, v103
    v_add_f32 v22, v22, v10
    v_add_f32 v23, v23, v11
    s_waitcnt vmcnt(0)
    v_add_f32 v16, v16, v104
    v_add_f32 v17, v17, v105
    v_add_f32 v18, v18, v106
    v_add_f32 v19, v19, v107
    v_add_f32 v20, v20, v108
    v_add_f32 v21, v21, v109
    v_add_f32 v22, v22, v110
    v_add_f32 v23, v23, v111
    v_cvt_pk_bf16_f32 v32, v16, v17
    v_cvt_pk_bf16_f32 v33, v18, v19
    v_cvt_pk_bf16_f32 v34, v20, v21
    v_cvt_pk_bf16_f32 v35, v22, v23
    s_nop 1
    v_permlane32_swap_b32 v32, v34
    v_permlane32_swap_b32 v33, v35
    s_nop 1
    buffer_store_dwordx4 v[32:35], v9, s[44:47], 0 offen
L_k3_done:
    s_endpgm
L_code_end:
.section .rodata,"a"
.p2align 6
.amdhsa_kernel prep_kernel
  .amdhsa_next_free_vgpr 128
  .amdhsa_next_free_sgpr 96
  .amdhsa_accum_offset 128
  .amdhsa_group_segment_fixed_size 0
  .amdhsa_kernarg_size 96
  .amdhsa_user_sgpr_count 2
  .amdhsa_user_sgpr_kernarg_segment_ptr 1
  .amdhsa_system_sgpr_workgroup_id_x 1
  .amdhsa_float_denorm_mode_32 3
  .amdhsa_float_denorm_mode_16_64 3
.end_amdhsa_kernel
.section .rodata,"a"
.p2align 6
.amdhsa_kernel ffn_kernel
  .amdhsa_next_free_vgpr 512
  .amdhsa_next_free_sgpr 102
  .amdhsa_accum_offset 256
  .amdhsa_group_segment_fixed_size 0
  .amdhsa_kernarg_size 96
  .amdhsa_user_sgpr_count 2
  .amdhsa_user_sgpr_kernarg_segment_ptr 1
  .amdhsa_system_sgpr_workgroup_id_x 1
  .amdhsa_float_denorm_mode_32 3
  .amdhsa_float_denorm_mode_16_64 3
.end_amdhsa_kernel
.section .rodata,"a"
.p2align 6
.amdhsa_kernel fin_kernel
  .amdhsa_next_free_vgpr 160
  .amdhsa_next_free_sgpr 96
  .amdhsa_accum_offset 160
  .amdhsa_group_segment_fixed_size 0
  .amdhsa_kernarg_size 96
  .amdhsa_user_sgpr_count 2
  .amdhsa_user_sgpr_kernarg_segment_ptr 1
  .amdhsa_system_sgpr_workgroup_id_x 1
  .amdhsa_float_denorm_mode_32 3
  .amdhsa_float_denorm_mode_16_64 3
.end_amdhsa_kernel
```
